```python
import torch

def _softmax(x, axis=-1):
    return torch.softmax(x, dim=axis)
def _gelu(x):
    return torch.nn.functional.gelu(x, approximate="tanh")
def _silu(x):
    return torch.nn.functional.silu(x)
def _sigmoid(x):
    return torch.sigmoid(x)
def _layernorm(x, axis=-1, eps=1e-5):
    m = x.mean(dim=axis, keepdim=True)
    v = x.var(dim=axis, keepdim=True, unbiased=False)
    return (x - m) / torch.sqrt(v + eps)
def _scatter_add(tgt, idx, src, axis=0):
    return tgt.clone().index_add_(axis, idx, src)
def _segment_sum(src, seg, n):
    out = torch.zeros((n,) + src.shape[1:], dtype=src.dtype)
    return out.index_add_(0, seg, src)
def _pad(x, pw):
    flat = tuple(v for pair in reversed(pw) for v in pair)
    return torch.nn.functional.pad(x, flat)

kernel_name = 'recurrent_scan__softmax_full_mha__geglu_ffn__prompt'

def setup_inputs():

    _w = (lambda a: (lambda t: t.to(torch.bfloat16) if t.is_floating_point() else t)(torch.as_tensor(a)))
    def _A_setup():
        B, S, D = 1, 2048, 576
        return {
            "x": _w((lambda *s: torch.randn(*s, dtype=torch.bfloat16) * 0.05)(B, S, D)),
            "wqkv": _w((lambda *s: torch.randn(*s, dtype=torch.bfloat16) * 0.05)(D, 3 * D)),
            "wo": _w((lambda *s: torch.randn(*s, dtype=torch.bfloat16) * 0.05)(D, D)),
        }
    _A_in = _A_setup()

    def _B_setup():
        B, S, D, F = 1, 2048, 576, 4608
        return {
            "x": _w((lambda *s: torch.randn(*s, dtype=torch.bfloat16) * 0.05)(B, S, D)),
            "w_gate": _w((lambda *s: torch.randn(*s, dtype=torch.bfloat16) * 0.05)(D, F)),
            "w_up": _w((lambda *s: torch.randn(*s, dtype=torch.bfloat16) * 0.05)(D, F)),
            "w_down": _w((lambda *s: torch.randn(*s, dtype=torch.bfloat16) * 0.05)(F, D)),
        }
    _B_in = _B_setup()

    return {
        "A_x": _A_in["x"],
        "A_wqkv": _A_in["wqkv"],
        "A_wo": _A_in["wo"],
        "B_x": _B_in["x"],
        "B_w_gate": _B_in["w_gate"],
        "B_w_up": _B_in["w_up"],
        "B_w_down": _B_in["w_down"],
    }

def reference(A_x, A_wqkv, A_wo, B_x, B_w_gate, B_w_up, B_w_down):
    def _A_ref(x, wqkv, wo):
        B, S, D = x.shape
        H = 32; Dh = D // H
        qkv = (lambda x, *d: x.permute(*d))((x @ wqkv).reshape(B, S, 3, H, Dh), 2, 0, 3, 1, 4)
        q, k, v = qkv[0], qkv[1], qkv[2]
        scale = Dh ** -0.5
        scores = torch.einsum("bhqd,bhkd->bhqk", q, k) * scale
        p = _softmax(scores, axis=-1)
        o = torch.einsum("bhqk,bhkd->bhqd", p, v)
        return (lambda x, *d: x.permute(*d))(o, 0, 2, 1, 3).reshape(B, S, D) @ wo

    def _B_ref(x, w_gate, w_up, w_down):
        return (_gelu(x @ w_gate) * (x @ w_up)) @ w_down

    x = A_x
    xn = _layernorm(x, axis=-1)
    s = _A_ref(xn, A_wqkv, A_wo)
    g = _silu(_B_ref(xn, B_w_gate, B_w_up, B_w_down))
    return x + s * g
```

```asm
; @launch kernel=gemm1_kernel grid=(256,1,1) block=(256,1,1) lds=147456
; @launch kernel=mid_kernel grid=(512,1,1) block=(256,1,1) lds=77824
.amdgcn_target "amdgcn-amd-amdhsa--gfx950"
.text
.globl gemm1_kernel
.p2align 8
.type gemm1_kernel,@function
gemm1_kernel:
    s_cmp_ge_u32 s2, 256
    s_cbranch_scc1 L_k1_end
    s_load_dwordx4 s[68:71], s[0:1], 0
    s_load_dwordx4 s[64:67], s[0:1], 32
    s_load_dwordx4 s[4:7], s[0:1], 64
    s_load_dwordx2 s[80:81], s[0:1], 16
    s_load_dwordx2 s[76:77], s[0:1], 48
    s_memrealtime s[60:61]
    v_lshrrev_b32 v1, 6, v0
    v_and_b32 v0, 63, v0
    v_readfirstlane_b32 s40, v1
    s_getpc_b64 s[32:33]
L_k1_pc:
    s_and_b32 s32, s32, 0xffffff00
    s_bitcmp1_b32 s2, 3
    s_cselect_b32 s34, L_code_end - L_k1_pc, 0
    s_mov_b32 s35, 0x00020000
    v_lshlrev_b32 v123, 7, v0
    s_lshr_b32 s51, s2, 4
    s_lshl_b32 s52, s51, 2
    s_add_u32 s52, s52, s40
    s_lshl_b32 s53, s52, 13
    buffer_load_dword v114, v123, s[32:35], s53 offen
    s_lshl_b32 s51, s51, 3
    s_and_b32 s42, s2, 7
    s_add_u32 s51, s51, s42
    s_lshl_b32 s51, s51, 2
    s_add_u32 s51, s51, s40
    s_lshl_b32 s42, s42, 2
    s_lshr_b32 s53, s2, 6
    s_add_u32 s42, s42, s53
    s_add_u32 s53, s42, 112
    s_lshl_b32 s50, s42, 1
    s_sub_u32 s58, s50, 28
    s_cmp_ge_u32 s42, 28
    s_cselect_b32 s50, s53, s50
    s_cselect_b32 s58, s58, s42
    v_mov_b32 v125, 0
    v_mov_b32 v119, 1073741824
    s_bitcmp1_b32 s2, 3
    s_cbranch_scc1 L_k1_touch
    s_waitcnt lgkmcnt(0)
    s_mov_b64 s[12:13], s[70:71]
    s_mov_b32 s70, 2359296
    s_mov_b32 s71, 0x00020000
    v_lshrrev_b32 v129, 4, v0
    s_lshl_b32 s52, s51, 2
    v_add_u32 v129, s52, v129
    v_and_b32 v130, 15, v0
    v_mul_u32_u24 v131, 1152, v129
    v_lshl_add_u32 v131, v130, 3, v131
    buffer_load_dwordx2 v[136:137], v131, s[68:71], 0 offen offset:0 nt
    buffer_load_dwordx2 v[138:139], v131, s[68:71], 0 offen offset:128 nt
    buffer_load_dwordx2 v[140:141], v131, s[68:71], 0 offen offset:256 nt
    buffer_load_dwordx2 v[142:143], v131, s[68:71], 0 offen offset:384 nt
    buffer_load_dwordx2 v[144:145], v131, s[68:71], 0 offen offset:512 nt
    buffer_load_dwordx2 v[146:147], v131, s[68:71], 0 offen offset:640 nt
    buffer_load_dwordx2 v[148:149], v131, s[68:71], 0 offen offset:768 nt
    buffer_load_dwordx2 v[150:151], v131, s[68:71], 0 offen offset:896 nt
    buffer_load_dwordx2 v[152:153], v131, s[68:71], 0 offen offset:1024 nt
    s_cmp_lg_u32 s51, 0
    s_cbranch_scc1 L_k1_setup
    s_or_b32 s60, s60, 1
    v_mov_b32 v52, s60
    v_mov_b32 v53, s61
    global_store_dwordx2 v125, v[52:53], s[4:5] sc1
    s_branch L_k1_setup
L_k1_touch:
    s_and_b32 s52, s52, 15
    s_mul_i32 s53, s52, 36
    v_cmp_gt_u32 vcc, 36, v0
    v_add_u32 v123, s53, v0
    v_mul_u32_u24 v124, 3456, v123
    v_mul_u32_u24 v123, 9216, v123
    v_cndmask_b32 v123, v119, v123, vcc
    v_cndmask_b32 v124, v119, v124, vcc
    s_lshl_b32 s53, s50, 6
    s_waitcnt lgkmcnt(0)
    s_mov_b32 s16, s64
    s_mov_b32 s17, s65
    s_mov_b32 s18, 5308416
    s_mov_b32 s19, 0x00020000
    buffer_load_dword v114, v123, s[16:19], s53 offen nt
    s_mov_b32 s20, s66
    s_mov_b32 s21, s67
    s_mov_b32 s22, 5308416
    s_mov_b32 s23, 0x00020000
    buffer_load_dword v114, v123, s[20:23], s53 offen nt
    s_mov_b64 s[12:13], s[70:71]
    s_cmp_ge_u32 s42, 28
    s_cselect_b32 s14, 1990656, 0
    s_mov_b32 s15, 0x00020000
    s_lshl_b32 s53, s58, 6
    buffer_load_dword v114, v124, s[12:15], s53 offen nt
    s_mov_b32 s70, 2359296
    s_mov_b32 s71, 0x00020000
L_k1_setup:
    s_mov_b32 s14, 1990656
    s_mov_b32 s15, 0x00020000
    s_mov_b32 s8, s6
    s_mov_b32 s9, s7
    s_mov_b32 s10, 2359296
    s_mov_b32 s11, 0x00020000
    s_mov_b32 s16, s64
    s_mov_b32 s17, s65
    s_mov_b32 s18, 5308416
    s_mov_b32 s19, 0x00020000
    s_mov_b32 s20, s66
    s_mov_b32 s21, s67
    s_mov_b32 s22, 5308416
    s_mov_b32 s23, 0x00020000
    s_bfe_u32 s41, s2, 0x30003
    s_mov_b32 s59, 1
    s_mov_b32 s101, s51
    v_lshlrev_b32 v15, 4, v0
    v_lshrrev_b32 v123, 2, v0
    v_lshrrev_b32 v124, 4, v0
    v_and_b32 v124, 2, v124
    v_xor_b32 v124, v124, v0
    v_and_b32 v124, 3, v124
    v_mul_u32_u24 v11, 9216, v123
    v_lshl_add_u32 v11, v124, 4, v11
    v_mul_u32_u24 v12, 3456, v123
    v_lshl_add_u32 v12, v124, 4, v12
    s_lshl_b32 s57, s41, 3
    s_lshl_b32 s52, s40, 1
    s_add_u32 s57, s57, s52
    s_mul_i32 s72, s57, 294912
    s_lshl_b32 s52, s50, 10
    s_add_u32 s73, s72, s52
    s_mul_i32 s43, s40, 147456
    s_lshl_b32 s52, s50, 6
    s_add_u32 s43, s43, s52
    s_add_u32 s50, s50, 1
    s_lshl_b32 s98, s40, 10
    s_add_u32 s48, s98, 73728
    s_xor_b32 s54, s98, s48
    s_mul_i32 s63, s57, 36864
    s_add_u32 s55, s63, 18432
    s_add_u32 s94, s63, 36864
    s_add_u32 s95, s63, 55296
    s_mov_b32 s35, 0x00020000
    s_mov_b32 s39, 0x00020000
    s_mov_b64 s[32:33], s[16:17]
    s_mov_b32 s34, s18
    s_mov_b64 s[36:37], s[20:21]
    s_mov_b32 s38, s22
    v_mov_b32 v9, v11
    v_mov_b32 v10, v11
    s_mov_b32 s46, 589824
    s_mov_b32 s47, 589824
    s_mul_i32 s44, s40, 147456
    s_lshl_b32 s52, s50, 6
    s_add_u32 s44, s44, s52
    s_mov_b32 s45, s44
    s_lshl_b32 s52, s50, 10
    s_add_u32 s74, s72, s52
    s_add_u32 s50, s50, 28
    s_add_u32 s50, s42, 56
    s_cmp_lt_u32 s42, 28
    s_cbranch_scc1 L_k1_p_done
    s_mov_b64 s[32:33], s[12:13]
    s_mov_b32 s34, s14
    v_mov_b32 v9, v12
    s_mov_b32 s46, 221184
    s_mul_i32 s44, s40, 55296
    s_lshl_b32 s52, s58, 6
    s_add_u32 s44, s44, s52
    s_mov_b64 s[36:37], s[12:13]
    s_mov_b32 s38, s14
    v_mov_b32 v10, v12
    s_mov_b32 s47, 221184
    s_add_u32 s45, s44, 64
L_k1_p_done:
    s_add_u32 s96, s6, 34676736
    s_addc_u32 s97, s7, 0
    s_mov_b32 s99, 9
    s_mov_b32 s100, s98
    s_mov_b32 s62, 0
    s_bitcmp1_b32 s2, 3
    s_cbranch_scc1 L_k1_dloop
    s_branch L_k1_ln2
L_k1_ln:
    v_lshrrev_b32 v129, 4, v0
    s_lshl_b32 s52, s51, 2
    v_add_u32 v129, s52, v129
    v_and_b32 v130, 15, v0
    v_mul_u32_u24 v131, 1152, v129
    v_lshl_add_u32 v131, v130, 3, v131
    buffer_load_dwordx2 v[136:137], v131, s[68:71], 0 offen offset:0 nt
    buffer_load_dwordx2 v[138:139], v131, s[68:71], 0 offen offset:128 nt
    buffer_load_dwordx2 v[140:141], v131, s[68:71], 0 offen offset:256 nt
    buffer_load_dwordx2 v[142:143], v131, s[68:71], 0 offen offset:384 nt
    buffer_load_dwordx2 v[144:145], v131, s[68:71], 0 offen offset:512 nt
    buffer_load_dwordx2 v[146:147], v131, s[68:71], 0 offen offset:640 nt
    buffer_load_dwordx2 v[148:149], v131, s[68:71], 0 offen offset:768 nt
    buffer_load_dwordx2 v[150:151], v131, s[68:71], 0 offen offset:896 nt
    buffer_load_dwordx2 v[152:153], v131, s[68:71], 0 offen offset:1024 nt
L_k1_ln2:
    v_lshrrev_b32 v132, 4, v129
    v_mul_u32_u24 v132, 18432, v132
    v_lshrrev_b32 v133, 1, v130
    v_lshl_add_u32 v132, v133, 8, v132
    v_and_b32 v133, 15, v129
    v_lshl_add_u32 v132, v133, 4, v132
    v_and_b32 v133, 1, v130
    v_lshl_add_u32 v132, v133, 3, v132
    s_waitcnt vmcnt(0)
    global_load_dwordx2 v[52:53], v125, s[4:5] sc1
    v_lshlrev_b32 v160, 16, v136
    v_and_b32 v161, 0xffff0000, v136
    v_lshlrev_b32 v162, 16, v137
    v_and_b32 v163, 0xffff0000, v137
    v_lshlrev_b32 v164, 16, v138
    v_and_b32 v165, 0xffff0000, v138
    v_lshlrev_b32 v166, 16, v139
    v_and_b32 v167, 0xffff0000, v139
    v_lshlrev_b32 v168, 16, v140
    v_and_b32 v169, 0xffff0000, v140
    v_lshlrev_b32 v170, 16, v141
    v_and_b32 v171, 0xffff0000, v141
    v_lshlrev_b32 v172, 16, v142
    v_and_b32 v173, 0xffff0000, v142
    v_lshlrev_b32 v174, 16, v143
    v_and_b32 v175, 0xffff0000, v143
    v_lshlrev_b32 v176, 16, v144
    v_and_b32 v177, 0xffff0000, v144
    v_lshlrev_b32 v178, 16, v145
    v_and_b32 v179, 0xffff0000, v145
    v_lshlrev_b32 v180, 16, v146
    v_and_b32 v181, 0xffff0000, v146
    v_lshlrev_b32 v182, 16, v147
    v_and_b32 v183, 0xffff0000, v147
    v_lshlrev_b32 v184, 16, v148
    v_and_b32 v185, 0xffff0000, v148
    v_lshlrev_b32 v186, 16, v149
    v_and_b32 v187, 0xffff0000, v149
    v_lshlrev_b32 v188, 16, v150
    v_and_b32 v189, 0xffff0000, v150
    v_lshlrev_b32 v190, 16, v151
    v_and_b32 v191, 0xffff0000, v151
    v_lshlrev_b32 v192, 16, v152
    v_and_b32 v193, 0xffff0000, v152
    v_lshlrev_b32 v194, 16, v153
    v_and_b32 v195, 0xffff0000, v153
    v_pk_add_f32 v[136:137], v[160:161], v[162:163]
    v_pk_add_f32 v[136:137], v[136:137], v[164:165]
    v_pk_add_f32 v[136:137], v[136:137], v[166:167]
    v_pk_add_f32 v[136:137], v[136:137], v[168:169]
    v_pk_add_f32 v[136:137], v[136:137], v[170:171]
    v_pk_add_f32 v[136:137], v[136:137], v[172:173]
    v_pk_add_f32 v[136:137], v[136:137], v[174:175]
    v_pk_add_f32 v[136:137], v[136:137], v[176:177]
    v_pk_add_f32 v[136:137], v[136:137], v[178:179]
    v_pk_add_f32 v[136:137], v[136:137], v[180:181]
    v_pk_add_f32 v[136:137], v[136:137], v[182:183]
    v_pk_add_f32 v[136:137], v[136:137], v[184:185]
    v_pk_add_f32 v[136:137], v[136:137], v[186:187]
    v_pk_add_f32 v[136:137], v[136:137], v[188:189]
    v_pk_add_f32 v[136:137], v[136:137], v[190:191]
    v_pk_add_f32 v[136:137], v[136:137], v[192:193]
    v_pk_add_f32 v[136:137], v[136:137], v[194:195]
    v_add_f32 v133, v136, v137
    s_nop 1
    v_add_f32_dpp v133, v133, v133 row_ror:8 row_mask:0xf bank_mask:0xf
    s_nop 1
    v_add_f32_dpp v133, v133, v133 row_ror:4 row_mask:0xf bank_mask:0xf
    s_nop 1
    v_add_f32_dpp v133, v133, v133 row_ror:2 row_mask:0xf bank_mask:0xf
    s_nop 1
    v_add_f32_dpp v133, v133, v133 row_ror:1 row_mask:0xf bank_mask:0xf
    v_mul_f32 v138, 0xbae38e39, v133
    v_mul_f32 v139, 0xbae38e39, v133
    v_mul_f32 v133, 0x3ae38e39, v133
    v_pk_add_f32 v[140:141], v[160:161], v[138:139]
    v_pk_mul_f32 v[136:137], v[140:141], v[140:141]
    v_pk_add_f32 v[140:141], v[162:163], v[138:139]
    v_pk_fma_f32 v[136:137], v[140:141], v[140:141], v[136:137]
    v_pk_add_f32 v[140:141], v[164:165], v[138:139]
    v_pk_fma_f32 v[136:137], v[140:141], v[140:141], v[136:137]
    v_pk_add_f32 v[140:141], v[166:167], v[138:139]
    v_pk_fma_f32 v[136:137], v[140:141], v[140:141], v[136:137]
    v_pk_add_f32 v[140:141], v[168:169], v[138:139]
    v_pk_fma_f32 v[136:137], v[140:141], v[140:141], v[136:137]
    v_pk_add_f32 v[140:141], v[170:171], v[138:139]
    v_pk_fma_f32 v[136:137], v[140:141], v[140:141], v[136:137]
    v_pk_add_f32 v[140:141], v[172:173], v[138:139]
    v_pk_fma_f32 v[136:137], v[140:141], v[140:141], v[136:137]
    v_pk_add_f32 v[140:141], v[174:175], v[138:139]
    v_pk_fma_f32 v[136:137], v[140:141], v[140:141], v[136:137]
    v_pk_add_f32 v[140:141], v[176:177], v[138:139]
    v_pk_fma_f32 v[136:137], v[140:141], v[140:141], v[136:137]
    v_pk_add_f32 v[140:141], v[178:179], v[138:139]
    v_pk_fma_f32 v[136:137], v[140:141], v[140:141], v[136:137]
    v_pk_add_f32 v[140:141], v[180:181], v[138:139]
    v_pk_fma_f32 v[136:137], v[140:141], v[140:141], v[136:137]
    v_pk_add_f32 v[140:141], v[182:183], v[138:139]
    v_pk_fma_f32 v[136:137], v[140:141], v[140:141], v[136:137]
    v_pk_add_f32 v[140:141], v[184:185], v[138:139]
    v_pk_fma_f32 v[136:137], v[140:141], v[140:141], v[136:137]
    v_pk_add_f32 v[140:141], v[186:187], v[138:139]
    v_pk_fma_f32 v[136:137], v[140:141], v[140:141], v[136:137]
    v_pk_add_f32 v[140:141], v[188:189], v[138:139]
    v_pk_fma_f32 v[136:137], v[140:141], v[140:141], v[136:137]
    v_pk_add_f32 v[140:141], v[190:191], v[138:139]
    v_pk_fma_f32 v[136:137], v[140:141], v[140:141], v[136:137]
    v_pk_add_f32 v[140:141], v[192:193], v[138:139]
    v_pk_fma_f32 v[136:137], v[140:141], v[140:141], v[136:137]
    v_pk_add_f32 v[140:141], v[194:195], v[138:139]
    v_pk_fma_f32 v[136:137], v[140:141], v[140:141], v[136:137]
    v_add_f32 v134, v136, v137
    s_nop 1
    v_add_f32_dpp v134, v134, v134 row_ror:8 row_mask:0xf bank_mask:0xf
    s_nop 1
    v_add_f32_dpp v134, v134, v134 row_ror:4 row_mask:0xf bank_mask:0xf
    s_nop 1
    v_add_f32_dpp v134, v134, v134 row_ror:2 row_mask:0xf bank_mask:0xf
    s_nop 1
    v_add_f32_dpp v134, v134, v134 row_ror:1 row_mask:0xf bank_mask:0xf
    v_mul_f32 v134, 0x3ae38e39, v134
    v_cvt_pk_bf16_f32 v133, v133, v134
    v_and_b32 v134, 0xffff0000, v133
    v_lshlrev_b32 v133, 16, v133
    v_add_f32 v134, 0x3727c5ac, v134
    v_cvt_pk_bf16_f32 v134, v134, v134
    v_and_b32 v134, 0xffff0000, v134
    v_sqrt_f32 v134, v134
    v_sub_f32 v154, 0, v133
    v_cvt_pk_bf16_f32 v134, v134, v134
    v_and_b32 v134, 0xffff0000, v134
    v_rcp_f32 v156, v134
    v_sub_f32 v155, 0, v133
    v_mov_b32 v157, v156
    v_pk_add_f32 v[160:161], v[160:161], v[154:155]
    v_cvt_pk_bf16_f32 v160, v160, v161
    v_and_b32 v161, 0xffff0000, v160
    v_lshlrev_b32 v160, 16, v160
    v_pk_mul_f32 v[160:161], v[160:161], v[156:157]
    v_cvt_pk_bf16_f32 v136, v160, v161
    v_pk_add_f32 v[162:163], v[162:163], v[154:155]
    v_cvt_pk_bf16_f32 v162, v162, v163
    v_and_b32 v163, 0xffff0000, v162
    v_lshlrev_b32 v162, 16, v162
    v_pk_mul_f32 v[162:163], v[162:163], v[156:157]
    v_cvt_pk_bf16_f32 v137, v162, v163
    s_mov_b32 s52, 0
    buffer_store_dwordx2 v[136:137], v132, s[8:11], s52 offen sc1
    v_pk_add_f32 v[164:165], v[164:165], v[154:155]
    v_cvt_pk_bf16_f32 v164, v164, v165
    v_and_b32 v165, 0xffff0000, v164
    v_lshlrev_b32 v164, 16, v164
    v_pk_mul_f32 v[164:165], v[164:165], v[156:157]
    v_cvt_pk_bf16_f32 v138, v164, v165
    v_pk_add_f32 v[166:167], v[166:167], v[154:155]
    v_cvt_pk_bf16_f32 v166, v166, v167
    v_and_b32 v167, 0xffff0000, v166
    v_lshlrev_b32 v166, 16, v166
    v_pk_mul_f32 v[166:167], v[166:167], v[156:157]
    v_cvt_pk_bf16_f32 v139, v166, v167
    s_mov_b32 s52, 2048
    buffer_store_dwordx2 v[138:139], v132, s[8:11], s52 offen sc1
    v_pk_add_f32 v[168:169], v[168:169], v[154:155]
    v_cvt_pk_bf16_f32 v168, v168, v169
    v_and_b32 v169, 0xffff0000, v168
    v_lshlrev_b32 v168, 16, v168
    v_pk_mul_f32 v[168:169], v[168:169], v[156:157]
    v_cvt_pk_bf16_f32 v140, v168, v169
    v_pk_add_f32 v[170:171], v[170:171], v[154:155]
    v_cvt_pk_bf16_f32 v170, v170, v171
    v_and_b32 v171, 0xffff0000, v170
    v_lshlrev_b32 v170, 16, v170
    v_pk_mul_f32 v[170:171], v[170:171], v[156:157]
    v_cvt_pk_bf16_f32 v141, v170, v171
    s_mov_b32 s52, 4096
    buffer_store_dwordx2 v[140:141], v132, s[8:11], s52 offen sc1
    v_pk_add_f32 v[172:173], v[172:173], v[154:155]
    v_cvt_pk_bf16_f32 v172, v172, v173
    v_and_b32 v173, 0xffff0000, v172
    v_lshlrev_b32 v172, 16, v172
    v_pk_mul_f32 v[172:173], v[172:173], v[156:157]
    v_cvt_pk_bf16_f32 v142, v172, v173
    v_pk_add_f32 v[174:175], v[174:175], v[154:155]
    v_cvt_pk_bf16_f32 v174, v174, v175
    v_and_b32 v175, 0xffff0000, v174
    v_lshlrev_b32 v174, 16, v174
    v_pk_mul_f32 v[174:175], v[174:175], v[156:157]
    v_cvt_pk_bf16_f32 v143, v174, v175
    s_mov_b32 s52, 6144
    buffer_store_dwordx2 v[142:143], v132, s[8:11], s52 offen sc1
    v_pk_add_f32 v[176:177], v[176:177], v[154:155]
    v_cvt_pk_bf16_f32 v176, v176, v177
    v_and_b32 v177, 0xffff0000, v176
    v_lshlrev_b32 v176, 16, v176
    v_pk_mul_f32 v[176:177], v[176:177], v[156:157]
    v_cvt_pk_bf16_f32 v144, v176, v177
    v_pk_add_f32 v[178:179], v[178:179], v[154:155]
    v_cvt_pk_bf16_f32 v178, v178, v179
    v_and_b32 v179, 0xffff0000, v178
    v_lshlrev_b32 v178, 16, v178
    v_pk_mul_f32 v[178:179], v[178:179], v[156:157]
    v_cvt_pk_bf16_f32 v145, v178, v179
    s_mov_b32 s52, 8192
    buffer_store_dwordx2 v[144:145], v132, s[8:11], s52 offen sc1
    v_pk_add_f32 v[180:181], v[180:181], v[154:155]
    v_cvt_pk_bf16_f32 v180, v180, v181
    v_and_b32 v181, 0xffff0000, v180
    v_lshlrev_b32 v180, 16, v180
    v_pk_mul_f32 v[180:181], v[180:181], v[156:157]
    v_cvt_pk_bf16_f32 v146, v180, v181
    v_pk_add_f32 v[182:183], v[182:183], v[154:155]
    v_cvt_pk_bf16_f32 v182, v182, v183
    v_and_b32 v183, 0xffff0000, v182
    v_lshlrev_b32 v182, 16, v182
    v_pk_mul_f32 v[182:183], v[182:183], v[156:157]
    v_cvt_pk_bf16_f32 v147, v182, v183
    s_mov_b32 s52, 10240
    buffer_store_dwordx2 v[146:147], v132, s[8:11], s52 offen sc1
    v_pk_add_f32 v[184:185], v[184:185], v[154:155]
    v_cvt_pk_bf16_f32 v184, v184, v185
    v_and_b32 v185, 0xffff0000, v184
    v_lshlrev_b32 v184, 16, v184
    v_pk_mul_f32 v[184:185], v[184:185], v[156:157]
    v_cvt_pk_bf16_f32 v148, v184, v185
    v_pk_add_f32 v[186:187], v[186:187], v[154:155]
    v_cvt_pk_bf16_f32 v186, v186, v187
    v_and_b32 v187, 0xffff0000, v186
    v_lshlrev_b32 v186, 16, v186
    v_pk_mul_f32 v[186:187], v[186:187], v[156:157]
    v_cvt_pk_bf16_f32 v149, v186, v187
    s_mov_b32 s52, 12288
    buffer_store_dwordx2 v[148:149], v132, s[8:11], s52 offen sc1
    v_pk_add_f32 v[188:189], v[188:189], v[154:155]
    v_cvt_pk_bf16_f32 v188, v188, v189
    v_and_b32 v189, 0xffff0000, v188
    v_lshlrev_b32 v188, 16, v188
    v_pk_mul_f32 v[188:189], v[188:189], v[156:157]
    v_cvt_pk_bf16_f32 v150, v188, v189
    v_pk_add_f32 v[190:191], v[190:191], v[154:155]
    v_cvt_pk_bf16_f32 v190, v190, v191
    v_and_b32 v191, 0xffff0000, v190
    v_lshlrev_b32 v190, 16, v190
    v_pk_mul_f32 v[190:191], v[190:191], v[156:157]
    v_cvt_pk_bf16_f32 v151, v190, v191
    s_mov_b32 s52, 14336
    buffer_store_dwordx2 v[150:151], v132, s[8:11], s52 offen sc1
    v_pk_add_f32 v[192:193], v[192:193], v[154:155]
    v_cvt_pk_bf16_f32 v192, v192, v193
    v_and_b32 v193, 0xffff0000, v192
    v_lshlrev_b32 v192, 16, v192
    v_pk_mul_f32 v[192:193], v[192:193], v[156:157]
    v_cvt_pk_bf16_f32 v152, v192, v193
    v_pk_add_f32 v[194:195], v[194:195], v[154:155]
    v_cvt_pk_bf16_f32 v194, v194, v195
    v_and_b32 v195, 0xffff0000, v194
    v_lshlrev_b32 v194, 16, v194
    v_pk_mul_f32 v[194:195], v[194:195], v[156:157]
    v_cvt_pk_bf16_f32 v153, v194, v195
    s_mov_b32 s52, 16384
    buffer_store_dwordx2 v[152:153], v132, s[8:11], s52 offen sc1
    s_add_u32 s51, s51, 1
    s_sub_u32 s59, s59, 1
    s_cmp_gt_u32 s59, 1
    s_cbranch_scc1 L_k1_ln
    s_cmp_eq_u32 s59, 1
    s_cbranch_scc1 L_k1_go
    s_mov_b32 s62, 9
    s_branch L_k1_pub
L_k1_dloop:
    s_mov_b32 m0, s100
    s_sub_u32 s99, s99, 1
    buffer_load_dwordx4 v11, s[16:19], s43 offen lds
    s_add_u32 m0, s100, 73728
    s_nop 0
    buffer_load_dwordx4 v9, s[32:35], s44 offen lds
    s_add_u32 m0, s100, 36864
    s_add_u32 s44, s44, s46
    buffer_load_dwordx4 v11, s[20:23], s43 offen lds
    s_add_u32 m0, s100, 110592
    s_add_u32 s43, s43, 589824
    buffer_load_dwordx4 v10, s[36:39], s45 offen lds
    s_add_u32 s45, s45, s47
    s_add_u32 s100, s100, 4096
    s_cmp_lg_u32 s99, s62
    s_cbranch_scc1 L_k1_dloop
    s_cmp_eq_u32 s62, 0
    s_cbranch_scc1 L_k1_ddone
L_k1_pub:
    s_mov_b32 s62, 0
    s_mov_b32 s53, 2000
    s_waitcnt vmcnt(0)
L_k1_npoll:
    v_cmp_ne_u32 vcc, 0, v52
    s_cbranch_vccnz L_k1_ngot
    global_load_dwordx2 v[52:53], v125, s[4:5] sc1
    s_sub_u32 s53, s53, 1
    s_waitcnt vmcnt(0)
    s_cbranch_scc0 L_k1_npoll
    s_branch L_k1_dloop
L_k1_ngot:
    s_lshl_b32 s52, s101, 6
    v_mov_b32 v123, s52
    global_store_dwordx2 v123, v[52:53], s[96:97] sc1
    s_branch L_k1_dloop
L_k1_ddone:
    s_lshl_b32 s52, s41, 12
    v_lshlrev_b32 v123, 6, v0
    v_add_u32 v48, s52, v123
    s_cmp_lg_u32 s40, 0
    s_cbranch_scc1 L_k1_nop
    global_load_dwordx2 v[52:53], v125, s[4:5] sc1
    global_load_dwordx2 v[54:55], v48, s[96:97] sc1
L_k1_nop:
    s_add_u32 s28, s6, 2359296
    s_addc_u32 s29, s7, 0
    s_mov_b32 s30, 7340032
    s_mov_b32 s31, 0x00020000
    s_add_u32 s24, s6, 9699328
    s_addc_u32 s25, s7, 0
    s_mov_b32 s26, 18874368
    s_mov_b32 s27, 0x00020000
    s_mul_i32 s51, s41, 28
    s_add_u32 s51, s51, s42
    s_mul_i32 s75, s51, 36864
    s_lshl_b32 s3, s41, 2
    s_add_u32 s3, s3, s42
    s_cmp_eq_u32 s42, 29
    s_cselect_b32 s52, 29, 28
    s_sub_u32 s3, s3, s52
    s_mul_i32 s52, s3, 20736
    s_cmp_ge_u32 s42, 28
    s_cselect_b64 s[76:77], s[80:81], s[76:77]
    s_mov_b32 s78, 5308416
    s_cmov_b32 s78, 663552
    s_cselect_b32 s75, s52, s75
    s_add_u32 s75, s75, s98
    s_mov_b32 s79, 0x00020000
    s_add_u32 s80, s6, 28573696
    s_addc_u32 s81, s7, 0
    s_mov_b32 s82, 5971968
    s_mov_b32 s83, 0x00020000
    v_lshrrev_b32 v13, 4, v0
    v_bfe_u32 v123, v0, 2, 2
    v_lshl_add_u32 v123, v13, 3, v123
    v_and_b32 v124, 3, v0
    v_lshlrev_b32 v124, 3, v124
    v_lshl_add_u32 v123, v123, 6, v124
    v_and_b32 v124, 1, v13
    v_lshl_add_u32 v1, v124, 5, v123
    v_xor_b32 v2, 32, v1
    v_add_u32 v3, 36864, v1
    v_add_u32 v5, 73728, v1
    v_add_u32 v7, 110592, v1
    v_add_u32 v4, 36864, v2
    v_add_u32 v6, 73728, v2
    v_add_u32 v8, 110592, v2
    v_mov_b32 v118, 0xbdd2d3e8
    v_and_b32 v14, 0xf0, v15
    s_sub_u32 s61, s58, 18
    s_cmp_ge_u32 s58, 18
    s_cselect_b32 s61, s61, s58
    s_mov_b32 s60, 73728
    s_cmov_b32 s60, 155648
    s_cselect_b32 s56, 1.0, 0x3eae1a93
    s_cselect_b32 s62, 2359296, 0
    s_lshl_b32 s61, s61, 3
    s_lshr_b32 s53, s60, 3
    s_mul_i32 s53, s53, s41
    s_add_u32 s62, s62, s53
    s_cmp_lg_u32 s40, 1
    s_cbranch_scc1 L_k1_nw1
    s_mul_i32 s52, s2, 19456
    s_add_u32 s52, s52, 2368512
    v_and_b32 v123, 31, v0
    v_mul_u32_u24 v123, 304, v123
    v_mov_b32 v128, 0x3f803f80
    v_mov_b32 v129, 0x3f803f80
    v_mov_b32 v130, 0x3f803f80
    v_mov_b32 v131, 0x3f803f80
    buffer_store_dwordx4 v[128:131], v123, s[28:31], s52 offen offset:288
    s_add_u32 s68, s6, 34545664
    s_addc_u32 s69, s7, 0
    s_mov_b32 s70, 131072
    s_mov_b32 s71, 0x00020000
    v_lshlrev_b32 v123, 6, v0
    s_lshl_b32 s52, s2, 12
    buffer_store_dword v125, v123, s[68:71], s52 offen
    s_waitcnt vmcnt(2)
    s_branch L_k1_bar
L_k1_nw1:
    s_cmp_lg_u32 s40, 0
    s_cbranch_scc1 L_k1_go
    s_mov_b32 s53, 2000
L_k1_fpoll:
    s_waitcnt vmcnt(0)
    v_cmp_ne_u64 vcc, v[52:53], v[54:55]
    v_cmp_eq_u32 s[100:101], 0, v52
    s_nop 1
    s_or_b64 vcc, vcc, s[100:101]
    s_cbranch_scc0 L_k1_bar
    global_load_dwordx2 v[52:53], v125, s[4:5] sc1
    global_load_dwordx2 v[54:55], v48, s[96:97] sc1
    s_sub_u32 s53, s53, 1
    s_cbranch_scc0 L_k1_fpoll
    s_lshl_b32 s51, s41, 6
    s_mov_b32 s59, 65
    s_branch L_k1_ln
L_k1_go:
    s_waitcnt vmcnt(0)
L_k1_bar:
    s_barrier
    ds_read_b64_tr_b16 v[16:17], v1 offset:0
    ds_read_b64_tr_b16 v[18:19], v1 offset:256
    ds_read_b64_tr_b16 v[24:25], v2 offset:0
    ds_read_b64_tr_b16 v[26:27], v2 offset:256
    ds_read_b64_tr_b16 v[32:33], v3 offset:0
    ds_read_b64_tr_b16 v[34:35], v3 offset:256
    ds_read_b64_tr_b16 v[40:41], v4 offset:0
    ds_read_b64_tr_b16 v[42:43], v4 offset:256
    buffer_load_dwordx4 a[0:3], v15, s[8:11], s63 offen offset:0 sc1
    buffer_load_dwordx4 a[4:7], v15, s[8:11], s55 offen offset:0 sc1
    buffer_load_dwordx4 a[8:11], v15, s[8:11], s94 offen offset:0 sc1
    buffer_load_dwordx4 a[12:15], v15, s[8:11], s95 offen offset:0 sc1
    buffer_load_dwordx4 a[16:19], v15, s[8:11], s63 offen offset:1024 sc1
    buffer_load_dwordx4 a[20:23], v15, s[8:11], s55 offen offset:1024 sc1
    buffer_load_dwordx4 a[24:27], v15, s[8:11], s94 offen offset:1024 sc1
    buffer_load_dwordx4 a[28:31], v15, s[8:11], s95 offen offset:1024 sc1
    buffer_load_dwordx4 a[32:35], v15, s[8:11], s63 offen offset:2048 sc1
    buffer_load_dwordx4 a[36:39], v15, s[8:11], s55 offen offset:2048 sc1
    buffer_load_dwordx4 a[40:43], v15, s[8:11], s94 offen offset:2048 sc1
    buffer_load_dwordx4 a[44:47], v15, s[8:11], s95 offen offset:2048 sc1
    buffer_load_dwordx4 a[48:51], v15, s[8:11], s63 offen offset:3072 sc1
    s_add_u32 s63, s63, 4096
    buffer_load_dwordx4 a[52:55], v15, s[8:11], s55 offen offset:3072 sc1
    s_add_u32 s55, s55, 4096
    buffer_load_dwordx4 a[56:59], v15, s[8:11], s94 offen offset:3072 sc1
    s_add_u32 s94, s94, 4096
    buffer_load_dwordx4 a[60:63], v15, s[8:11], s95 offen offset:3072 sc1
    s_add_u32 s95, s95, 4096
    s_lshl_b32 s52, s41, 1
    s_lshr_b32 s53, s40, 1
    s_add_u32 s52, s52, s53
    s_mul_i32 s52, s52, 36
    v_cmp_gt_u32 vcc, 36, v0
    v_add_u32 v123, s52, v0
    v_mul_u32_u24 v124, 3456, v123
    v_mul_u32_u24 v123, 9216, v123
    v_cndmask_b32 v115, v119, v123, vcc
    v_cndmask_b32 v116, v119, v124, vcc
    v_cmp_gt_u32 vcc, 24, v0
    v_lshlrev_b32 v123, 7, v0
    s_nop 0
    v_cndmask_b32 v117, v119, v123, vcc
    s_bitcmp0_b32 s40, 0
    s_cselect_b64 s[68:69], s[16:17], s[20:21]
    s_mov_b32 s70, s18
    s_mov_b32 s71, 0x00020000
    s_lshl_b32 s99, s50, 6
    s_cmp_lt_u32 s42, 28
    s_cbranch_scc1 L_k1_ts
    s_mov_b64 s[68:69], s[12:13]
    s_mov_b32 s70, s14
    v_mov_b32 v115, v116
    s_lshl_b32 s99, s42, 8
    s_sub_u32 s99, s99, 4736
    s_cmp_eq_u32 s42, 28
    s_cselect_b32 s99, 2304, s99
L_k1_ts:
    s_waitcnt vmcnt(12) lgkmcnt(4)
    v_mfma_f32_16x16x32_bf16 v[128:131], v[16:19], a[0:3], 0
    ds_read_b64_tr_b16 v[20:21], v1 offset:2048
    v_mfma_f32_16x16x32_bf16 v[132:135], v[16:19], a[4:7], 0
    buffer_load_dwordx4 a[64:67], v15, s[8:11], s63 offen offset:0 sc1
    v_mfma_f32_16x16x32_bf16 v[136:139], v[16:19], a[8:11], 0
    ds_read_b64_tr_b16 v[22:23], v1 offset:2304
    v_mfma_f32_16x16x32_bf16 v[140:143], v[16:19], a[12:15], 0
    v_mov_b32 v122, v119
    v_mfma_f32_16x16x32_bf16 v[144:147], v[24:27], a[0:3], 0
    ds_read_b64_tr_b16 v[28:29], v2 offset:2048
    v_add3_u32 v48, v13, s61, 0
    v_mfma_f32_16x16x32_bf16 v[148:151], v[24:27], a[4:7], 0
    buffer_load_dwordx4 a[68:71], v15, s[8:11], s55 offen offset:0 sc1
    v_mfma_f32_16x16x32_bf16 v[152:155], v[24:27], a[8:11], 0
    ds_read_b64_tr_b16 v[30:31], v2 offset:2304
    v_mul_u32_u24 v49, 57, v48
    v_mfma_f32_16x16x32_bf16 v[156:159], v[24:27], a[12:15], 0
    s_waitcnt lgkmcnt(4)
    v_lshrrev_b32 v49, 9, v49
    v_mfma_f32_16x16x32_bf16 v[160:163], v[32:35], a[0:3], 0
    ds_read_b64_tr_b16 v[36:37], v3 offset:2048
    v_mad_i32_i24 v50, v49, -9, v48
    v_mfma_f32_16x16x32_bf16 v[164:167], v[32:35], a[4:7], 0
    v_cmp_lt_u32 vcc, 4, v50
    v_mfma_f32_16x16x32_bf16 v[168:171], v[32:35], a[8:11], 0
    ds_read_b64_tr_b16 v[38:39], v3 offset:2304
    v_cmp_eq_u32 s[64:65], 4, v50
    v_mfma_f32_16x16x32_bf16 v[172:175], v[32:35], a[12:15], 0
    buffer_load_dwordx4 a[72:75], v15, s[8:11], s94 offen offset:0 sc1
    v_mfma_f32_16x16x32_bf16 v[176:179], v[40:43], a[0:3], 0
    ds_read_b64_tr_b16 v[44:45], v4 offset:2048
    v_subrev_u32 v51, 5, v50
    v_mfma_f32_16x16x32_bf16 v[180:183], v[40:43], a[4:7], 0
    v_lshlrev_b32 v49, 1, v49
    v_mfma_f32_16x16x32_bf16 v[184:187], v[40:43], a[8:11], 0
    ds_read_b64_tr_b16 v[46:47], v4 offset:2304
    v_cndmask_b32 v50, v50, v51, vcc
    v_mfma_f32_16x16x32_bf16 v[188:191], v[40:43], a[12:15], 0
    s_waitcnt vmcnt(11) lgkmcnt(4)
    v_cndmask_b32 v51, 0, 1, vcc
    v_mfma_f32_16x16x32_bf16 v[128:131], v[20:23], a[16:19], v[128:131]
    ds_read_b64_tr_b16 v[16:17], v1 offset:4096
    v_add_u32 v49, v49, v51
    v_mfma_f32_16x16x32_bf16 v[132:135], v[20:23], a[20:23], v[132:135]
    buffer_load_dwordx4 a[76:79], v15, s[8:11], s95 offen offset:0 sc1
    v_mfma_f32_16x16x32_bf16 v[136:139], v[20:23], a[24:27], v[136:139]
    ds_read_b64_tr_b16 v[18:19], v1 offset:4352
    v_mul_u32_u24 v49, s60, v49
    v_mfma_f32_16x16x32_bf16 v[140:143], v[20:23], a[28:31], v[140:143]
    v_add_u32 v49, v49, v14
    v_mfma_f32_16x16x32_bf16 v[144:147], v[28:31], a[16:19], v[144:147]
    ds_read_b64_tr_b16 v[24:25], v2 offset:4096
    v_cndmask_b32 v122, v122, v49, s[64:65]
    v_mfma_f32_16x16x32_bf16 v[148:151], v[28:31], a[20:23], v[148:151]
    buffer_load_dwordx4 a[80:83], v15, s[8:11], s63 offen offset:1024 sc1
    v_mfma_f32_16x16x32_bf16 v[152:155], v[28:31], a[24:27], v[152:155]
    ds_read_b64_tr_b16 v[26:27], v2 offset:4352
    v_and_b32 v51, 1, v50
    v_mfma_f32_16x16x32_bf16 v[156:159], v[28:31], a[28:31], v[156:159]
    s_waitcnt lgkmcnt(4)
    v_lshl_add_u32 v49, v51, 9, v49
    v_mfma_f32_16x16x32_bf16 v[160:163], v[36:39], a[16:19], v[160:163]
    ds_read_b64_tr_b16 v[32:33], v3 offset:4096
    v_lshrrev_b32 v51, 1, v50
    v_mfma_f32_16x16x32_bf16 v[164:167], v[36:39], a[20:23], v[164:167]
    v_lshl_add_u32 v49, v51, 3, v49
    v_mfma_f32_16x16x32_bf16 v[168:171], v[36:39], a[24:27], v[168:171]
    ds_read_b64_tr_b16 v[34:35], v3 offset:4352
    v_cndmask_b32 v120, v49, v119, s[64:65]
    v_mfma_f32_16x16x32_bf16 v[172:175], v[36:39], a[28:31], v[172:175]
    buffer_load_dwordx4 a[84:87], v15, s[8:11], s55 offen offset:1024 sc1
    v_mfma_f32_16x16x32_bf16 v[176:179], v[44:47], a[16:19], v[176:179]
    ds_read_b64_tr_b16 v[40:41], v4 offset:4096
    v_add3_u32 v48, v13, s61, 4
    v_mfma_f32_16x16x32_bf16 v[180:183], v[44:47], a[20:23], v[180:183]
    v_mul_u32_u24 v49, 57, v48
    v_mfma_f32_16x16x32_bf16 v[184:187], v[44:47], a[24:27], v[184:187]
    ds_read_b64_tr_b16 v[42:43], v4 offset:4352
    v_lshrrev_b32 v49, 9, v49
    v_mfma_f32_16x16x32_bf16 v[188:191], v[44:47], a[28:31], v[188:191]
    s_waitcnt vmcnt(10) lgkmcnt(4)
    v_mad_i32_i24 v50, v49, -9, v48
    v_mfma_f32_16x16x32_bf16 v[128:131], v[16:19], a[32:35], v[128:131]
    ds_read_b64_tr_b16 v[20:21], v5 offset:0
    v_cmp_lt_u32 vcc, 4, v50
    v_mfma_f32_16x16x32_bf16 v[132:135], v[16:19], a[36:39], v[132:135]
    buffer_load_dwordx4 a[88:91], v15, s[8:11], s94 offen offset:1024 sc1
    v_mfma_f32_16x16x32_bf16 v[136:139], v[16:19], a[40:43], v[136:139]
    ds_read_b64_tr_b16 v[22:23], v5 offset:256
    v_cmp_eq_u32 s[66:67], 4, v50
    v_mfma_f32_16x16x32_bf16 v[140:143], v[16:19], a[44:47], v[140:143]
    v_subrev_u32 v51, 5, v50
    v_mfma_f32_16x16x32_bf16 v[144:147], v[24:27], a[32:35], v[144:147]
    ds_read_b64_tr_b16 v[28:29], v6 offset:0
    v_lshlrev_b32 v49, 1, v49
    v_mfma_f32_16x16x32_bf16 v[148:151], v[24:27], a[36:39], v[148:151]
    buffer_load_dwordx4 a[92:95], v15, s[8:11], s95 offen offset:1024 sc1
    v_mfma_f32_16x16x32_bf16 v[152:155], v[24:27], a[40:43], v[152:155]
    ds_read_b64_tr_b16 v[30:31], v6 offset:256
    v_cndmask_b32 v50, v50, v51, vcc
    v_mfma_f32_16x16x32_bf16 v[156:159], v[24:27], a[44:47], v[156:159]
    s_waitcnt lgkmcnt(4)
    v_cndmask_b32 v51, 0, 1, vcc
    v_mfma_f32_16x16x32_bf16 v[160:163], v[32:35], a[32:35], v[160:163]
    ds_read_b64_tr_b16 v[36:37], v7 offset:0
    v_add_u32 v49, v49, v51
    v_mfma_f32_16x16x32_bf16 v[164:167], v[32:35], a[36:39], v[164:167]
    v_mul_u32_u24 v49, s60, v49
    v_mfma_f32_16x16x32_bf16 v[168:171], v[32:35], a[40:43], v[168:171]
    ds_read_b64_tr_b16 v[38:39], v7 offset:256
    v_add_u32 v49, v49, v14
    v_mfma_f32_16x16x32_bf16 v[172:175], v[32:35], a[44:47], v[172:175]
    buffer_load_dwordx4 a[96:99], v15, s[8:11], s63 offen offset:2048 sc1
    v_mfma_f32_16x16x32_bf16 v[176:179], v[40:43], a[32:35], v[176:179]
    ds_read_b64_tr_b16 v[44:45], v8 offset:0
    v_cndmask_b32 v122, v122, v49, s[66:67]
    v_mfma_f32_16x16x32_bf16 v[180:183], v[40:43], a[36:39], v[180:183]
    v_and_b32 v51, 1, v50
    v_mfma_f32_16x16x32_bf16 v[184:187], v[40:43], a[40:43], v[184:187]
    ds_read_b64_tr_b16 v[46:47], v8 offset:256
    v_lshl_add_u32 v49, v51, 9, v49
    v_mfma_f32_16x16x32_bf16 v[188:191], v[40:43], a[44:47], v[188:191]
    s_waitcnt lgkmcnt(4)
    v_lshrrev_b32 v51, 1, v50
    v_mfma_f32_16x16x32_bf16 v[192:195], v[20:23], a[0:3], 0
    ds_read_b64_tr_b16 v[16:17], v1 offset:6144
    v_lshl_add_u32 v49, v51, 3, v49
    v_mfma_f32_16x16x32_bf16 v[196:199], v[20:23], a[4:7], 0
    buffer_load_dwordx4 a[100:103], v15, s[8:11], s55 offen offset:2048 sc1
    v_mfma_f32_16x16x32_bf16 v[200:203], v[20:23], a[8:11], 0
    ds_read_b64_tr_b16 v[18:19], v1 offset:6400
    v_cndmask_b32 v121, v49, v119, s[66:67]
    v_mfma_f32_16x16x32_bf16 v[204:207], v[20:23], a[12:15], 0
    v_mfma_f32_16x16x32_bf16 v[208:211], v[28:31], a[0:3], 0
    ds_read_b64_tr_b16 v[24:25], v2 offset:6144
    v_mfma_f32_16x16x32_bf16 v[212:215], v[28:31], a[4:7], 0
    buffer_load_dwordx4 a[104:107], v15, s[8:11], s94 offen offset:2048 sc1
    v_mfma_f32_16x16x32_bf16 v[216:219], v[28:31], a[8:11], 0
    ds_read_b64_tr_b16 v[26:27], v2 offset:6400
    v_mfma_f32_16x16x32_bf16 v[220:223], v[28:31], a[12:15], 0
    s_waitcnt lgkmcnt(4)
    v_mfma_f32_16x16x32_bf16 v[224:227], v[36:39], a[0:3], 0
    ds_read_b64_tr_b16 v[32:33], v3 offset:6144
    v_mfma_f32_16x16x32_bf16 v[228:231], v[36:39], a[4:7], 0
    v_mfma_f32_16x16x32_bf16 v[232:235], v[36:39], a[8:11], 0
    ds_read_b64_tr_b16 v[34:35], v3 offset:6400
    v_mfma_f32_16x16x32_bf16 v[236:239], v[36:39], a[12:15], 0
    buffer_load_dwordx4 a[108:111], v15, s[8:11], s95 offen offset:2048 sc1
    v_mfma_f32_16x16x32_bf16 v[240:243], v[44:47], a[0:3], 0
    ds_read_b64_tr_b16 v[40:41], v4 offset:6144
    v_mfma_f32_16x16x32_bf16 v[244:247], v[44:47], a[4:7], 0
    v_mfma_f32_16x16x32_bf16 v[248:251], v[44:47], a[8:11], 0
    ds_read_b64_tr_b16 v[42:43], v4 offset:6400
    v_mfma_f32_16x16x32_bf16 v[252:255], v[44:47], a[12:15], 0
    s_waitcnt vmcnt(12) lgkmcnt(4)
    v_mfma_f32_16x16x32_bf16 v[128:131], v[16:19], a[48:51], v[128:131]
    ds_read_b64_tr_b16 v[20:21], v1 offset:8192
    v_mfma_f32_16x16x32_bf16 v[132:135], v[16:19], a[52:55], v[132:135]
    buffer_load_dwordx4 a[112:115], v15, s[8:11], s63 offen offset:3072 sc1
    v_mfma_f32_16x16x32_bf16 v[136:139], v[16:19], a[56:59], v[136:139]
    ds_read_b64_tr_b16 v[22:23], v1 offset:8448
    v_mfma_f32_16x16x32_bf16 v[140:143], v[16:19], a[60:63], v[140:143]
    s_add_u32 s63, s63, 4096
    v_mfma_f32_16x16x32_bf16 v[144:147], v[24:27], a[48:51], v[144:147]
    ds_read_b64_tr_b16 v[28:29], v2 offset:8192
    v_mfma_f32_16x16x32_bf16 v[148:151], v[24:27], a[52:55], v[148:151]
    buffer_load_dwordx4 a[116:119], v15, s[8:11], s55 offen offset:3072 sc1
    v_mfma_f32_16x16x32_bf16 v[152:155], v[24:27], a[56:59], v[152:155]
    ds_read_b64_tr_b16 v[30:31], v2 offset:8448
    v_mfma_f32_16x16x32_bf16 v[156:159], v[24:27], a[60:63], v[156:159]
    s_waitcnt lgkmcnt(4)
    s_add_u32 s55, s55, 4096
    v_mfma_f32_16x16x32_bf16 v[160:163], v[32:35], a[48:51], v[160:163]
    ds_read_b64_tr_b16 v[36:37], v3 offset:8192
    v_mfma_f32_16x16x32_bf16 v[164:167], v[32:35], a[52:55], v[164:167]
    v_mfma_f32_16x16x32_bf16 v[168:171], v[32:35], a[56:59], v[168:171]
    ds_read_b64_tr_b16 v[38:39], v3 offset:8448
    v_mfma_f32_16x16x32_bf16 v[172:175], v[32:35], a[60:63], v[172:175]
    buffer_load_dwordx4 a[120:123], v15, s[8:11], s94 offen offset:3072 sc1
    v_mfma_f32_16x16x32_bf16 v[176:179], v[40:43], a[48:51], v[176:179]
    ds_read_b64_tr_b16 v[44:45], v4 offset:8192
    v_mfma_f32_16x16x32_bf16 v[180:183], v[40:43], a[52:55], v[180:183]
    s_add_u32 s94, s94, 4096
    v_mfma_f32_16x16x32_bf16 v[184:187], v[40:43], a[56:59], v[184:187]
    ds_read_b64_tr_b16 v[46:47], v4 offset:8448
    v_mfma_f32_16x16x32_bf16 v[188:191], v[40:43], a[60:63], v[188:191]
    s_waitcnt vmcnt(11) lgkmcnt(4)
    v_mfma_f32_16x16x32_bf16 v[128:131], v[20:23], a[64:67], v[128:131]
    ds_read_b64_tr_b16 v[16:17], v1 offset:10240
    v_mfma_f32_16x16x32_bf16 v[132:135], v[20:23], a[68:71], v[132:135]
    buffer_load_dwordx4 a[124:127], v15, s[8:11], s95 offen offset:3072 sc1
    v_mfma_f32_16x16x32_bf16 v[136:139], v[20:23], a[72:75], v[136:139]
    ds_read_b64_tr_b16 v[18:19], v1 offset:10496
    v_mfma_f32_16x16x32_bf16 v[140:143], v[20:23], a[76:79], v[140:143]
    s_add_u32 s95, s95, 4096
    v_mfma_f32_16x16x32_bf16 v[144:147], v[28:31], a[64:67], v[144:147]
    ds_read_b64_tr_b16 v[24:25], v2 offset:10240
    v_mfma_f32_16x16x32_bf16 v[148:151], v[28:31], a[68:71], v[148:151]
    buffer_load_dwordx4 a[128:131], v15, s[8:11], s63 offen offset:0 sc1
    v_mfma_f32_16x16x32_bf16 v[152:155], v[28:31], a[72:75], v[152:155]
    ds_read_b64_tr_b16 v[26:27], v2 offset:10496
    v_mfma_f32_16x16x32_bf16 v[156:159], v[28:31], a[76:79], v[156:159]
    s_waitcnt lgkmcnt(4)
    v_mfma_f32_16x16x32_bf16 v[160:163], v[36:39], a[64:67], v[160:163]
    ds_read_b64_tr_b16 v[32:33], v3 offset:10240
    v_mfma_f32_16x16x32_bf16 v[164:167], v[36:39], a[68:71], v[164:167]
    v_mfma_f32_16x16x32_bf16 v[168:171], v[36:39], a[72:75], v[168:171]
    ds_read_b64_tr_b16 v[34:35], v3 offset:10496
    v_mfma_f32_16x16x32_bf16 v[172:175], v[36:39], a[76:79], v[172:175]
    buffer_load_dwordx4 a[132:135], v15, s[8:11], s55 offen offset:0 sc1
    v_mfma_f32_16x16x32_bf16 v[176:179], v[44:47], a[64:67], v[176:179]
    ds_read_b64_tr_b16 v[40:41], v4 offset:10240
    v_mfma_f32_16x16x32_bf16 v[180:183], v[44:47], a[68:71], v[180:183]
    v_mfma_f32_16x16x32_bf16 v[184:187], v[44:47], a[72:75], v[184:187]
    ds_read_b64_tr_b16 v[42:43], v4 offset:10496
    v_mfma_f32_16x16x32_bf16 v[188:191], v[44:47], a[76:79], v[188:191]
    s_waitcnt vmcnt(10) lgkmcnt(4)
    v_mfma_f32_16x16x32_bf16 v[128:131], v[16:19], a[80:83], v[128:131]
    ds_read_b64_tr_b16 v[20:21], v5 offset:2048
    v_mfma_f32_16x16x32_bf16 v[132:135], v[16:19], a[84:87], v[132:135]
    buffer_load_dwordx4 a[136:139], v15, s[8:11], s94 offen offset:0 sc1
    v_mfma_f32_16x16x32_bf16 v[136:139], v[16:19], a[88:91], v[136:139]
    ds_read_b64_tr_b16 v[22:23], v5 offset:2304
    v_mfma_f32_16x16x32_bf16 v[140:143], v[16:19], a[92:95], v[140:143]
    v_mfma_f32_16x16x32_bf16 v[144:147], v[24:27], a[80:83], v[144:147]
    ds_read_b64_tr_b16 v[28:29], v6 offset:2048
    v_mfma_f32_16x16x32_bf16 v[148:151], v[24:27], a[84:87], v[148:151]
    buffer_load_dwordx4 a[140:143], v15, s[8:11], s95 offen offset:0 sc1
    v_mfma_f32_16x16x32_bf16 v[152:155], v[24:27], a[88:91], v[152:155]
    ds_read_b64_tr_b16 v[30:31], v6 offset:2304
    v_mfma_f32_16x16x32_bf16 v[156:159], v[24:27], a[92:95], v[156:159]
    s_waitcnt lgkmcnt(4)
    v_mfma_f32_16x16x32_bf16 v[160:163], v[32:35], a[80:83], v[160:163]
    ds_read_b64_tr_b16 v[36:37], v7 offset:2048
    v_mfma_f32_16x16x32_bf16 v[164:167], v[32:35], a[84:87], v[164:167]
    v_mfma_f32_16x16x32_bf16 v[168:171], v[32:35], a[88:91], v[168:171]
    ds_read_b64_tr_b16 v[38:39], v7 offset:2304
    v_mfma_f32_16x16x32_bf16 v[172:175], v[32:35], a[92:95], v[172:175]
    buffer_load_dwordx4 a[144:147], v15, s[8:11], s63 offen offset:1024 sc1
    v_mfma_f32_16x16x32_bf16 v[176:179], v[40:43], a[80:83], v[176:179]
    ds_read_b64_tr_b16 v[44:45], v8 offset:2048
    v_mfma_f32_16x16x32_bf16 v[180:183], v[40:43], a[84:87], v[180:183]
    v_mfma_f32_16x16x32_bf16 v[184:187], v[40:43], a[88:91], v[184:187]
    ds_read_b64_tr_b16 v[46:47], v8 offset:2304
    v_mfma_f32_16x16x32_bf16 v[188:191], v[40:43], a[92:95], v[188:191]
    s_waitcnt lgkmcnt(4)
    v_mfma_f32_16x16x32_bf16 v[192:195], v[20:23], a[16:19], v[192:195]
    ds_read_b64_tr_b16 v[16:17], v1 offset:12288
    v_mfma_f32_16x16x32_bf16 v[196:199], v[20:23], a[20:23], v[196:199]
    buffer_load_dwordx4 a[148:151], v15, s[8:11], s55 offen offset:1024 sc1
    v_mfma_f32_16x16x32_bf16 v[200:203], v[20:23], a[24:27], v[200:203]
    ds_read_b64_tr_b16 v[18:19], v1 offset:12544
    v_mfma_f32_16x16x32_bf16 v[204:207], v[20:23], a[28:31], v[204:207]
    v_mfma_f32_16x16x32_bf16 v[208:211], v[28:31], a[16:19], v[208:211]
    ds_read_b64_tr_b16 v[24:25], v2 offset:12288
    v_mfma_f32_16x16x32_bf16 v[212:215], v[28:31], a[20:23], v[212:215]
    buffer_load_dwordx4 a[152:155], v15, s[8:11], s94 offen offset:1024 sc1
    v_mfma_f32_16x16x32_bf16 v[216:219], v[28:31], a[24:27], v[216:219]
    ds_read_b64_tr_b16 v[26:27], v2 offset:12544
    v_mfma_f32_16x16x32_bf16 v[220:223], v[28:31], a[28:31], v[220:223]
    s_waitcnt lgkmcnt(4)
    v_mfma_f32_16x16x32_bf16 v[224:227], v[36:39], a[16:19], v[224:227]
    ds_read_b64_tr_b16 v[32:33], v3 offset:12288
    v_mfma_f32_16x16x32_bf16 v[228:231], v[36:39], a[20:23], v[228:231]
    v_mfma_f32_16x16x32_bf16 v[232:235], v[36:39], a[24:27], v[232:235]
    ds_read_b64_tr_b16 v[34:35], v3 offset:12544
    v_mfma_f32_16x16x32_bf16 v[236:239], v[36:39], a[28:31], v[236:239]
    buffer_load_dwordx4 a[156:159], v15, s[8:11], s95 offen offset:1024 sc1
    v_mfma_f32_16x16x32_bf16 v[240:243], v[44:47], a[16:19], v[240:243]
    ds_read_b64_tr_b16 v[40:41], v4 offset:12288
    v_mfma_f32_16x16x32_bf16 v[244:247], v[44:47], a[20:23], v[244:247]
    v_mfma_f32_16x16x32_bf16 v[248:251], v[44:47], a[24:27], v[248:251]
    ds_read_b64_tr_b16 v[42:43], v4 offset:12544
    v_mfma_f32_16x16x32_bf16 v[252:255], v[44:47], a[28:31], v[252:255]
    s_waitcnt vmcnt(12) lgkmcnt(4)
    v_mfma_f32_16x16x32_bf16 v[128:131], v[16:19], a[96:99], v[128:131]
    ds_read_b64_tr_b16 v[20:21], v1 offset:14336
    v_mfma_f32_16x16x32_bf16 v[132:135], v[16:19], a[100:103], v[132:135]
    buffer_load_dwordx4 a[160:163], v15, s[8:11], s63 offen offset:2048 sc1
    v_mfma_f32_16x16x32_bf16 v[136:139], v[16:19], a[104:107], v[136:139]
    ds_read_b64_tr_b16 v[22:23], v1 offset:14592
    v_mfma_f32_16x16x32_bf16 v[140:143], v[16:19], a[108:111], v[140:143]
    v_mfma_f32_16x16x32_bf16 v[144:147], v[24:27], a[96:99], v[144:147]
    ds_read_b64_tr_b16 v[28:29], v2 offset:14336
    v_mfma_f32_16x16x32_bf16 v[148:151], v[24:27], a[100:103], v[148:151]
    buffer_load_dwordx4 a[164:167], v15, s[8:11], s55 offen offset:2048 sc1
    v_mfma_f32_16x16x32_bf16 v[152:155], v[24:27], a[104:107], v[152:155]
    ds_read_b64_tr_b16 v[30:31], v2 offset:14592
    v_mfma_f32_16x16x32_bf16 v[156:159], v[24:27], a[108:111], v[156:159]
    s_waitcnt lgkmcnt(4)
    v_mfma_f32_16x16x32_bf16 v[160:163], v[32:35], a[96:99], v[160:163]
    ds_read_b64_tr_b16 v[36:37], v3 offset:14336
    v_mfma_f32_16x16x32_bf16 v[164:167], v[32:35], a[100:103], v[164:167]
    v_mfma_f32_16x16x32_bf16 v[168:171], v[32:35], a[104:107], v[168:171]
    ds_read_b64_tr_b16 v[38:39], v3 offset:14592
    v_mfma_f32_16x16x32_bf16 v[172:175], v[32:35], a[108:111], v[172:175]
    buffer_load_dwordx4 a[168:171], v15, s[8:11], s94 offen offset:2048 sc1
    v_mfma_f32_16x16x32_bf16 v[176:179], v[40:43], a[96:99], v[176:179]
    ds_read_b64_tr_b16 v[44:45], v4 offset:14336
    v_mfma_f32_16x16x32_bf16 v[180:183], v[40:43], a[100:103], v[180:183]
    v_mfma_f32_16x16x32_bf16 v[184:187], v[40:43], a[104:107], v[184:187]
    ds_read_b64_tr_b16 v[46:47], v4 offset:14592
    v_mfma_f32_16x16x32_bf16 v[188:191], v[40:43], a[108:111], v[188:191]
    s_waitcnt vmcnt(11) lgkmcnt(4)
    v_mfma_f32_16x16x32_bf16 v[128:131], v[20:23], a[112:115], v[128:131]
    ds_read_b64_tr_b16 v[16:17], v1 offset:16384
    v_mfma_f32_16x16x32_bf16 v[132:135], v[20:23], a[116:119], v[132:135]
    buffer_load_dwordx4 a[172:175], v15, s[8:11], s95 offen offset:2048 sc1
    v_mfma_f32_16x16x32_bf16 v[136:139], v[20:23], a[120:123], v[136:139]
    ds_read_b64_tr_b16 v[18:19], v1 offset:16640
    v_mfma_f32_16x16x32_bf16 v[140:143], v[20:23], a[124:127], v[140:143]
    v_mfma_f32_16x16x32_bf16 v[144:147], v[28:31], a[112:115], v[144:147]
    ds_read_b64_tr_b16 v[24:25], v2 offset:16384
    v_mfma_f32_16x16x32_bf16 v[148:151], v[28:31], a[116:119], v[148:151]
    buffer_load_dwordx4 a[176:179], v15, s[8:11], s63 offen offset:3072 sc1
    v_mfma_f32_16x16x32_bf16 v[152:155], v[28:31], a[120:123], v[152:155]
    ds_read_b64_tr_b16 v[26:27], v2 offset:16640
    v_mfma_f32_16x16x32_bf16 v[156:159], v[28:31], a[124:127], v[156:159]
    s_waitcnt lgkmcnt(4)
    s_add_u32 s63, s63, 4096
    v_mfma_f32_16x16x32_bf16 v[160:163], v[36:39], a[112:115], v[160:163]
    ds_read_b64_tr_b16 v[32:33], v3 offset:16384
    v_mfma_f32_16x16x32_bf16 v[164:167], v[36:39], a[116:119], v[164:167]
    v_mfma_f32_16x16x32_bf16 v[168:171], v[36:39], a[120:123], v[168:171]
    ds_read_b64_tr_b16 v[34:35], v3 offset:16640
    v_mfma_f32_16x16x32_bf16 v[172:175], v[36:39], a[124:127], v[172:175]
    buffer_load_dwordx4 a[180:183], v15, s[8:11], s55 offen offset:3072 sc1
    v_mfma_f32_16x16x32_bf16 v[176:179], v[44:47], a[112:115], v[176:179]
    ds_read_b64_tr_b16 v[40:41], v4 offset:16384
    v_mfma_f32_16x16x32_bf16 v[180:183], v[44:47], a[116:119], v[180:183]
    s_add_u32 s55, s55, 4096
    v_mfma_f32_16x16x32_bf16 v[184:187], v[44:47], a[120:123], v[184:187]
    ds_read_b64_tr_b16 v[42:43], v4 offset:16640
    v_mfma_f32_16x16x32_bf16 v[188:191], v[44:47], a[124:127], v[188:191]
    s_waitcnt vmcnt(10) lgkmcnt(4)
    v_mfma_f32_16x16x32_bf16 v[128:131], v[16:19], a[128:131], v[128:131]
    ds_read_b64_tr_b16 v[20:21], v5 offset:4096
    v_mfma_f32_16x16x32_bf16 v[132:135], v[16:19], a[132:135], v[132:135]
    buffer_load_dwordx4 a[184:187], v15, s[8:11], s94 offen offset:3072 sc1
    v_mfma_f32_16x16x32_bf16 v[136:139], v[16:19], a[136:139], v[136:139]
    ds_read_b64_tr_b16 v[22:23], v5 offset:4352
    v_mfma_f32_16x16x32_bf16 v[140:143], v[16:19], a[140:143], v[140:143]
    s_add_u32 s94, s94, 4096
    v_mfma_f32_16x16x32_bf16 v[144:147], v[24:27], a[128:131], v[144:147]
    ds_read_b64_tr_b16 v[28:29], v6 offset:4096
    v_mfma_f32_16x16x32_bf16 v[148:151], v[24:27], a[132:135], v[148:151]
    buffer_load_dwordx4 a[188:191], v15, s[8:11], s95 offen offset:3072 sc1
    v_mfma_f32_16x16x32_bf16 v[152:155], v[24:27], a[136:139], v[152:155]
    ds_read_b64_tr_b16 v[30:31], v6 offset:4352
    v_mfma_f32_16x16x32_bf16 v[156:159], v[24:27], a[140:143], v[156:159]
    s_waitcnt lgkmcnt(4)
    s_add_u32 s95, s95, 4096
    v_mfma_f32_16x16x32_bf16 v[160:163], v[32:35], a[128:131], v[160:163]
    ds_read_b64_tr_b16 v[36:37], v7 offset:4096
    v_mfma_f32_16x16x32_bf16 v[164:167], v[32:35], a[132:135], v[164:167]
    v_mfma_f32_16x16x32_bf16 v[168:171], v[32:35], a[136:139], v[168:171]
    ds_read_b64_tr_b16 v[38:39], v7 offset:4352
    v_mfma_f32_16x16x32_bf16 v[172:175], v[32:35], a[140:143], v[172:175]
    buffer_load_dwordx4 a[192:195], v15, s[8:11], s63 offen offset:0 sc1
    v_mfma_f32_16x16x32_bf16 v[176:179], v[40:43], a[128:131], v[176:179]
    ds_read_b64_tr_b16 v[44:45], v8 offset:4096
    v_mfma_f32_16x16x32_bf16 v[180:183], v[40:43], a[132:135], v[180:183]
    v_mfma_f32_16x16x32_bf16 v[184:187], v[40:43], a[136:139], v[184:187]
    ds_read_b64_tr_b16 v[46:47], v8 offset:4352
    v_mfma_f32_16x16x32_bf16 v[188:191], v[40:43], a[140:143], v[188:191]
    s_waitcnt lgkmcnt(4)
    v_mfma_f32_16x16x32_bf16 v[192:195], v[20:23], a[32:35], v[192:195]
    ds_read_b64_tr_b16 v[16:17], v1 offset:18432
    v_mfma_f32_16x16x32_bf16 v[196:199], v[20:23], a[36:39], v[196:199]
    buffer_load_dwordx4 a[196:199], v15, s[8:11], s55 offen offset:0 sc1
    v_mfma_f32_16x16x32_bf16 v[200:203], v[20:23], a[40:43], v[200:203]
    ds_read_b64_tr_b16 v[18:19], v1 offset:18688
    v_mfma_f32_16x16x32_bf16 v[204:207], v[20:23], a[44:47], v[204:207]
    v_mfma_f32_16x16x32_bf16 v[208:211], v[28:31], a[32:35], v[208:211]
    ds_read_b64_tr_b16 v[24:25], v2 offset:18432
    v_mfma_f32_16x16x32_bf16 v[212:215], v[28:31], a[36:39], v[212:215]
    buffer_load_dwordx4 a[200:203], v15, s[8:11], s94 offen offset:0 sc1
    v_mfma_f32_16x16x32_bf16 v[216:219], v[28:31], a[40:43], v[216:219]
    ds_read_b64_tr_b16 v[26:27], v2 offset:18688
    v_mfma_f32_16x16x32_bf16 v[220:223], v[28:31], a[44:47], v[220:223]
    s_waitcnt lgkmcnt(4)
    v_mfma_f32_16x16x32_bf16 v[224:227], v[36:39], a[32:35], v[224:227]
    ds_read_b64_tr_b16 v[32:33], v3 offset:18432
    v_mfma_f32_16x16x32_bf16 v[228:231], v[36:39], a[36:39], v[228:231]
    v_mfma_f32_16x16x32_bf16 v[232:235], v[36:39], a[40:43], v[232:235]
    ds_read_b64_tr_b16 v[34:35], v3 offset:18688
    v_mfma_f32_16x16x32_bf16 v[236:239], v[36:39], a[44:47], v[236:239]
    buffer_load_dwordx4 a[204:207], v15, s[8:11], s95 offen offset:0 sc1
    v_mfma_f32_16x16x32_bf16 v[240:243], v[44:47], a[32:35], v[240:243]
    ds_read_b64_tr_b16 v[40:41], v4 offset:18432
    v_mfma_f32_16x16x32_bf16 v[244:247], v[44:47], a[36:39], v[244:247]
    v_mfma_f32_16x16x32_bf16 v[248:251], v[44:47], a[40:43], v[248:251]
    ds_read_b64_tr_b16 v[42:43], v4 offset:18688
    v_mfma_f32_16x16x32_bf16 v[252:255], v[44:47], a[44:47], v[252:255]
    s_waitcnt vmcnt(12) lgkmcnt(4)
    v_mfma_f32_16x16x32_bf16 v[128:131], v[16:19], a[144:147], v[128:131]
    ds_read_b64_tr_b16 v[20:21], v1 offset:20480
    v_mfma_f32_16x16x32_bf16 v[132:135], v[16:19], a[148:151], v[132:135]
    buffer_load_dwordx4 a[208:211], v15, s[8:11], s63 offen offset:1024 sc1
    v_mfma_f32_16x16x32_bf16 v[136:139], v[16:19], a[152:155], v[136:139]
    ds_read_b64_tr_b16 v[22:23], v1 offset:20736
    v_mfma_f32_16x16x32_bf16 v[140:143], v[16:19], a[156:159], v[140:143]
    v_mfma_f32_16x16x32_bf16 v[144:147], v[24:27], a[144:147], v[144:147]
    ds_read_b64_tr_b16 v[28:29], v2 offset:20480
    v_mfma_f32_16x16x32_bf16 v[148:151], v[24:27], a[148:151], v[148:151]
    buffer_load_dwordx4 a[212:215], v15, s[8:11], s55 offen offset:1024 sc1
    v_mfma_f32_16x16x32_bf16 v[152:155], v[24:27], a[152:155], v[152:155]
    ds_read_b64_tr_b16 v[30:31], v2 offset:20736
    v_mfma_f32_16x16x32_bf16 v[156:159], v[24:27], a[156:159], v[156:159]
    s_waitcnt lgkmcnt(4)
    v_mfma_f32_16x16x32_bf16 v[160:163], v[32:35], a[144:147], v[160:163]
    ds_read_b64_tr_b16 v[36:37], v3 offset:20480
    v_mfma_f32_16x16x32_bf16 v[164:167], v[32:35], a[148:151], v[164:167]
    v_mfma_f32_16x16x32_bf16 v[168:171], v[32:35], a[152:155], v[168:171]
    ds_read_b64_tr_b16 v[38:39], v3 offset:20736
    v_mfma_f32_16x16x32_bf16 v[172:175], v[32:35], a[156:159], v[172:175]
    buffer_load_dwordx4 a[216:219], v15, s[8:11], s94 offen offset:1024 sc1
    v_mfma_f32_16x16x32_bf16 v[176:179], v[40:43], a[144:147], v[176:179]
    ds_read_b64_tr_b16 v[44:45], v4 offset:20480
    v_mfma_f32_16x16x32_bf16 v[180:183], v[40:43], a[148:151], v[180:183]
    v_mfma_f32_16x16x32_bf16 v[184:187], v[40:43], a[152:155], v[184:187]
    ds_read_b64_tr_b16 v[46:47], v4 offset:20736
    v_mfma_f32_16x16x32_bf16 v[188:191], v[40:43], a[156:159], v[188:191]
    s_waitcnt vmcnt(11) lgkmcnt(4)
    v_mfma_f32_16x16x32_bf16 v[128:131], v[20:23], a[160:163], v[128:131]
    ds_read_b64_tr_b16 v[16:17], v1 offset:22528
    v_mfma_f32_16x16x32_bf16 v[132:135], v[20:23], a[164:167], v[132:135]
    buffer_load_dwordx4 a[220:223], v15, s[8:11], s95 offen offset:1024 sc1
    v_mfma_f32_16x16x32_bf16 v[136:139], v[20:23], a[168:171], v[136:139]
    ds_read_b64_tr_b16 v[18:19], v1 offset:22784
    v_mfma_f32_16x16x32_bf16 v[140:143], v[20:23], a[172:175], v[140:143]
    v_mfma_f32_16x16x32_bf16 v[144:147], v[28:31], a[160:163], v[144:147]
    ds_read_b64_tr_b16 v[24:25], v2 offset:22528
    v_mfma_f32_16x16x32_bf16 v[148:151], v[28:31], a[164:167], v[148:151]
    buffer_load_dwordx4 a[224:227], v15, s[8:11], s63 offen offset:2048 sc1
    v_mfma_f32_16x16x32_bf16 v[152:155], v[28:31], a[168:171], v[152:155]
    ds_read_b64_tr_b16 v[26:27], v2 offset:22784
    v_mfma_f32_16x16x32_bf16 v[156:159], v[28:31], a[172:175], v[156:159]
    s_waitcnt lgkmcnt(4)
    v_mfma_f32_16x16x32_bf16 v[160:163], v[36:39], a[160:163], v[160:163]
    ds_read_b64_tr_b16 v[32:33], v3 offset:22528
    v_mfma_f32_16x16x32_bf16 v[164:167], v[36:39], a[164:167], v[164:167]
    v_mfma_f32_16x16x32_bf16 v[168:171], v[36:39], a[168:171], v[168:171]
    ds_read_b64_tr_b16 v[34:35], v3 offset:22784
    v_mfma_f32_16x16x32_bf16 v[172:175], v[36:39], a[172:175], v[172:175]
    buffer_load_dwordx4 a[228:231], v15, s[8:11], s55 offen offset:2048 sc1
    v_mfma_f32_16x16x32_bf16 v[176:179], v[44:47], a[160:163], v[176:179]
    ds_read_b64_tr_b16 v[40:41], v4 offset:22528
    v_mfma_f32_16x16x32_bf16 v[180:183], v[44:47], a[164:167], v[180:183]
    v_mfma_f32_16x16x32_bf16 v[184:187], v[44:47], a[168:171], v[184:187]
    ds_read_b64_tr_b16 v[42:43], v4 offset:22784
    v_mfma_f32_16x16x32_bf16 v[188:191], v[44:47], a[172:175], v[188:191]
    s_waitcnt vmcnt(10) lgkmcnt(4)
    v_mfma_f32_16x16x32_bf16 v[128:131], v[16:19], a[176:179], v[128:131]
    ds_read_b64_tr_b16 v[20:21], v5 offset:6144
    v_mfma_f32_16x16x32_bf16 v[132:135], v[16:19], a[180:183], v[132:135]
    buffer_load_dwordx4 a[232:235], v15, s[8:11], s94 offen offset:2048 sc1
    v_mfma_f32_16x16x32_bf16 v[136:139], v[16:19], a[184:187], v[136:139]
    ds_read_b64_tr_b16 v[22:23], v5 offset:6400
    v_mfma_f32_16x16x32_bf16 v[140:143], v[16:19], a[188:191], v[140:143]
    v_mfma_f32_16x16x32_bf16 v[144:147], v[24:27], a[176:179], v[144:147]
    ds_read_b64_tr_b16 v[28:29], v6 offset:6144
    v_mfma_f32_16x16x32_bf16 v[148:151], v[24:27], a[180:183], v[148:151]
    buffer_load_dwordx4 a[236:239], v15, s[8:11], s95 offen offset:2048 sc1
    v_mfma_f32_16x16x32_bf16 v[152:155], v[24:27], a[184:187], v[152:155]
    ds_read_b64_tr_b16 v[30:31], v6 offset:6400
    v_mfma_f32_16x16x32_bf16 v[156:159], v[24:27], a[188:191], v[156:159]
    s_waitcnt lgkmcnt(4)
    v_mfma_f32_16x16x32_bf16 v[160:163], v[32:35], a[176:179], v[160:163]
    ds_read_b64_tr_b16 v[36:37], v7 offset:6144
    v_mfma_f32_16x16x32_bf16 v[164:167], v[32:35], a[180:183], v[164:167]
    v_mfma_f32_16x16x32_bf16 v[168:171], v[32:35], a[184:187], v[168:171]
    ds_read_b64_tr_b16 v[38:39], v7 offset:6400
    v_mfma_f32_16x16x32_bf16 v[172:175], v[32:35], a[188:191], v[172:175]
    buffer_load_dwordx4 a[240:243], v15, s[8:11], s63 offen offset:3072 sc1
    v_mfma_f32_16x16x32_bf16 v[176:179], v[40:43], a[176:179], v[176:179]
    ds_read_b64_tr_b16 v[44:45], v8 offset:6144
    v_mfma_f32_16x16x32_bf16 v[180:183], v[40:43], a[180:183], v[180:183]
    s_add_u32 s63, s63, 4096
    v_mfma_f32_16x16x32_bf16 v[184:187], v[40:43], a[184:187], v[184:187]
    ds_read_b64_tr_b16 v[46:47], v8 offset:6400
    v_mfma_f32_16x16x32_bf16 v[188:191], v[40:43], a[188:191], v[188:191]
    s_waitcnt lgkmcnt(4)
    v_mfma_f32_16x16x32_bf16 v[192:195], v[20:23], a[48:51], v[192:195]
    ds_read_b64_tr_b16 v[16:17], v1 offset:24576
    v_mfma_f32_16x16x32_bf16 v[196:199], v[20:23], a[52:55], v[196:199]
    buffer_load_dwordx4 a[244:247], v15, s[8:11], s55 offen offset:3072 sc1
    v_mfma_f32_16x16x32_bf16 v[200:203], v[20:23], a[56:59], v[200:203]
    ds_read_b64_tr_b16 v[18:19], v1 offset:24832
    v_mfma_f32_16x16x32_bf16 v[204:207], v[20:23], a[60:63], v[204:207]
    s_add_u32 s55, s55, 4096
    v_mfma_f32_16x16x32_bf16 v[208:211], v[28:31], a[48:51], v[208:211]
    ds_read_b64_tr_b16 v[24:25], v2 offset:24576
    v_mfma_f32_16x16x32_bf16 v[212:215], v[28:31], a[52:55], v[212:215]
    buffer_load_dwordx4 a[248:251], v15, s[8:11], s94 offen offset:3072 sc1
    v_mfma_f32_16x16x32_bf16 v[216:219], v[28:31], a[56:59], v[216:219]
    ds_read_b64_tr_b16 v[26:27], v2 offset:24832
    v_mfma_f32_16x16x32_bf16 v[220:223], v[28:31], a[60:63], v[220:223]
    s_waitcnt lgkmcnt(4)
    s_add_u32 s94, s94, 4096
    v_mfma_f32_16x16x32_bf16 v[224:227], v[36:39], a[48:51], v[224:227]
    ds_read_b64_tr_b16 v[32:33], v3 offset:24576
    v_mfma_f32_16x16x32_bf16 v[228:231], v[36:39], a[52:55], v[228:231]
    v_mfma_f32_16x16x32_bf16 v[232:235], v[36:39], a[56:59], v[232:235]
    ds_read_b64_tr_b16 v[34:35], v3 offset:24832
    v_mfma_f32_16x16x32_bf16 v[236:239], v[36:39], a[60:63], v[236:239]
    buffer_load_dwordx4 a[252:255], v15, s[8:11], s95 offen offset:3072 sc1
    v_mfma_f32_16x16x32_bf16 v[240:243], v[44:47], a[48:51], v[240:243]
    ds_read_b64_tr_b16 v[40:41], v4 offset:24576
    v_mfma_f32_16x16x32_bf16 v[244:247], v[44:47], a[52:55], v[244:247]
    s_add_u32 s95, s95, 4096
    v_mfma_f32_16x16x32_bf16 v[248:251], v[44:47], a[56:59], v[248:251]
    ds_read_b64_tr_b16 v[42:43], v4 offset:24832
    v_mfma_f32_16x16x32_bf16 v[252:255], v[44:47], a[60:63], v[252:255]
    s_waitcnt vmcnt(12) lgkmcnt(4)
    v_mfma_f32_16x16x32_bf16 v[128:131], v[16:19], a[192:195], v[128:131]
    ds_read_b64_tr_b16 v[20:21], v1 offset:26624
    v_mfma_f32_16x16x32_bf16 v[132:135], v[16:19], a[196:199], v[132:135]
    buffer_load_dwordx4 v[80:83], v15, s[8:11], s63 offen offset:0 sc1
    v_mfma_f32_16x16x32_bf16 v[136:139], v[16:19], a[200:203], v[136:139]
    ds_read_b64_tr_b16 v[22:23], v1 offset:26880
    v_mfma_f32_16x16x32_bf16 v[140:143], v[16:19], a[204:207], v[140:143]
    v_mfma_f32_16x16x32_bf16 v[144:147], v[24:27], a[192:195], v[144:147]
    ds_read_b64_tr_b16 v[28:29], v2 offset:26624
    v_mfma_f32_16x16x32_bf16 v[148:151], v[24:27], a[196:199], v[148:151]
    buffer_load_dwordx4 v[84:87], v15, s[8:11], s55 offen offset:0 sc1
    v_mfma_f32_16x16x32_bf16 v[152:155], v[24:27], a[200:203], v[152:155]
    ds_read_b64_tr_b16 v[30:31], v2 offset:26880
    v_mfma_f32_16x16x32_bf16 v[156:159], v[24:27], a[204:207], v[156:159]
    s_waitcnt lgkmcnt(4)
    v_mfma_f32_16x16x32_bf16 v[160:163], v[32:35], a[192:195], v[160:163]
    ds_read_b64_tr_b16 v[36:37], v3 offset:26624
    v_mfma_f32_16x16x32_bf16 v[164:167], v[32:35], a[196:199], v[164:167]
    v_mfma_f32_16x16x32_bf16 v[168:171], v[32:35], a[200:203], v[168:171]
    ds_read_b64_tr_b16 v[38:39], v3 offset:26880
    v_mfma_f32_16x16x32_bf16 v[172:175], v[32:35], a[204:207], v[172:175]
    buffer_load_dwordx4 v[88:91], v15, s[8:11], s94 offen offset:0 sc1
    v_mfma_f32_16x16x32_bf16 v[176:179], v[40:43], a[192:195], v[176:179]
    ds_read_b64_tr_b16 v[44:45], v4 offset:26624
    v_mfma_f32_16x16x32_bf16 v[180:183], v[40:43], a[196:199], v[180:183]
    v_mfma_f32_16x16x32_bf16 v[184:187], v[40:43], a[200:203], v[184:187]
    ds_read_b64_tr_b16 v[46:47], v4 offset:26880
    v_mfma_f32_16x16x32_bf16 v[188:191], v[40:43], a[204:207], v[188:191]
    s_waitcnt vmcnt(11) lgkmcnt(4)
    v_mfma_f32_16x16x32_bf16 v[128:131], v[20:23], a[208:211], v[128:131]
    ds_read_b64_tr_b16 v[16:17], v1 offset:28672
    v_mfma_f32_16x16x32_bf16 v[132:135], v[20:23], a[212:215], v[132:135]
    buffer_load_dwordx4 v[92:95], v15, s[8:11], s95 offen offset:0 sc1
    v_mfma_f32_16x16x32_bf16 v[136:139], v[20:23], a[216:219], v[136:139]
    ds_read_b64_tr_b16 v[18:19], v1 offset:28928
    v_mfma_f32_16x16x32_bf16 v[140:143], v[20:23], a[220:223], v[140:143]
    v_mfma_f32_16x16x32_bf16 v[144:147], v[28:31], a[208:211], v[144:147]
    ds_read_b64_tr_b16 v[24:25], v2 offset:28672
    v_mfma_f32_16x16x32_bf16 v[148:151], v[28:31], a[212:215], v[148:151]
    buffer_load_dwordx4 v[96:99], v15, s[8:11], s63 offen offset:1024 sc1
    v_mfma_f32_16x16x32_bf16 v[152:155], v[28:31], a[216:219], v[152:155]
    ds_read_b64_tr_b16 v[26:27], v2 offset:28928
    v_mfma_f32_16x16x32_bf16 v[156:159], v[28:31], a[220:223], v[156:159]
    s_waitcnt lgkmcnt(4)
    v_mfma_f32_16x16x32_bf16 v[160:163], v[36:39], a[208:211], v[160:163]
    ds_read_b64_tr_b16 v[32:33], v3 offset:28672
    v_mfma_f32_16x16x32_bf16 v[164:167], v[36:39], a[212:215], v[164:167]
    v_mfma_f32_16x16x32_bf16 v[168:171], v[36:39], a[216:219], v[168:171]
    ds_read_b64_tr_b16 v[34:35], v3 offset:28928
    v_mfma_f32_16x16x32_bf16 v[172:175], v[36:39], a[220:223], v[172:175]
    buffer_load_dwordx4 v[100:103], v15, s[8:11], s55 offen offset:1024 sc1
    v_mfma_f32_16x16x32_bf16 v[176:179], v[44:47], a[208:211], v[176:179]
    ds_read_b64_tr_b16 v[40:41], v4 offset:28672
    v_mfma_f32_16x16x32_bf16 v[180:183], v[44:47], a[212:215], v[180:183]
    v_mfma_f32_16x16x32_bf16 v[184:187], v[44:47], a[216:219], v[184:187]
    ds_read_b64_tr_b16 v[42:43], v4 offset:28928
    v_mfma_f32_16x16x32_bf16 v[188:191], v[44:47], a[220:223], v[188:191]
    s_waitcnt vmcnt(10) lgkmcnt(4)
    v_mfma_f32_16x16x32_bf16 v[128:131], v[16:19], a[224:227], v[128:131]
    ds_read_b64_tr_b16 v[20:21], v5 offset:8192
    v_mfma_f32_16x16x32_bf16 v[132:135], v[16:19], a[228:231], v[132:135]
    buffer_load_dwordx4 v[104:107], v15, s[8:11], s94 offen offset:1024 sc1
    v_mfma_f32_16x16x32_bf16 v[136:139], v[16:19], a[232:235], v[136:139]
    ds_read_b64_tr_b16 v[22:23], v5 offset:8448
    v_mfma_f32_16x16x32_bf16 v[140:143], v[16:19], a[236:239], v[140:143]
    v_mfma_f32_16x16x32_bf16 v[144:147], v[24:27], a[224:227], v[144:147]
    ds_read_b64_tr_b16 v[28:29], v6 offset:8192
    v_mfma_f32_16x16x32_bf16 v[148:151], v[24:27], a[228:231], v[148:151]
    buffer_load_dwordx4 v[108:111], v15, s[8:11], s95 offen offset:1024 sc1
    v_mfma_f32_16x16x32_bf16 v[152:155], v[24:27], a[232:235], v[152:155]
    ds_read_b64_tr_b16 v[30:31], v6 offset:8448
    v_mfma_f32_16x16x32_bf16 v[156:159], v[24:27], a[236:239], v[156:159]
    s_waitcnt lgkmcnt(4)
    v_mfma_f32_16x16x32_bf16 v[160:163], v[32:35], a[224:227], v[160:163]
    ds_read_b64_tr_b16 v[36:37], v7 offset:8192
    v_mfma_f32_16x16x32_bf16 v[164:167], v[32:35], a[228:231], v[164:167]
    buffer_load_dword v114, v115, s[68:71], s99 offen
    v_mfma_f32_16x16x32_bf16 v[168:171], v[32:35], a[232:235], v[168:171]
    ds_read_b64_tr_b16 v[38:39], v7 offset:8448
    v_mfma_f32_16x16x32_bf16 v[172:175], v[32:35], a[236:239], v[172:175]
    v_mfma_f32_16x16x32_bf16 v[176:179], v[40:43], a[224:227], v[176:179]
    ds_read_b64_tr_b16 v[44:45], v8 offset:8192
    v_mfma_f32_16x16x32_bf16 v[180:183], v[40:43], a[228:231], v[180:183]
    v_mfma_f32_16x16x32_bf16 v[184:187], v[40:43], a[232:235], v[184:187]
    ds_read_b64_tr_b16 v[46:47], v8 offset:8448
    v_mfma_f32_16x16x32_bf16 v[188:191], v[40:43], a[236:239], v[188:191]
    s_waitcnt lgkmcnt(4)
    v_mfma_f32_16x16x32_bf16 v[192:195], v[20:23], a[64:67], v[192:195]
    ds_read_b64_tr_b16 v[16:17], v1 offset:30720
    v_mfma_f32_16x16x32_bf16 v[196:199], v[20:23], a[68:71], v[196:199]
    v_mfma_f32_16x16x32_bf16 v[200:203], v[20:23], a[72:75], v[200:203]
    ds_read_b64_tr_b16 v[18:19], v1 offset:30976
    v_mfma_f32_16x16x32_bf16 v[204:207], v[20:23], a[76:79], v[204:207]
    v_mfma_f32_16x16x32_bf16 v[208:211], v[28:31], a[64:67], v[208:211]
    ds_read_b64_tr_b16 v[24:25], v2 offset:30720
    v_mfma_f32_16x16x32_bf16 v[212:215], v[28:31], a[68:71], v[212:215]
    v_mfma_f32_16x16x32_bf16 v[216:219], v[28:31], a[72:75], v[216:219]
    ds_read_b64_tr_b16 v[26:27], v2 offset:30976
    v_mfma_f32_16x16x32_bf16 v[220:223], v[28:31], a[76:79], v[220:223]
    s_waitcnt lgkmcnt(4)
    v_mfma_f32_16x16x32_bf16 v[224:227], v[36:39], a[64:67], v[224:227]
    ds_read_b64_tr_b16 v[32:33], v3 offset:30720
    v_mfma_f32_16x16x32_bf16 v[228:231], v[36:39], a[68:71], v[228:231]
    v_mfma_f32_16x16x32_bf16 v[232:235], v[36:39], a[72:75], v[232:235]
    ds_read_b64_tr_b16 v[34:35], v3 offset:30976
    v_mfma_f32_16x16x32_bf16 v[236:239], v[36:39], a[76:79], v[236:239]
    v_mfma_f32_16x16x32_bf16 v[240:243], v[44:47], a[64:67], v[240:243]
    ds_read_b64_tr_b16 v[40:41], v4 offset:30720
    v_mfma_f32_16x16x32_bf16 v[244:247], v[44:47], a[68:71], v[244:247]
    v_mfma_f32_16x16x32_bf16 v[248:251], v[44:47], a[72:75], v[248:251]
    ds_read_b64_tr_b16 v[42:43], v4 offset:30976
    v_mfma_f32_16x16x32_bf16 v[252:255], v[44:47], a[76:79], v[252:255]
    s_waitcnt vmcnt(9) lgkmcnt(4)
    v_mfma_f32_16x16x32_bf16 v[128:131], v[16:19], a[240:243], v[128:131]
    ds_read_b64_tr_b16 v[20:21], v1 offset:32768
    v_mfma_f32_16x16x32_bf16 v[132:135], v[16:19], a[244:247], v[132:135]
    v_mfma_f32_16x16x32_bf16 v[136:139], v[16:19], a[248:251], v[136:139]
    ds_read_b64_tr_b16 v[22:23], v1 offset:33024
    v_mfma_f32_16x16x32_bf16 v[140:143], v[16:19], a[252:255], v[140:143]
    v_mfma_f32_16x16x32_bf16 v[144:147], v[24:27], a[240:243], v[144:147]
    ds_read_b64_tr_b16 v[28:29], v2 offset:32768
    v_mfma_f32_16x16x32_bf16 v[148:151], v[24:27], a[244:247], v[148:151]
    v_mfma_f32_16x16x32_bf16 v[152:155], v[24:27], a[248:251], v[152:155]
    ds_read_b64_tr_b16 v[30:31], v2 offset:33024
    v_mfma_f32_16x16x32_bf16 v[156:159], v[24:27], a[252:255], v[156:159]
    s_waitcnt lgkmcnt(4)
    v_mfma_f32_16x16x32_bf16 v[160:163], v[32:35], a[240:243], v[160:163]
    ds_read_b64_tr_b16 v[36:37], v3 offset:32768
    v_mfma_f32_16x16x32_bf16 v[164:167], v[32:35], a[244:247], v[164:167]
    v_mfma_f32_16x16x32_bf16 v[168:171], v[32:35], a[248:251], v[168:171]
    ds_read_b64_tr_b16 v[38:39], v3 offset:33024
    v_mfma_f32_16x16x32_bf16 v[172:175], v[32:35], a[252:255], v[172:175]
    v_mfma_f32_16x16x32_bf16 v[176:179], v[40:43], a[240:243], v[176:179]
    ds_read_b64_tr_b16 v[44:45], v4 offset:32768
    v_mfma_f32_16x16x32_bf16 v[180:183], v[40:43], a[244:247], v[180:183]
    v_mfma_f32_16x16x32_bf16 v[184:187], v[40:43], a[248:251], v[184:187]
    ds_read_b64_tr_b16 v[46:47], v4 offset:33024
    v_mfma_f32_16x16x32_bf16 v[188:191], v[40:43], a[252:255], v[188:191]
    s_waitcnt vmcnt(5) lgkmcnt(4)
    v_mfma_f32_16x16x32_bf16 v[128:131], v[20:23], v[80:83], v[128:131]
    ds_read_b64_tr_b16 v[16:17], v1 offset:34816
    v_mfma_f32_16x16x32_bf16 v[132:135], v[20:23], v[84:87], v[132:135]
    v_mfma_f32_16x16x32_bf16 v[136:139], v[20:23], v[88:91], v[136:139]
    ds_read_b64_tr_b16 v[18:19], v1 offset:35072
    v_mfma_f32_16x16x32_bf16 v[140:143], v[20:23], v[92:95], v[140:143]
    v_mfma_f32_16x16x32_bf16 v[144:147], v[28:31], v[80:83], v[144:147]
    ds_read_b64_tr_b16 v[24:25], v2 offset:34816
    v_mfma_f32_16x16x32_bf16 v[148:151], v[28:31], v[84:87], v[148:151]
    v_mfma_f32_16x16x32_bf16 v[152:155], v[28:31], v[88:91], v[152:155]
    ds_read_b64_tr_b16 v[26:27], v2 offset:35072
    v_mfma_f32_16x16x32_bf16 v[156:159], v[28:31], v[92:95], v[156:159]
    s_waitcnt lgkmcnt(4)
    v_mfma_f32_16x16x32_bf16 v[160:163], v[36:39], v[80:83], v[160:163]
    ds_read_b64_tr_b16 v[32:33], v3 offset:34816
    v_mfma_f32_16x16x32_bf16 v[164:167], v[36:39], v[84:87], v[164:167]
    v_mfma_f32_16x16x32_bf16 v[168:171], v[36:39], v[88:91], v[168:171]
    ds_read_b64_tr_b16 v[34:35], v3 offset:35072
    v_mfma_f32_16x16x32_bf16 v[172:175], v[36:39], v[92:95], v[172:175]
    v_mfma_f32_16x16x32_bf16 v[176:179], v[44:47], v[80:83], v[176:179]
    ds_read_b64_tr_b16 v[40:41], v4 offset:34816
    v_mfma_f32_16x16x32_bf16 v[180:183], v[44:47], v[84:87], v[180:183]
    v_mfma_f32_16x16x32_bf16 v[184:187], v[44:47], v[88:91], v[184:187]
    ds_read_b64_tr_b16 v[42:43], v4 offset:35072
    v_mfma_f32_16x16x32_bf16 v[188:191], v[44:47], v[92:95], v[188:191]
    s_waitcnt vmcnt(1) lgkmcnt(4)
    v_mfma_f32_16x16x32_bf16 v[128:131], v[16:19], v[96:99], v[128:131]
    ds_read_b64_tr_b16 v[20:21], v5 offset:10240
    v_mfma_f32_16x16x32_bf16 v[132:135], v[16:19], v[100:103], v[132:135]
    v_mfma_f32_16x16x32_bf16 v[136:139], v[16:19], v[104:107], v[136:139]
    ds_read_b64_tr_b16 v[22:23], v5 offset:10496
    v_mfma_f32_16x16x32_bf16 v[140:143], v[16:19], v[108:111], v[140:143]
    v_mfma_f32_16x16x32_bf16 v[144:147], v[24:27], v[96:99], v[144:147]
    ds_read_b64_tr_b16 v[28:29], v6 offset:10240
    v_mfma_f32_16x16x32_bf16 v[148:151], v[24:27], v[100:103], v[148:151]
    v_mfma_f32_16x16x32_bf16 v[152:155], v[24:27], v[104:107], v[152:155]
    ds_read_b64_tr_b16 v[30:31], v6 offset:10496
    v_mfma_f32_16x16x32_bf16 v[156:159], v[24:27], v[108:111], v[156:159]
    s_waitcnt lgkmcnt(4)
    v_mfma_f32_16x16x32_bf16 v[160:163], v[32:35], v[96:99], v[160:163]
    ds_read_b64_tr_b16 v[36:37], v7 offset:10240
    v_mfma_f32_16x16x32_bf16 v[164:167], v[32:35], v[100:103], v[164:167]
    v_mfma_f32_16x16x32_bf16 v[168:171], v[32:35], v[104:107], v[168:171]
    ds_read_b64_tr_b16 v[38:39], v7 offset:10496
    v_mfma_f32_16x16x32_bf16 v[172:175], v[32:35], v[108:111], v[172:175]
    v_mfma_f32_16x16x32_bf16 v[176:179], v[40:43], v[96:99], v[176:179]
    ds_read_b64_tr_b16 v[44:45], v8 offset:10240
    v_mfma_f32_16x16x32_bf16 v[180:183], v[40:43], v[100:103], v[180:183]
    v_mfma_f32_16x16x32_bf16 v[184:187], v[40:43], v[104:107], v[184:187]
    ds_read_b64_tr_b16 v[46:47], v8 offset:10496
    v_mfma_f32_16x16x32_bf16 v[188:191], v[40:43], v[108:111], v[188:191]
    s_waitcnt lgkmcnt(4)
    v_mfma_f32_16x16x32_bf16 v[192:195], v[20:23], a[80:83], v[192:195]
    v_mfma_f32_16x16x32_bf16 v[196:199], v[20:23], a[84:87], v[196:199]
    v_mfma_f32_16x16x32_bf16 v[200:203], v[20:23], a[88:91], v[200:203]
    v_mfma_f32_16x16x32_bf16 v[204:207], v[20:23], a[92:95], v[204:207]
    s_waitcnt lgkmcnt(0)
    s_barrier
    v_mfma_f32_16x16x32_bf16 v[208:211], v[28:31], a[80:83], v[208:211]
    ds_read_b64_tr_b16 v[16:17], v5 offset:12288
    v_mfma_f32_16x16x32_bf16 v[212:215], v[28:31], a[84:87], v[212:215]
    ds_read_b64_tr_b16 v[18:19], v5 offset:12544
    v_mfma_f32_16x16x32_bf16 v[216:219], v[28:31], a[88:91], v[216:219]
    ds_read_b64_tr_b16 v[24:25], v6 offset:12288
    v_mfma_f32_16x16x32_bf16 v[220:223], v[28:31], a[92:95], v[220:223]
    ds_read_b64_tr_b16 v[26:27], v6 offset:12544
    v_mfma_f32_16x16x32_bf16 v[224:227], v[36:39], a[80:83], v[224:227]
    ds_read_b64_tr_b16 v[32:33], v7 offset:12288
    v_mfma_f32_16x16x32_bf16 v[228:231], v[36:39], a[84:87], v[228:231]
    ds_read_b64_tr_b16 v[34:35], v7 offset:12544
    v_mfma_f32_16x16x32_bf16 v[232:235], v[36:39], a[88:91], v[232:235]
    ds_read_b64_tr_b16 v[40:41], v8 offset:12288
    v_mfma_f32_16x16x32_bf16 v[236:239], v[36:39], a[92:95], v[236:239]
    ds_read_b64_tr_b16 v[42:43], v8 offset:12544
    v_mfma_f32_16x16x32_bf16 v[240:243], v[44:47], a[80:83], v[240:243]
    v_mfma_f32_16x16x32_bf16 v[244:247], v[44:47], a[84:87], v[244:247]
    v_mfma_f32_16x16x32_bf16 v[248:251], v[44:47], a[88:91], v[248:251]
    v_mfma_f32_16x16x32_bf16 v[252:255], v[44:47], a[92:95], v[252:255]
    v_swap_b32 v1, v5
    v_swap_b32 v2, v6
    v_swap_b32 v3, v7
    v_swap_b32 v4, v8
    s_xor_b32 s48, s48, s54
    s_mov_b32 s49, s73
    s_mov_b32 s73, s74
    s_cmp_ge_u32 s42, 28
    s_cbranch_scc1 L_k1_special
    s_mov_b32 s51, 0
    s_mul_i32 s101, s40, 8192
    s_add_u32 s101, s101, s75
    s_mul_i32 s44, s40, 147456
    s_lshl_b32 s52, s50, 6
    s_add_u32 s44, s44, s52
    s_mov_b32 s45, s44
    s_lshl_b32 s52, s50, 10
    s_add_u32 s74, s72, s52
    s_add_u32 s50, s50, 28
    s_lshl_b32 s99, s50, 6
    s_waitcnt lgkmcnt(4)
    v_mfma_f32_16x16x32_bf16 v[192:195], v[16:19], a[96:99], v[192:195]
    ds_read_b64_tr_b16 v[20:21], v1 offset:14336
    v_mfma_f32_16x16x32_bf16 v[196:199], v[16:19], a[100:103], v[196:199]
    v_mfma_f32_16x16x32_bf16 v[200:203], v[16:19], a[104:107], v[200:203]
    ds_read_b64_tr_b16 v[22:23], v1 offset:14592
    v_mfma_f32_16x16x32_bf16 v[204:207], v[16:19], a[108:111], v[204:207]
    s_add_u32 m0, s48, 0
    v_mfma_f32_16x16x32_bf16 v[208:211], v[24:27], a[96:99], v[208:211]
    ds_read_b64_tr_b16 v[28:29], v2 offset:14336
    v_mfma_f32_16x16x32_bf16 v[212:215], v[24:27], a[100:103], v[212:215]
    buffer_load_dwordx4 v9, s[32:35], s44 offen lds
    v_mfma_f32_16x16x32_bf16 v[216:219], v[24:27], a[104:107], v[216:219]
    ds_read_b64_tr_b16 v[30:31], v2 offset:14592
    v_mfma_f32_16x16x32_bf16 v[220:223], v[24:27], a[108:111], v[220:223]
    s_waitcnt lgkmcnt(4)
    s_add_u32 s44, s44, s46
    v_mfma_f32_16x16x32_bf16 v[224:227], v[32:35], a[96:99], v[224:227]
    ds_read_b64_tr_b16 v[36:37], v3 offset:14336
    v_mul_f32 v48, v128, v128
    v_mfma_f32_16x16x32_bf16 v[228:231], v[32:35], a[100:103], v[228:231]
    s_add_u32 m0, s48, 36864
    v_mul_f32 v49, v129, v129
    v_mul_f32 v50, v130, v130
    v_mul_f32 v51, v131, v131
    v_mfma_f32_16x16x32_bf16 v[232:235], v[32:35], a[104:107], v[232:235]
    ds_read_b64_tr_b16 v[38:39], v3 offset:14592
    v_fmaak_f32 v48, v48, v118, 0xc0135761
    v_fmaak_f32 v49, v49, v118, 0xc0135761
    v_mfma_f32_16x16x32_bf16 v[236:239], v[32:35], a[108:111], v[236:239]
    buffer_load_dwordx4 v10, s[36:39], s45 offen lds
    v_fmaak_f32 v50, v50, v118, 0xc0135761
    v_mfma_f32_16x16x32_bf16 v[240:243], v[40:43], a[96:99], v[240:243]
    ds_read_b64_tr_b16 v[44:45], v4 offset:14336
    v_fmaak_f32 v51, v51, v118, 0xc0135761
    v_mul_f32 v48, v48, v128
    v_mfma_f32_16x16x32_bf16 v[244:247], v[40:43], a[100:103], v[244:247]
    s_add_u32 s45, s45, s47
    v_exp_f32 v52, v48
    v_mul_f32 v49, v49, v129
    v_mfma_f32_16x16x32_bf16 v[248:251], v[40:43], a[104:107], v[248:251]
    ds_read_b64_tr_b16 v[46:47], v4 offset:14592
    v_mul_f32 v50, v50, v130
    v_mfma_f32_16x16x32_bf16 v[252:255], v[40:43], a[108:111], v[252:255]
    s_waitcnt lgkmcnt(4)
    s_add_u32 m0, s48, 4096
    v_exp_f32 v53, v49
    v_mfma_f32_16x16x32_bf16 v[192:195], v[20:23], a[112:115], v[192:195]
    ds_read_b64_tr_b16 v[16:17], v1 offset:16384
    v_exp_f32 v54, v50
    v_mfma_f32_16x16x32_bf16 v[196:199], v[20:23], a[116:119], v[196:199]
    buffer_load_dwordx4 v9, s[32:35], s44 offen lds
    v_mul_f32 v51, v51, v131
    v_mfma_f32_16x16x32_bf16 v[200:203], v[20:23], a[120:123], v[200:203]
    ds_read_b64_tr_b16 v[18:19], v1 offset:16640
    v_exp_f32 v55, v51
    v_mfma_f32_16x16x32_bf16 v[204:207], v[20:23], a[124:127], v[204:207]
    s_add_u32 s44, s44, s46
    v_mul_f32 v48, v128, v160
    v_mul_f32 v49, v129, v161
    v_mul_f32 v50, v130, v162
    v_mfma_f32_16x16x32_bf16 v[208:211], v[28:31], a[112:115], v[208:211]
    ds_read_b64_tr_b16 v[24:25], v2 offset:16384
    v_mul_f32 v51, v131, v163
    v_add_f32 v52, 1.0, v52
    v_mfma_f32_16x16x32_bf16 v[212:215], v[28:31], a[116:119], v[212:215]
    s_add_u32 m0, s48, 40960
    v_rcp_f32 v52, v52
    v_mfma_f32_16x16x32_bf16 v[216:219], v[28:31], a[120:123], v[216:219]
    ds_read_b64_tr_b16 v[26:27], v2 offset:16640
    v_add_f32 v53, 1.0, v53
    v_add_f32 v54, 1.0, v54
    v_mfma_f32_16x16x32_bf16 v[220:223], v[28:31], a[124:127], v[220:223]
    s_waitcnt lgkmcnt(4)
    buffer_load_dwordx4 v10, s[36:39], s45 offen lds
    v_add_f32 v55, 1.0, v55
    v_mfma_f32_16x16x32_bf16 v[224:227], v[36:39], a[112:115], v[224:227]
    ds_read_b64_tr_b16 v[32:33], v3 offset:16384
    v_rcp_f32 v53, v53
    v_mfma_f32_16x16x32_bf16 v[228:231], v[36:39], a[116:119], v[228:231]
    s_add_u32 s45, s45, s47
    v_rcp_f32 v54, v54
    v_mul_f32 v48, v48, v52
    v_mfma_f32_16x16x32_bf16 v[232:235], v[36:39], a[120:123], v[232:235]
    ds_read_b64_tr_b16 v[34:35], v3 offset:16640
    v_rcp_f32 v55, v55
    v_mfma_f32_16x16x32_bf16 v[236:239], v[36:39], a[124:127], v[236:239]
    s_add_u32 m0, s48, 8192
    v_mul_f32 v49, v49, v53
    v_mul_f32 v50, v50, v54
    v_mfma_f32_16x16x32_bf16 v[240:243], v[44:47], a[112:115], v[240:243]
    ds_read_b64_tr_b16 v[40:41], v4 offset:16384
    v_mul_f32 v51, v51, v55
    v_cvt_pk_bf16_f32 v72, v48, v49
    v_mfma_f32_16x16x32_bf16 v[244:247], v[44:47], a[116:119], v[244:247]
    buffer_load_dwordx4 v9, s[32:35], s44 offen lds
    v_cvt_pk_bf16_f32 v73, v50, v51
    v_mfma_f32_16x16x32_bf16 v[248:251], v[44:47], a[120:123], v[248:251]
    ds_read_b64_tr_b16 v[42:43], v4 offset:16640
    v_mul_f32 v56, v144, v144
    v_mul_f32 v57, v145, v145
    v_mfma_f32_16x16x32_bf16 v[252:255], v[44:47], a[124:127], v[252:255]
    s_waitcnt lgkmcnt(4)
    s_add_u32 s44, s44, s46
    v_mul_f32 v58, v146, v146
    v_mul_f32 v59, v147, v147
    v_mfma_f32_16x16x32_bf16 v[192:195], v[16:19], a[128:131], v[192:195]
    ds_read_b64_tr_b16 v[20:21], v1 offset:18432
    v_fmaak_f32 v56, v56, v118, 0xc0135761
    v_fmaak_f32 v57, v57, v118, 0xc0135761
    v_mfma_f32_16x16x32_bf16 v[196:199], v[16:19], a[132:135], v[196:199]
    s_add_u32 m0, s48, 45056
    v_fmaak_f32 v58, v58, v118, 0xc0135761
    v_fmaak_f32 v59, v59, v118, 0xc0135761
    v_mul_f32 v56, v56, v144
    v_mfma_f32_16x16x32_bf16 v[200:203], v[16:19], a[136:139], v[200:203]
    ds_read_b64_tr_b16 v[22:23], v1 offset:18688
    v_mul_f32 v57, v57, v145
    v_mfma_f32_16x16x32_bf16 v[204:207], v[16:19], a[140:143], v[204:207]
    buffer_load_dwordx4 v10, s[36:39], s45 offen lds
    v_mul_f32 v58, v58, v146
    v_mfma_f32_16x16x32_bf16 v[208:211], v[24:27], a[128:131], v[208:211]
    ds_read_b64_tr_b16 v[28:29], v2 offset:18432
    v_exp_f32 v60, v56
    v_mfma_f32_16x16x32_bf16 v[212:215], v[24:27], a[132:135], v[212:215]
    s_add_u32 s45, s45, s47
    v_exp_f32 v61, v57
    v_mul_f32 v59, v59, v147
    v_mfma_f32_16x16x32_bf16 v[216:219], v[24:27], a[136:139], v[216:219]
    ds_read_b64_tr_b16 v[30:31], v2 offset:18688
    v_exp_f32 v62, v58
    v_mfma_f32_16x16x32_bf16 v[220:223], v[24:27], a[140:143], v[220:223]
    s_waitcnt lgkmcnt(4)
    s_add_u32 m0, s48, 12288
    v_exp_f32 v63, v59
    v_mfma_f32_16x16x32_bf16 v[224:227], v[32:35], a[128:131], v[224:227]
    ds_read_b64_tr_b16 v[36:37], v3 offset:18432
    v_mul_f32 v56, v144, v176
    v_mul_f32 v57, v145, v177
    v_mfma_f32_16x16x32_bf16 v[228:231], v[32:35], a[132:135], v[228:231]
    buffer_load_dwordx4 v9, s[32:35], s44 offen lds
    v_mfma_f32_16x16x32_bf16 v[232:235], v[32:35], a[136:139], v[232:235]
    ds_read_b64_tr_b16 v[38:39], v3 offset:18688
    v_mul_f32 v58, v146, v178
    v_mul_f32 v59, v147, v179
    v_mfma_f32_16x16x32_bf16 v[236:239], v[32:35], a[140:143], v[236:239]
    s_add_u32 s44, s44, s46
    v_add_f32 v60, 1.0, v60
    v_add_f32 v61, 1.0, v61
    v_add_f32 v62, 1.0, v62
    v_mfma_f32_16x16x32_bf16 v[240:243], v[40:43], a[128:131], v[240:243]
    ds_read_b64_tr_b16 v[44:45], v4 offset:18432
    v_rcp_f32 v60, v60
    v_mfma_f32_16x16x32_bf16 v[244:247], v[40:43], a[132:135], v[244:247]
    s_add_u32 m0, s48, 49152
    v_rcp_f32 v61, v61
    v_add_f32 v63, 1.0, v63
    v_mfma_f32_16x16x32_bf16 v[248:251], v[40:43], a[136:139], v[248:251]
    ds_read_b64_tr_b16 v[46:47], v4 offset:18688
    v_rcp_f32 v62, v62
    v_mfma_f32_16x16x32_bf16 v[252:255], v[40:43], a[140:143], v[252:255]
    s_waitcnt lgkmcnt(4)
    buffer_load_dwordx4 v10, s[36:39], s45 offen lds
    v_mfma_f32_16x16x32_bf16 v[192:195], v[20:23], a[144:147], v[192:195]
    ds_read_b64_tr_b16 v[16:17], v1 offset:20480
    v_rcp_f32 v63, v63
    v_mfma_f32_16x16x32_bf16 v[196:199], v[20:23], a[148:151], v[196:199]
    s_add_u32 s45, s45, s47
    v_mul_f32 v56, v56, v60
    v_mul_f32 v57, v57, v61
    v_mul_f32 v58, v58, v62
    v_mfma_f32_16x16x32_bf16 v[200:203], v[20:23], a[152:155], v[200:203]
    ds_read_b64_tr_b16 v[18:19], v1 offset:20736
    v_mul_f32 v59, v59, v63
    v_cvt_pk_bf16_f32 v74, v56, v57
    v_mfma_f32_16x16x32_bf16 v[204:207], v[20:23], a[156:159], v[204:207]
    s_add_u32 m0, s48, 16384
    v_cvt_pk_bf16_f32 v75, v58, v59
    v_mul_f32 v64, v132, v132
    v_mul_f32 v65, v133, v133
    v_mfma_f32_16x16x32_bf16 v[208:211], v[28:31], a[144:147], v[208:211]
    ds_read_b64_tr_b16 v[24:25], v2 offset:20480
    buffer_store_dwordx4 v[72:75], v15, s[24:27], s49 offen sc1
    v_mfma_f32_16x16x32_bf16 v[212:215], v[28:31], a[148:151], v[212:215]
    buffer_load_dwordx4 v9, s[32:35], s44 offen lds
    v_mul_f32 v66, v134, v134
    v_mfma_f32_16x16x32_bf16 v[216:219], v[28:31], a[152:155], v[216:219]
    ds_read_b64_tr_b16 v[26:27], v2 offset:20736
    v_mul_f32 v67, v135, v135
    v_mfma_f32_16x16x32_bf16 v[220:223], v[28:31], a[156:159], v[220:223]
    s_waitcnt lgkmcnt(4)
    s_add_u32 s44, s44, s46
    v_fmaak_f32 v64, v64, v118, 0xc0135761
    v_fmaak_f32 v65, v65, v118, 0xc0135761
    v_mfma_f32_16x16x32_bf16 v[224:227], v[36:39], a[144:147], v[224:227]
    ds_read_b64_tr_b16 v[32:33], v3 offset:20480
    v_fmaak_f32 v66, v66, v118, 0xc0135761
    v_fmaak_f32 v67, v67, v118, 0xc0135761
    v_mfma_f32_16x16x32_bf16 v[228:231], v[36:39], a[148:151], v[228:231]
    s_add_u32 m0, s48, 53248
    v_mul_f32 v64, v64, v132
    v_mul_f32 v65, v65, v133
    v_mul_f32 v66, v66, v134
    v_mfma_f32_16x16x32_bf16 v[232:235], v[36:39], a[152:155], v[232:235]
    ds_read_b64_tr_b16 v[34:35], v3 offset:20736
    v_exp_f32 v68, v64
    v_mfma_f32_16x16x32_bf16 v[236:239], v[36:39], a[156:159], v[236:239]
    buffer_load_dwordx4 v10, s[36:39], s45 offen lds
    v_mul_f32 v67, v67, v135
    v_mfma_f32_16x16x32_bf16 v[240:243], v[44:47], a[144:147], v[240:243]
    ds_read_b64_tr_b16 v[40:41], v4 offset:20480
    v_mul_f32 v64, v132, v164
    v_mfma_f32_16x16x32_bf16 v[244:247], v[44:47], a[148:151], v[244:247]
    s_add_u32 s45, s45, s47
    v_exp_f32 v69, v65
    v_add_f32 v68, 1.0, v68
    v_mfma_f32_16x16x32_bf16 v[248:251], v[44:47], a[152:155], v[248:251]
    ds_read_b64_tr_b16 v[42:43], v4 offset:20736
    v_exp_f32 v70, v66
    v_mfma_f32_16x16x32_bf16 v[252:255], v[44:47], a[156:159], v[252:255]
    s_waitcnt lgkmcnt(4)
    s_add_u32 m0, s48, 20480
    v_exp_f32 v71, v67
    v_mfma_f32_16x16x32_bf16 v[192:195], v[16:19], a[160:163], v[192:195]
    ds_read_b64_tr_b16 v[20:21], v1 offset:22528
    v_rcp_f32 v68, v68
    v_mfma_f32_16x16x32_bf16 v[196:199], v[16:19], a[164:167], v[196:199]
    buffer_load_dwordx4 v9, s[32:35], s44 offen lds
    v_mul_f32 v65, v133, v165
    v_mfma_f32_16x16x32_bf16 v[200:203], v[16:19], a[168:171], v[200:203]
    ds_read_b64_tr_b16 v[22:23], v1 offset:22784
    v_mul_f32 v66, v134, v166
    v_mul_f32 v67, v135, v167
    v_mfma_f32_16x16x32_bf16 v[204:207], v[16:19], a[172:175], v[204:207]
    s_add_u32 s44, s44, s46
    v_add_f32 v69, 1.0, v69
    v_add_f32 v70, 1.0, v70
    v_mfma_f32_16x16x32_bf16 v[208:211], v[24:27], a[160:163], v[208:211]
    ds_read_b64_tr_b16 v[28:29], v2 offset:22528
    v_rcp_f32 v69, v69
    v_mfma_f32_16x16x32_bf16 v[212:215], v[24:27], a[164:167], v[212:215]
    s_add_u32 m0, s48, 57344
    v_rcp_f32 v70, v70
    v_add_f32 v71, 1.0, v71
    v_mfma_f32_16x16x32_bf16 v[216:219], v[24:27], a[168:171], v[216:219]
    ds_read_b64_tr_b16 v[30:31], v2 offset:22784
    v_rcp_f32 v71, v71
    v_mfma_f32_16x16x32_bf16 v[220:223], v[24:27], a[172:175], v[220:223]
    s_waitcnt lgkmcnt(4)
    buffer_load_dwordx4 v10, s[36:39], s45 offen lds
    v_mul_f32 v64, v64, v68
    v_mfma_f32_16x16x32_bf16 v[224:227], v[32:35], a[160:163], v[224:227]
    ds_read_b64_tr_b16 v[36:37], v3 offset:22528
    v_mul_f32 v65, v65, v69
    v_mul_f32 v66, v66, v70
    v_mfma_f32_16x16x32_bf16 v[228:231], v[32:35], a[164:167], v[228:231]
    s_add_u32 s45, s45, s47
    v_mul_f32 v67, v67, v71
    v_cvt_pk_bf16_f32 v76, v64, v65
    v_mul_f32 v48, v148, v148
    v_mfma_f32_16x16x32_bf16 v[232:235], v[32:35], a[168:171], v[232:235]
    ds_read_b64_tr_b16 v[38:39], v3 offset:22784
    v_cvt_pk_bf16_f32 v77, v66, v67
    v_mfma_f32_16x16x32_bf16 v[236:239], v[32:35], a[172:175], v[236:239]
    s_add_u32 m0, s48, 24576
    v_mul_f32 v49, v149, v149
    v_mul_f32 v50, v150, v150
    v_mul_f32 v51, v151, v151
    v_mfma_f32_16x16x32_bf16 v[240:243], v[40:43], a[160:163], v[240:243]
    ds_read_b64_tr_b16 v[44:45], v4 offset:22528
    v_fmaak_f32 v48, v48, v118, 0xc0135761
    v_fmaak_f32 v49, v49, v118, 0xc0135761
    v_mfma_f32_16x16x32_bf16 v[244:247], v[40:43], a[164:167], v[244:247]
    buffer_load_dwordx4 v9, s[32:35], s44 offen lds
    v_fmaak_f32 v50, v50, v118, 0xc0135761
    v_mfma_f32_16x16x32_bf16 v[248:251], v[40:43], a[168:171], v[248:251]
    ds_read_b64_tr_b16 v[46:47], v4 offset:22784
    v_fmaak_f32 v51, v51, v118, 0xc0135761
    v_mul_f32 v48, v48, v148
    v_mfma_f32_16x16x32_bf16 v[252:255], v[40:43], a[172:175], v[252:255]
    s_waitcnt lgkmcnt(4)
    s_add_u32 s44, s44, s46
    v_exp_f32 v52, v48
    v_mfma_f32_16x16x32_bf16 v[192:195], v[20:23], a[176:179], v[192:195]
    ds_read_b64_tr_b16 v[16:17], v1 offset:24576
    v_mul_f32 v49, v49, v149
    v_mfma_f32_16x16x32_bf16 v[196:199], v[20:23], a[180:183], v[196:199]
    s_add_u32 m0, s48, 61440
    v_exp_f32 v53, v49
    v_mul_f32 v50, v50, v150
    v_mfma_f32_16x16x32_bf16 v[200:203], v[20:23], a[184:187], v[200:203]
    ds_read_b64_tr_b16 v[18:19], v1 offset:24832
    v_exp_f32 v54, v50
    v_mfma_f32_16x16x32_bf16 v[204:207], v[20:23], a[188:191], v[204:207]
    buffer_load_dwordx4 v10, s[36:39], s45 offen lds
    v_mul_f32 v51, v51, v151
    v_mfma_f32_16x16x32_bf16 v[208:211], v[28:31], a[176:179], v[208:211]
    ds_read_b64_tr_b16 v[24:25], v2 offset:24576
    v_exp_f32 v55, v51
    v_mfma_f32_16x16x32_bf16 v[212:215], v[28:31], a[180:183], v[212:215]
    s_add_u32 s45, s45, s47
    v_mul_f32 v48, v148, v180
    v_mul_f32 v49, v149, v181
    v_mul_f32 v50, v150, v182
    v_mfma_f32_16x16x32_bf16 v[216:219], v[28:31], a[184:187], v[216:219]
    ds_read_b64_tr_b16 v[26:27], v2 offset:24832
    v_mul_f32 v51, v151, v183
    v_add_f32 v52, 1.0, v52
    v_mfma_f32_16x16x32_bf16 v[220:223], v[28:31], a[188:191], v[220:223]
    s_waitcnt lgkmcnt(4)
    s_add_u32 m0, s48, 28672
    v_add_f32 v53, 1.0, v53
    v_mfma_f32_16x16x32_bf16 v[224:227], v[36:39], a[176:179], v[224:227]
    ds_read_b64_tr_b16 v[32:33], v3 offset:24576
    v_rcp_f32 v52, v52
    v_mfma_f32_16x16x32_bf16 v[228:231], v[36:39], a[180:183], v[228:231]
    buffer_load_dwordx4 v9, s[32:35], s44 offen lds
    v_add_f32 v54, 1.0, v54
    v_mfma_f32_16x16x32_bf16 v[232:235], v[36:39], a[184:187], v[232:235]
    ds_read_b64_tr_b16 v[34:35], v3 offset:24832
    v_rcp_f32 v53, v53
    v_mfma_f32_16x16x32_bf16 v[236:239], v[36:39], a[188:191], v[236:239]
    s_add_u32 s44, s44, s46
    v_rcp_f32 v54, v54
    v_add_f32 v55, 1.0, v55
    v_mfma_f32_16x16x32_bf16 v[240:243], v[44:47], a[176:179], v[240:243]
    ds_read_b64_tr_b16 v[40:41], v4 offset:24576
    v_rcp_f32 v55, v55
    v_mfma_f32_16x16x32_bf16 v[244:247], v[44:47], a[180:183], v[244:247]
    s_add_u32 m0, s48, 65536
    v_mul_f32 v48, v48, v52
    v_mul_f32 v49, v49, v53
    v_mfma_f32_16x16x32_bf16 v[248:251], v[44:47], a[184:187], v[248:251]
    ds_read_b64_tr_b16 v[42:43], v4 offset:24832
    v_mul_f32 v50, v50, v54
    v_mul_f32 v51, v51, v55
    v_mfma_f32_16x16x32_bf16 v[252:255], v[44:47], a[188:191], v[252:255]
    s_waitcnt lgkmcnt(4)
    buffer_load_dwordx4 v10, s[36:39], s45 offen lds
    v_cvt_pk_bf16_f32 v78, v48, v49
    v_mfma_f32_16x16x32_bf16 v[192:195], v[16:19], a[192:195], v[192:195]
    ds_read_b64_tr_b16 v[20:21], v1 offset:26624
    v_cvt_pk_bf16_f32 v79, v50, v51
    s_add_u32 s52, s49, 147456
    v_mfma_f32_16x16x32_bf16 v[196:199], v[16:19], a[196:199], v[196:199]
    s_add_u32 s45, s45, s47
    buffer_store_dwordx4 v[76:79], v15, s[24:27], s52 offen sc1
    v_mul_f32 v56, v136, v136
    v_mfma_f32_16x16x32_bf16 v[200:203], v[16:19], a[200:203], v[200:203]
    ds_read_b64_tr_b16 v[22:23], v1 offset:26880
    v_mul_f32 v57, v137, v137
    v_mul_f32 v58, v138, v138
    v_mfma_f32_16x16x32_bf16 v[204:207], v[16:19], a[204:207], v[204:207]
    s_add_u32 m0, s48, 32768
    v_mul_f32 v59, v139, v139
    v_fmaak_f32 v56, v56, v118, 0xc0135761
    v_fmaak_f32 v57, v57, v118, 0xc0135761
    v_mfma_f32_16x16x32_bf16 v[208:211], v[24:27], a[192:195], v[208:211]
    ds_read_b64_tr_b16 v[28:29], v2 offset:26624
    v_fmaak_f32 v58, v58, v118, 0xc0135761
    v_mfma_f32_16x16x32_bf16 v[212:215], v[24:27], a[196:199], v[212:215]
    buffer_load_dwordx4 v9, s[32:35], s44 offen lds
    v_fmaak_f32 v59, v59, v118, 0xc0135761
    v_mfma_f32_16x16x32_bf16 v[216:219], v[24:27], a[200:203], v[216:219]
    ds_read_b64_tr_b16 v[30:31], v2 offset:26880
    v_mul_f32 v56, v56, v136
    v_mul_f32 v57, v57, v137
    v_mfma_f32_16x16x32_bf16 v[220:223], v[24:27], a[204:207], v[220:223]
    s_waitcnt lgkmcnt(4)
    s_add_u32 s44, s44, s46
    v_exp_f32 v60, v56
    v_mfma_f32_16x16x32_bf16 v[224:227], v[32:35], a[192:195], v[224:227]
    ds_read_b64_tr_b16 v[36:37], v3 offset:26624
    v_exp_f32 v61, v57
    v_mfma_f32_16x16x32_bf16 v[228:231], v[32:35], a[196:199], v[228:231]
    s_add_u32 m0, s48, 69632
    v_mul_f32 v58, v58, v138
    v_mul_f32 v59, v59, v139
    v_mul_f32 v56, v136, v168
    v_mfma_f32_16x16x32_bf16 v[232:235], v[32:35], a[200:203], v[232:235]
    ds_read_b64_tr_b16 v[38:39], v3 offset:26880
    v_exp_f32 v62, v58
    v_mfma_f32_16x16x32_bf16 v[236:239], v[32:35], a[204:207], v[236:239]
    buffer_load_dwordx4 v10, s[36:39], s45 offen lds
    v_mfma_f32_16x16x32_bf16 v[240:243], v[40:43], a[192:195], v[240:243]
    ds_read_b64_tr_b16 v[44:45], v4 offset:26624
    v_exp_f32 v63, v59
    v_mfma_f32_16x16x32_bf16 v[244:247], v[40:43], a[196:199], v[244:247]
    s_add_u32 s45, s45, s47
    v_mul_f32 v57, v137, v169
    v_mul_f32 v58, v138, v170
    v_mul_f32 v59, v139, v171
    v_mfma_f32_16x16x32_bf16 v[248:251], v[40:43], a[200:203], v[248:251]
    ds_read_b64_tr_b16 v[46:47], v4 offset:26880
    v_add_f32 v60, 1.0, v60
    v_add_f32 v61, 1.0, v61
    v_mfma_f32_16x16x32_bf16 v[252:255], v[40:43], a[204:207], v[252:255]
    s_waitcnt lgkmcnt(4)
    v_rcp_f32 v60, v60
    v_add_f32 v62, 1.0, v62
    v_mfma_f32_16x16x32_bf16 v[192:195], v[20:23], a[208:211], v[192:195]
    ds_read_b64_tr_b16 v[16:17], v1 offset:28672
    v_rcp_f32 v61, v61
    v_mfma_f32_16x16x32_bf16 v[196:199], v[20:23], a[212:215], v[196:199]
    buffer_load_dword v114, v115, s[68:71], s99 offen
    v_mfma_f32_16x16x32_bf16 v[200:203], v[20:23], a[216:219], v[200:203]
    ds_read_b64_tr_b16 v[18:19], v1 offset:28928
    v_rcp_f32 v62, v62
    v_mfma_f32_16x16x32_bf16 v[204:207], v[20:23], a[220:223], v[204:207]
    buffer_load_dword v114, v117, s[76:79], s101 offen
    v_add_f32 v63, 1.0, v63
    v_mfma_f32_16x16x32_bf16 v[208:211], v[28:31], a[208:211], v[208:211]
    ds_read_b64_tr_b16 v[24:25], v2 offset:28672
    v_rcp_f32 v63, v63
    v_mfma_f32_16x16x32_bf16 v[212:215], v[28:31], a[212:215], v[212:215]
    v_mul_f32 v56, v56, v60
    v_mul_f32 v57, v57, v61
    v_mul_f32 v58, v58, v62
    v_mfma_f32_16x16x32_bf16 v[216:219], v[28:31], a[216:219], v[216:219]
    ds_read_b64_tr_b16 v[26:27], v2 offset:28928
    v_mul_f32 v59, v59, v63
    v_cvt_pk_bf16_f32 v72, v56, v57
    v_mfma_f32_16x16x32_bf16 v[220:223], v[28:31], a[220:223], v[220:223]
    s_waitcnt lgkmcnt(4)
    s_add_u32 s101, s101, 3072
    v_cvt_pk_bf16_f32 v73, v58, v59
    v_mul_f32 v64, v152, v152
    v_mfma_f32_16x16x32_bf16 v[224:227], v[36:39], a[208:211], v[224:227]
    ds_read_b64_tr_b16 v[32:33], v3 offset:28672
    v_mul_f32 v65, v153, v153
    v_mfma_f32_16x16x32_bf16 v[228:231], v[36:39], a[212:215], v[228:231]
    v_mul_f32 v66, v154, v154
    v_mul_f32 v67, v155, v155
    v_fmaak_f32 v64, v64, v118, 0xc0135761
    v_mfma_f32_16x16x32_bf16 v[232:235], v[36:39], a[216:219], v[232:235]
    ds_read_b64_tr_b16 v[34:35], v3 offset:28928
    v_fmaak_f32 v65, v65, v118, 0xc0135761
    v_fmaak_f32 v66, v66, v118, 0xc0135761
    v_mfma_f32_16x16x32_bf16 v[236:239], v[36:39], a[220:223], v[236:239]
    v_fmaak_f32 v67, v67, v118, 0xc0135761
    v_mul_f32 v64, v64, v152
    v_mul_f32 v65, v65, v153
    v_mfma_f32_16x16x32_bf16 v[240:243], v[44:47], a[208:211], v[240:243]
    ds_read_b64_tr_b16 v[40:41], v4 offset:28672
    v_exp_f32 v68, v64
    v_mfma_f32_16x16x32_bf16 v[244:247], v[44:47], a[212:215], v[244:247]
    v_exp_f32 v69, v65
    v_mul_f32 v66, v66, v154
    v_mfma_f32_16x16x32_bf16 v[248:251], v[44:47], a[216:219], v[248:251]
    ds_read_b64_tr_b16 v[42:43], v4 offset:28928
    v_mul_f32 v67, v67, v155
    v_mfma_f32_16x16x32_bf16 v[252:255], v[44:47], a[220:223], v[252:255]
    s_waitcnt lgkmcnt(4)
    v_exp_f32 v70, v66
    v_mul_f32 v64, v152, v184
    v_mfma_f32_16x16x32_bf16 v[192:195], v[16:19], a[224:227], v[192:195]
    ds_read_b64_tr_b16 v[20:21], v1 offset:30720
    v_exp_f32 v71, v67
    v_mfma_f32_16x16x32_bf16 v[196:199], v[16:19], a[228:231], v[196:199]
    v_mul_f32 v65, v153, v185
    v_mul_f32 v66, v154, v186
    v_mul_f32 v67, v155, v187
    v_mfma_f32_16x16x32_bf16 v[200:203], v[16:19], a[232:235], v[200:203]
    ds_read_b64_tr_b16 v[22:23], v1 offset:30976
    v_add_f32 v68, 1.0, v68
    v_add_f32 v69, 1.0, v69
    v_mfma_f32_16x16x32_bf16 v[204:207], v[16:19], a[236:239], v[204:207]
    v_rcp_f32 v68, v68
    v_add_f32 v70, 1.0, v70
    v_mfma_f32_16x16x32_bf16 v[208:211], v[24:27], a[224:227], v[208:211]
    ds_read_b64_tr_b16 v[28:29], v2 offset:30720
    v_rcp_f32 v69, v69
    v_mfma_f32_16x16x32_bf16 v[212:215], v[24:27], a[228:231], v[212:215]
    v_rcp_f32 v70, v70
    v_mfma_f32_16x16x32_bf16 v[216:219], v[24:27], a[232:235], v[216:219]
    ds_read_b64_tr_b16 v[30:31], v2 offset:30976
    v_add_f32 v71, 1.0, v71
    v_mul_f32 v64, v64, v68
    v_mfma_f32_16x16x32_bf16 v[220:223], v[24:27], a[236:239], v[220:223]
    s_waitcnt lgkmcnt(4)
    v_rcp_f32 v71, v71
    v_mul_f32 v65, v65, v69
    v_mfma_f32_16x16x32_bf16 v[224:227], v[32:35], a[224:227], v[224:227]
    ds_read_b64_tr_b16 v[36:37], v3 offset:30720
    v_mul_f32 v66, v66, v70
    v_mul_f32 v67, v67, v71
    v_mfma_f32_16x16x32_bf16 v[228:231], v[32:35], a[228:231], v[228:231]
    v_cvt_pk_bf16_f32 v74, v64, v65
    v_cvt_pk_bf16_f32 v75, v66, v67
    s_add_u32 s52, s49, 294912
    v_mfma_f32_16x16x32_bf16 v[232:235], v[32:35], a[232:235], v[232:235]
    ds_read_b64_tr_b16 v[38:39], v3 offset:30976
    buffer_store_dwordx4 v[72:75], v15, s[24:27], s52 offen sc1
    v_mfma_f32_16x16x32_bf16 v[236:239], v[32:35], a[236:239], v[236:239]
    v_mul_f32 v48, v140, v140
    v_mul_f32 v49, v141, v141
    v_mul_f32 v50, v142, v142
    v_mfma_f32_16x16x32_bf16 v[240:243], v[40:43], a[224:227], v[240:243]
    ds_read_b64_tr_b16 v[44:45], v4 offset:30720
    v_mul_f32 v51, v143, v143
    v_mfma_f32_16x16x32_bf16 v[244:247], v[40:43], a[228:231], v[244:247]
    v_fmaak_f32 v48, v48, v118, 0xc0135761
    v_fmaak_f32 v49, v49, v118, 0xc0135761
    v_fmaak_f32 v50, v50, v118, 0xc0135761
    v_mfma_f32_16x16x32_bf16 v[248:251], v[40:43], a[232:235], v[248:251]
    ds_read_b64_tr_b16 v[46:47], v4 offset:30976
    v_fmaak_f32 v51, v51, v118, 0xc0135761
    v_mul_f32 v48, v48, v140
    v_mfma_f32_16x16x32_bf16 v[252:255], v[40:43], a[236:239], v[252:255]
    s_waitcnt lgkmcnt(4)
    v_exp_f32 v52, v48
    v_mul_f32 v49, v49, v141
    v_mfma_f32_16x16x32_bf16 v[192:195], v[20:23], a[240:243], v[192:195]
    ds_read_b64_tr_b16 v[16:17], v1 offset:32768
    v_exp_f32 v53, v49
    v_mfma_f32_16x16x32_bf16 v[196:199], v[20:23], a[244:247], v[196:199]
    v_mul_f32 v50, v50, v142
    v_mul_f32 v51, v51, v143
    v_mul_f32 v48, v140, v172
    v_mfma_f32_16x16x32_bf16 v[200:203], v[20:23], a[248:251], v[200:203]
    ds_read_b64_tr_b16 v[18:19], v1 offset:33024
    v_mul_f32 v49, v141, v173
    v_mfma_f32_16x16x32_bf16 v[204:207], v[20:23], a[252:255], v[204:207]
    v_exp_f32 v54, v50
    v_add_f32 v52, 1.0, v52
    v_mfma_f32_16x16x32_bf16 v[208:211], v[28:31], a[240:243], v[208:211]
    ds_read_b64_tr_b16 v[24:25], v2 offset:32768
    v_exp_f32 v55, v51
    v_mfma_f32_16x16x32_bf16 v[212:215], v[28:31], a[244:247], v[212:215]
    v_rcp_f32 v52, v52
    v_mul_f32 v50, v142, v174
    v_mfma_f32_16x16x32_bf16 v[216:219], v[28:31], a[248:251], v[216:219]
    ds_read_b64_tr_b16 v[26:27], v2 offset:33024
    v_mul_f32 v51, v143, v175
    v_add_f32 v53, 1.0, v53
    v_mfma_f32_16x16x32_bf16 v[220:223], v[28:31], a[252:255], v[220:223]
    s_waitcnt lgkmcnt(4)
    v_rcp_f32 v53, v53
    v_add_f32 v54, 1.0, v54
    v_mfma_f32_16x16x32_bf16 v[224:227], v[36:39], a[240:243], v[224:227]
    ds_read_b64_tr_b16 v[32:33], v3 offset:32768
    v_rcp_f32 v54, v54
    v_mfma_f32_16x16x32_bf16 v[228:231], v[36:39], a[244:247], v[228:231]
    v_add_f32 v55, 1.0, v55
    v_mul_f32 v48, v48, v52
    v_mfma_f32_16x16x32_bf16 v[232:235], v[36:39], a[248:251], v[232:235]
    ds_read_b64_tr_b16 v[34:35], v3 offset:33024
    v_rcp_f32 v55, v55
    v_mfma_f32_16x16x32_bf16 v[236:239], v[36:39], a[252:255], v[236:239]
    v_mul_f32 v49, v49, v53
    v_mul_f32 v50, v50, v54
    v_mul_f32 v51, v51, v55
    v_mfma_f32_16x16x32_bf16 v[240:243], v[44:47], a[240:243], v[240:243]
    ds_read_b64_tr_b16 v[40:41], v4 offset:32768
    v_cvt_pk_bf16_f32 v76, v48, v49
    v_cvt_pk_bf16_f32 v77, v50, v51
    v_mfma_f32_16x16x32_bf16 v[244:247], v[44:47], a[244:247], v[244:247]
    v_mul_f32 v56, v156, v156
    v_mul_f32 v57, v157, v157
    v_mul_f32 v58, v158, v158
    v_mfma_f32_16x16x32_bf16 v[248:251], v[44:47], a[248:251], v[248:251]
    ds_read_b64_tr_b16 v[42:43], v4 offset:33024
    v_mul_f32 v59, v159, v159
    v_fmaak_f32 v56, v56, v118, 0xc0135761
    v_mfma_f32_16x16x32_bf16 v[252:255], v[44:47], a[252:255], v[252:255]
    s_waitcnt lgkmcnt(4)
    v_fmaak_f32 v57, v57, v118, 0xc0135761
    v_fmaak_f32 v58, v58, v118, 0xc0135761
    v_mfma_f32_16x16x32_bf16 v[192:195], v[16:19], v[80:83], v[192:195]
    ds_read_b64_tr_b16 v[20:21], v1 offset:34816
    v_fmaak_f32 v59, v59, v118, 0xc0135761
    v_mul_f32 v56, v56, v156
    v_mfma_f32_16x16x32_bf16 v[196:199], v[16:19], v[84:87], v[196:199]
    v_exp_f32 v60, v56
    v_mul_f32 v57, v57, v157
    v_mfma_f32_16x16x32_bf16 v[200:203], v[16:19], v[88:91], v[200:203]
    ds_read_b64_tr_b16 v[22:23], v1 offset:35072
    v_exp_f32 v61, v57
    v_mfma_f32_16x16x32_bf16 v[204:207], v[16:19], v[92:95], v[204:207]
    v_mul_f32 v58, v58, v158
    v_mul_f32 v59, v59, v159
    v_mul_f32 v56, v156, v188
    v_mfma_f32_16x16x32_bf16 v[208:211], v[24:27], v[80:83], v[208:211]
    ds_read_b64_tr_b16 v[28:29], v2 offset:34816
    v_exp_f32 v62, v58
    v_mfma_f32_16x16x32_bf16 v[212:215], v[24:27], v[84:87], v[212:215]
    v_exp_f32 v63, v59
    v_mul_f32 v57, v157, v189
    v_mfma_f32_16x16x32_bf16 v[216:219], v[24:27], v[88:91], v[216:219]
    ds_read_b64_tr_b16 v[30:31], v2 offset:35072
    v_mul_f32 v58, v158, v190
    v_mfma_f32_16x16x32_bf16 v[220:223], v[24:27], v[92:95], v[220:223]
    s_waitcnt lgkmcnt(4)
    v_mul_f32 v59, v159, v191
    v_add_f32 v60, 1.0, v60
    v_add_f32 v61, 1.0, v61
    v_mfma_f32_16x16x32_bf16 v[224:227], v[32:35], v[80:83], v[224:227]
    ds_read_b64_tr_b16 v[36:37], v3 offset:34816
    v_rcp_f32 v60, v60
    v_mfma_f32_16x16x32_bf16 v[228:231], v[32:35], v[84:87], v[228:231]
    v_rcp_f32 v61, v61
    v_add_f32 v62, 1.0, v62
    v_mfma_f32_16x16x32_bf16 v[232:235], v[32:35], v[88:91], v[232:235]
    ds_read_b64_tr_b16 v[38:39], v3 offset:35072
    v_rcp_f32 v62, v62
    v_mfma_f32_16x16x32_bf16 v[236:239], v[32:35], v[92:95], v[236:239]
    v_add_f32 v63, 1.0, v63
    v_mul_f32 v56, v56, v60
    v_mul_f32 v57, v57, v61
    v_mfma_f32_16x16x32_bf16 v[240:243], v[40:43], v[80:83], v[240:243]
    ds_read_b64_tr_b16 v[44:45], v4 offset:34816
    v_rcp_f32 v63, v63
    v_mfma_f32_16x16x32_bf16 v[244:247], v[40:43], v[84:87], v[244:247]
    v_mul_f32 v58, v58, v62
    v_mul_f32 v59, v59, v63
    v_mfma_f32_16x16x32_bf16 v[248:251], v[40:43], v[88:91], v[248:251]
    ds_read_b64_tr_b16 v[46:47], v4 offset:35072
    v_cvt_pk_bf16_f32 v78, v56, v57
    v_cvt_pk_bf16_f32 v79, v58, v59
    v_mfma_f32_16x16x32_bf16 v[252:255], v[40:43], v[92:95], v[252:255]
    s_waitcnt lgkmcnt(4)
    s_add_u32 s52, s49, 442368
    v_mfma_f32_16x16x32_bf16 v[192:195], v[20:23], v[96:99], v[192:195]
    buffer_store_dwordx4 v[76:79], v15, s[24:27], s52 offen sc1
    v_mfma_f32_16x16x32_bf16 v[196:199], v[20:23], v[100:103], v[196:199]
    v_mfma_f32_16x16x32_bf16 v[200:203], v[20:23], v[104:107], v[200:203]
    v_mfma_f32_16x16x32_bf16 v[204:207], v[20:23], v[108:111], v[204:207]
    s_waitcnt vmcnt(4) lgkmcnt(0)
    s_barrier
    v_mfma_f32_16x16x32_bf16 v[208:211], v[28:31], v[96:99], v[208:211]
    ds_read_b64_tr_b16 v[16:17], v5 offset:0
    v_mfma_f32_16x16x32_bf16 v[212:215], v[28:31], v[100:103], v[212:215]
    ds_read_b64_tr_b16 v[18:19], v5 offset:256
    v_mfma_f32_16x16x32_bf16 v[216:219], v[28:31], v[104:107], v[216:219]
    ds_read_b64_tr_b16 v[24:25], v6 offset:0
    v_mfma_f32_16x16x32_bf16 v[220:223], v[28:31], v[108:111], v[220:223]
    ds_read_b64_tr_b16 v[26:27], v6 offset:256
    v_mfma_f32_16x16x32_bf16 v[224:227], v[36:39], v[96:99], v[224:227]
    ds_read_b64_tr_b16 v[32:33], v7 offset:0
    v_mfma_f32_16x16x32_bf16 v[228:231], v[36:39], v[100:103], v[228:231]
    ds_read_b64_tr_b16 v[34:35], v7 offset:256
    v_mfma_f32_16x16x32_bf16 v[232:235], v[36:39], v[104:107], v[232:235]
    ds_read_b64_tr_b16 v[40:41], v8 offset:0
    v_mfma_f32_16x16x32_bf16 v[236:239], v[36:39], v[108:111], v[236:239]
    ds_read_b64_tr_b16 v[42:43], v8 offset:256
    v_mfma_f32_16x16x32_bf16 v[240:243], v[44:47], v[96:99], v[240:243]
    v_mfma_f32_16x16x32_bf16 v[244:247], v[44:47], v[100:103], v[244:247]
    v_mfma_f32_16x16x32_bf16 v[248:251], v[44:47], v[104:107], v[248:251]
    v_mfma_f32_16x16x32_bf16 v[252:255], v[44:47], v[108:111], v[252:255]
    v_swap_b32 v1, v5
    v_swap_b32 v2, v6
    v_swap_b32 v3, v7
    v_swap_b32 v4, v8
    s_xor_b32 s48, s48, s54
    s_mov_b32 s49, s73
    s_mov_b32 s73, s74
    s_branch L_k1_f2_ffn
L_k1_loop:
    s_mul_i32 s44, s40, 147456
    s_lshl_b32 s52, s50, 6
    s_add_u32 s44, s44, s52
    s_mov_b32 s45, s44
    s_lshl_b32 s52, s50, 10
    s_add_u32 s74, s72, s52
    s_add_u32 s50, s50, 28
    s_lshl_b32 s99, s50, 6
    s_cmp_eq_u32 s51, 0
    s_cbranch_scc1 L_k1_f1_go
    s_mov_b64 s[68:69], s[12:13]
    s_mov_b32 s70, s14
    v_mov_b32 v115, v116
    s_lshl_b32 s99, s58, 6
L_k1_f1_go:
    s_waitcnt lgkmcnt(4)
    v_mfma_f32_16x16x32_bf16 v[192:195], v[16:19], a[0:3], 0
    ds_read_b64_tr_b16 v[20:21], v1 offset:2048
    v_mfma_f32_16x16x32_bf16 v[196:199], v[16:19], a[4:7], 0
    v_mfma_f32_16x16x32_bf16 v[200:203], v[16:19], a[8:11], 0
    ds_read_b64_tr_b16 v[22:23], v1 offset:2304
    v_mfma_f32_16x16x32_bf16 v[204:207], v[16:19], a[12:15], 0
    s_add_u32 m0, s48, 0
    v_mfma_f32_16x16x32_bf16 v[208:211], v[24:27], a[0:3], 0
    ds_read_b64_tr_b16 v[28:29], v2 offset:2048
    v_mfma_f32_16x16x32_bf16 v[212:215], v[24:27], a[4:7], 0
    buffer_load_dwordx4 v9, s[32:35], s44 offen lds
    v_mfma_f32_16x16x32_bf16 v[216:219], v[24:27], a[8:11], 0
    ds_read_b64_tr_b16 v[30:31], v2 offset:2304
    v_mfma_f32_16x16x32_bf16 v[220:223], v[24:27], a[12:15], 0
    s_waitcnt lgkmcnt(4)
    s_add_u32 s44, s44, s46
    v_mfma_f32_16x16x32_bf16 v[224:227], v[32:35], a[0:3], 0
    ds_read_b64_tr_b16 v[36:37], v3 offset:2048
    v_mul_f32 v48, v128, v128
    v_mfma_f32_16x16x32_bf16 v[228:231], v[32:35], a[4:7], 0
    v_mul_f32 v49, v129, v129
    v_mul_f32 v50, v130, v130
    v_mfma_f32_16x16x32_bf16 v[232:235], v[32:35], a[8:11], 0
    ds_read_b64_tr_b16 v[38:39], v3 offset:2304
    v_mul_f32 v51, v131, v131
    v_mfma_f32_16x16x32_bf16 v[236:239], v[32:35], a[12:15], 0
    v_fmaak_f32 v48, v48, v118, 0xc0135761
    v_fmaak_f32 v49, v49, v118, 0xc0135761
    v_mfma_f32_16x16x32_bf16 v[240:243], v[40:43], a[0:3], 0
    ds_read_b64_tr_b16 v[44:45], v4 offset:2048
    v_fmaak_f32 v50, v50, v118, 0xc0135761
    v_mfma_f32_16x16x32_bf16 v[244:247], v[40:43], a[4:7], 0
    s_add_u32 m0, s48, 36864
    v_fmaak_f32 v51, v51, v118, 0xc0135761
    v_mul_f32 v48, v48, v128
    v_mfma_f32_16x16x32_bf16 v[248:251], v[40:43], a[8:11], 0
    ds_read_b64_tr_b16 v[46:47], v4 offset:2304
    v_mul_f32 v49, v49, v129
    v_mfma_f32_16x16x32_bf16 v[252:255], v[40:43], a[12:15], 0
    s_waitcnt lgkmcnt(4)
    buffer_load_dwordx4 v10, s[36:39], s45 offen lds
    v_mfma_f32_16x16x32_bf16 v[192:195], v[20:23], a[16:19], v[192:195]
    ds_read_b64_tr_b16 v[16:17], v1 offset:4096
    v_mul_f32 v50, v50, v130
    v_mfma_f32_16x16x32_bf16 v[196:199], v[20:23], a[20:23], v[196:199]
    s_add_u32 s45, s45, s47
    v_exp_f32 v52, v48
    v_mfma_f32_16x16x32_bf16 v[200:203], v[20:23], a[24:27], v[200:203]
    ds_read_b64_tr_b16 v[18:19], v1 offset:4352
    v_mul_f32 v51, v51, v131
    v_mfma_f32_16x16x32_bf16 v[204:207], v[20:23], a[28:31], v[204:207]
    v_exp_f32 v53, v49
    v_mfma_f32_16x16x32_bf16 v[208:211], v[28:31], a[16:19], v[208:211]
    ds_read_b64_tr_b16 v[24:25], v2 offset:4096
    v_mul_f32 v48, v128, v160
    v_mfma_f32_16x16x32_bf16 v[212:215], v[28:31], a[20:23], v[212:215]
    v_exp_f32 v54, v50
    v_mfma_f32_16x16x32_bf16 v[216:219], v[28:31], a[24:27], v[216:219]
    ds_read_b64_tr_b16 v[26:27], v2 offset:4352
    v_mul_f32 v49, v129, v161
    v_mfma_f32_16x16x32_bf16 v[220:223], v[28:31], a[28:31], v[220:223]
    s_waitcnt lgkmcnt(4)
    s_add_u32 m0, s48, 4096
    v_mul_f32 v50, v130, v162
    v_mfma_f32_16x16x32_bf16 v[224:227], v[36:39], a[16:19], v[224:227]
    ds_read_b64_tr_b16 v[32:33], v3 offset:4096
    v_add_f32 v52, 1.0, v52
    v_mfma_f32_16x16x32_bf16 v[228:231], v[36:39], a[20:23], v[228:231]
    buffer_load_dwordx4 v9, s[32:35], s44 offen lds
    v_mfma_f32_16x16x32_bf16 v[232:235], v[36:39], a[24:27], v[232:235]
    ds_read_b64_tr_b16 v[34:35], v3 offset:4352
    v_add_f32 v53, 1.0, v53
    v_mfma_f32_16x16x32_bf16 v[236:239], v[36:39], a[28:31], v[236:239]
    s_add_u32 s44, s44, s46
    v_exp_f32 v55, v51
    v_mfma_f32_16x16x32_bf16 v[240:243], v[44:47], a[16:19], v[240:243]
    ds_read_b64_tr_b16 v[40:41], v4 offset:4096
    v_mul_f32 v51, v131, v163
    v_mfma_f32_16x16x32_bf16 v[244:247], v[44:47], a[20:23], v[244:247]
    v_rcp_f32 v52, v52
    v_mfma_f32_16x16x32_bf16 v[248:251], v[44:47], a[24:27], v[248:251]
    ds_read_b64_tr_b16 v[42:43], v4 offset:4352
    v_add_f32 v54, 1.0, v54
    v_mfma_f32_16x16x32_bf16 v[252:255], v[44:47], a[28:31], v[252:255]
    s_waitcnt lgkmcnt(4)
    v_rcp_f32 v53, v53
    v_mfma_f32_16x16x32_bf16 v[192:195], v[16:19], a[32:35], v[192:195]
    ds_read_b64_tr_b16 v[20:21], v1 offset:6144
    v_add_f32 v55, 1.0, v55
    v_mfma_f32_16x16x32_bf16 v[196:199], v[16:19], a[36:39], v[196:199]
    s_add_u32 m0, s48, 40960
    v_rcp_f32 v54, v54
    v_mfma_f32_16x16x32_bf16 v[200:203], v[16:19], a[40:43], v[200:203]
    ds_read_b64_tr_b16 v[22:23], v1 offset:6400
    v_mul_f32 v48, v48, v52
    v_mfma_f32_16x16x32_bf16 v[204:207], v[16:19], a[44:47], v[204:207]
    buffer_load_dwordx4 v10, s[36:39], s45 offen lds
    v_mfma_f32_16x16x32_bf16 v[208:211], v[24:27], a[32:35], v[208:211]
    ds_read_b64_tr_b16 v[28:29], v2 offset:6144
    v_mul_f32 v49, v49, v53
    v_mfma_f32_16x16x32_bf16 v[212:215], v[24:27], a[36:39], v[212:215]
    s_add_u32 s45, s45, s47
    v_rcp_f32 v55, v55
    v_mfma_f32_16x16x32_bf16 v[216:219], v[24:27], a[40:43], v[216:219]
    ds_read_b64_tr_b16 v[30:31], v2 offset:6400
    v_mul_f32 v50, v50, v54
    v_mfma_f32_16x16x32_bf16 v[220:223], v[24:27], a[44:47], v[220:223]
    s_waitcnt lgkmcnt(4)
    v_mul_f32 v51, v51, v55
    v_cvt_pk_bf16_f32 v72, v48, v49
    v_mul_f32 v56, v144, v144
    v_mfma_f32_16x16x32_bf16 v[224:227], v[32:35], a[32:35], v[224:227]
    ds_read_b64_tr_b16 v[36:37], v3 offset:6144
    v_cvt_pk_bf16_f32 v73, v50, v51
    v_mfma_f32_16x16x32_bf16 v[228:231], v[32:35], a[36:39], v[228:231]
    v_mul_f32 v57, v145, v145
    v_mul_f32 v58, v146, v146
    v_mfma_f32_16x16x32_bf16 v[232:235], v[32:35], a[40:43], v[232:235]
    ds_read_b64_tr_b16 v[38:39], v3 offset:6400
    v_mul_f32 v59, v147, v147
    v_mfma_f32_16x16x32_bf16 v[236:239], v[32:35], a[44:47], v[236:239]
    s_add_u32 m0, s48, 8192
    v_fmaak_f32 v56, v56, v118, 0xc0135761
    v_fmaak_f32 v57, v57, v118, 0xc0135761
    v_mfma_f32_16x16x32_bf16 v[240:243], v[40:43], a[32:35], v[240:243]
    ds_read_b64_tr_b16 v[44:45], v4 offset:6144
    v_fmaak_f32 v58, v58, v118, 0xc0135761
    v_mfma_f32_16x16x32_bf16 v[244:247], v[40:43], a[36:39], v[244:247]
    buffer_load_dwordx4 v9, s[32:35], s44 offen lds
    v_mfma_f32_16x16x32_bf16 v[248:251], v[40:43], a[40:43], v[248:251]
    ds_read_b64_tr_b16 v[46:47], v4 offset:6400
    v_fmaak_f32 v59, v59, v118, 0xc0135761
    v_mfma_f32_16x16x32_bf16 v[252:255], v[40:43], a[44:47], v[252:255]
    s_waitcnt lgkmcnt(4)
    s_add_u32 s44, s44, s46
    v_mul_f32 v56, v56, v144
    v_mfma_f32_16x16x32_bf16 v[192:195], v[20:23], a[48:51], v[192:195]
    ds_read_b64_tr_b16 v[16:17], v1 offset:8192
    v_mul_f32 v57, v57, v145
    v_mfma_f32_16x16x32_bf16 v[196:199], v[20:23], a[52:55], v[196:199]
    v_exp_f32 v60, v56
    v_mfma_f32_16x16x32_bf16 v[200:203], v[20:23], a[56:59], v[200:203]
    ds_read_b64_tr_b16 v[18:19], v1 offset:8448
    v_mul_f32 v58, v58, v146
    v_mfma_f32_16x16x32_bf16 v[204:207], v[20:23], a[60:63], v[204:207]
    v_exp_f32 v61, v57
    v_mfma_f32_16x16x32_bf16 v[208:211], v[28:31], a[48:51], v[208:211]
    ds_read_b64_tr_b16 v[24:25], v2 offset:8192
    v_mul_f32 v59, v59, v147
    v_mfma_f32_16x16x32_bf16 v[212:215], v[28:31], a[52:55], v[212:215]
    s_add_u32 m0, s48, 45056
    v_exp_f32 v62, v58
    v_mfma_f32_16x16x32_bf16 v[216:219], v[28:31], a[56:59], v[216:219]
    ds_read_b64_tr_b16 v[26:27], v2 offset:8448
    v_mul_f32 v56, v144, v176
    v_mfma_f32_16x16x32_bf16 v[220:223], v[28:31], a[60:63], v[220:223]
    s_waitcnt lgkmcnt(4)
    buffer_load_dwordx4 v10, s[36:39], s45 offen lds
    v_mfma_f32_16x16x32_bf16 v[224:227], v[36:39], a[48:51], v[224:227]
    ds_read_b64_tr_b16 v[32:33], v3 offset:8192
    v_mul_f32 v57, v145, v177
    v_mfma_f32_16x16x32_bf16 v[228:231], v[36:39], a[52:55], v[228:231]
    s_add_u32 s45, s45, s47
    v_exp_f32 v63, v59
    v_mfma_f32_16x16x32_bf16 v[232:235], v[36:39], a[56:59], v[232:235]
    ds_read_b64_tr_b16 v[34:35], v3 offset:8448
    v_mul_f32 v58, v146, v178
    v_mfma_f32_16x16x32_bf16 v[236:239], v[36:39], a[60:63], v[236:239]
    v_mul_f32 v59, v147, v179
    v_add_f32 v60, 1.0, v60
    v_mfma_f32_16x16x32_bf16 v[240:243], v[44:47], a[48:51], v[240:243]
    ds_read_b64_tr_b16 v[40:41], v4 offset:8192
    v_add_f32 v61, 1.0, v61
    v_mfma_f32_16x16x32_bf16 v[244:247], v[44:47], a[52:55], v[244:247]
    v_rcp_f32 v60, v60
    v_mfma_f32_16x16x32_bf16 v[248:251], v[44:47], a[56:59], v[248:251]
    ds_read_b64_tr_b16 v[42:43], v4 offset:8448
    v_add_f32 v62, 1.0, v62
    v_mfma_f32_16x16x32_bf16 v[252:255], v[44:47], a[60:63], v[252:255]
    s_waitcnt lgkmcnt(4)
    s_add_u32 m0, s48, 12288
    v_add_f32 v63, 1.0, v63
    v_mfma_f32_16x16x32_bf16 v[192:195], v[16:19], a[64:67], v[192:195]
    ds_read_b64_tr_b16 v[20:21], v1 offset:10240
    v_mul_f32 v56, v56, v60
    v_mfma_f32_16x16x32_bf16 v[196:199], v[16:19], a[68:71], v[196:199]
    buffer_load_dwordx4 v9, s[32:35], s44 offen lds
    v_mfma_f32_16x16x32_bf16 v[200:203], v[16:19], a[72:75], v[200:203]
    ds_read_b64_tr_b16 v[22:23], v1 offset:10496
    v_mul_f32 v64, v132, v132
    v_mfma_f32_16x16x32_bf16 v[204:207], v[16:19], a[76:79], v[204:207]
    s_add_u32 s44, s44, s46
    v_rcp_f32 v61, v61
    v_mfma_f32_16x16x32_bf16 v[208:211], v[24:27], a[64:67], v[208:211]
    ds_read_b64_tr_b16 v[28:29], v2 offset:10240
    v_mul_f32 v57, v57, v61
    v_mfma_f32_16x16x32_bf16 v[212:215], v[24:27], a[68:71], v[212:215]
    v_rcp_f32 v62, v62
    v_mfma_f32_16x16x32_bf16 v[216:219], v[24:27], a[72:75], v[216:219]
    ds_read_b64_tr_b16 v[30:31], v2 offset:10496
    v_rcp_f32 v63, v63
    v_mfma_f32_16x16x32_bf16 v[220:223], v[24:27], a[76:79], v[220:223]
    s_waitcnt lgkmcnt(4)
    v_mul_f32 v58, v58, v62
    v_mul_f32 v59, v59, v63
    v_mfma_f32_16x16x32_bf16 v[224:227], v[32:35], a[64:67], v[224:227]
    ds_read_b64_tr_b16 v[36:37], v3 offset:10240
    v_cvt_pk_bf16_f32 v74, v56, v57
    v_mfma_f32_16x16x32_bf16 v[228:231], v[32:35], a[68:71], v[228:231]
    s_add_u32 m0, s48, 49152
    v_cvt_pk_bf16_f32 v75, v58, v59
    v_mul_f32 v65, v133, v133
    v_mfma_f32_16x16x32_bf16 v[232:235], v[32:35], a[72:75], v[232:235]
    ds_read_b64_tr_b16 v[38:39], v3 offset:10496
    v_mul_f32 v66, v134, v134
    v_mfma_f32_16x16x32_bf16 v[236:239], v[32:35], a[76:79], v[236:239]
    buffer_load_dwordx4 v10, s[36:39], s45 offen lds
    v_mfma_f32_16x16x32_bf16 v[240:243], v[40:43], a[64:67], v[240:243]
    ds_read_b64_tr_b16 v[44:45], v4 offset:10240
    v_mul_f32 v67, v135, v135
    v_mfma_f32_16x16x32_bf16 v[244:247], v[40:43], a[68:71], v[244:247]
    s_add_u32 s45, s45, s47
    buffer_store_dwordx4 v[72:75], v15, s[24:27], s49 offen sc1
    v_mfma_f32_16x16x32_bf16 v[248:251], v[40:43], a[72:75], v[248:251]
    ds_read_b64_tr_b16 v[46:47], v4 offset:10496
    v_fmaak_f32 v64, v64, v118, 0xc0135761
    v_mfma_f32_16x16x32_bf16 v[252:255], v[40:43], a[76:79], v[252:255]
    s_waitcnt lgkmcnt(4)
    v_fmaak_f32 v65, v65, v118, 0xc0135761
    v_fmaak_f32 v66, v66, v118, 0xc0135761
    v_mfma_f32_16x16x32_bf16 v[192:195], v[20:23], a[80:83], v[192:195]
    ds_read_b64_tr_b16 v[16:17], v1 offset:12288
    v_fmaak_f32 v67, v67, v118, 0xc0135761
    v_mfma_f32_16x16x32_bf16 v[196:199], v[20:23], a[84:87], v[196:199]
    v_mul_f32 v64, v64, v132
    v_mul_f32 v65, v65, v133
    v_mfma_f32_16x16x32_bf16 v[200:203], v[20:23], a[88:91], v[200:203]
    ds_read_b64_tr_b16 v[18:19], v1 offset:12544
    v_mul_f32 v66, v66, v134
    v_mfma_f32_16x16x32_bf16 v[204:207], v[20:23], a[92:95], v[204:207]
    s_add_u32 m0, s48, 16384
    v_exp_f32 v68, v64
    v_mfma_f32_16x16x32_bf16 v[208:211], v[28:31], a[80:83], v[208:211]
    ds_read_b64_tr_b16 v[24:25], v2 offset:12288
    v_mul_f32 v67, v67, v135
    v_mfma_f32_16x16x32_bf16 v[212:215], v[28:31], a[84:87], v[212:215]
    buffer_load_dwordx4 v9, s[32:35], s44 offen lds
    v_mfma_f32_16x16x32_bf16 v[216:219], v[28:31], a[88:91], v[216:219]
    ds_read_b64_tr_b16 v[26:27], v2 offset:12544
    v_mul_f32 v64, v132, v164
    v_mfma_f32_16x16x32_bf16 v[220:223], v[28:31], a[92:95], v[220:223]
    s_waitcnt lgkmcnt(4)
    s_add_u32 s44, s44, s46
    v_add_f32 v68, 1.0, v68
    v_mfma_f32_16x16x32_bf16 v[224:227], v[36:39], a[80:83], v[224:227]
    ds_read_b64_tr_b16 v[32:33], v3 offset:12288
    v_mul_f32 v48, v148, v148
    v_mfma_f32_16x16x32_bf16 v[228:231], v[36:39], a[84:87], v[228:231]
    v_exp_f32 v69, v65
    v_mfma_f32_16x16x32_bf16 v[232:235], v[36:39], a[88:91], v[232:235]
    ds_read_b64_tr_b16 v[34:35], v3 offset:12544
    v_mul_f32 v65, v133, v165
    v_mfma_f32_16x16x32_bf16 v[236:239], v[36:39], a[92:95], v[236:239]
    v_exp_f32 v70, v66
    v_mfma_f32_16x16x32_bf16 v[240:243], v[44:47], a[80:83], v[240:243]
    ds_read_b64_tr_b16 v[40:41], v4 offset:12288
    v_mul_f32 v66, v134, v166
    v_mfma_f32_16x16x32_bf16 v[244:247], v[44:47], a[84:87], v[244:247]
    s_add_u32 m0, s48, 53248
    v_exp_f32 v71, v67
    v_mfma_f32_16x16x32_bf16 v[248:251], v[44:47], a[88:91], v[248:251]
    ds_read_b64_tr_b16 v[42:43], v4 offset:12544
    v_mul_f32 v67, v135, v167
    v_mfma_f32_16x16x32_bf16 v[252:255], v[44:47], a[92:95], v[252:255]
    s_waitcnt lgkmcnt(4)
    buffer_load_dwordx4 v10, s[36:39], s45 offen lds
    v_mfma_f32_16x16x32_bf16 v[192:195], v[16:19], a[96:99], v[192:195]
    ds_read_b64_tr_b16 v[20:21], v1 offset:14336
    v_add_f32 v69, 1.0, v69
    v_mfma_f32_16x16x32_bf16 v[196:199], v[16:19], a[100:103], v[196:199]
    s_add_u32 s45, s45, s47
    v_rcp_f32 v68, v68
    v_mfma_f32_16x16x32_bf16 v[200:203], v[16:19], a[104:107], v[200:203]
    ds_read_b64_tr_b16 v[22:23], v1 offset:14592
    v_add_f32 v70, 1.0, v70
    v_mfma_f32_16x16x32_bf16 v[204:207], v[16:19], a[108:111], v[204:207]
    v_rcp_f32 v69, v69
    v_mfma_f32_16x16x32_bf16 v[208:211], v[24:27], a[96:99], v[208:211]
    ds_read_b64_tr_b16 v[28:29], v2 offset:14336
    v_add_f32 v71, 1.0, v71
    v_mfma_f32_16x16x32_bf16 v[212:215], v[24:27], a[100:103], v[212:215]
    v_rcp_f32 v70, v70
    v_mfma_f32_16x16x32_bf16 v[216:219], v[24:27], a[104:107], v[216:219]
    ds_read_b64_tr_b16 v[30:31], v2 offset:14592
    v_rcp_f32 v71, v71
    v_mfma_f32_16x16x32_bf16 v[220:223], v[24:27], a[108:111], v[220:223]
    s_waitcnt lgkmcnt(4)
    s_add_u32 m0, s48, 20480
    v_mul_f32 v64, v64, v68
    v_mfma_f32_16x16x32_bf16 v[224:227], v[32:35], a[96:99], v[224:227]
    ds_read_b64_tr_b16 v[36:37], v3 offset:14336
    v_mul_f32 v65, v65, v69
    v_mfma_f32_16x16x32_bf16 v[228:231], v[32:35], a[100:103], v[228:231]
    buffer_load_dwordx4 v9, s[32:35], s44 offen lds
    v_mfma_f32_16x16x32_bf16 v[232:235], v[32:35], a[104:107], v[232:235]
    ds_read_b64_tr_b16 v[38:39], v3 offset:14592
    v_mul_f32 v66, v66, v70
    v_mfma_f32_16x16x32_bf16 v[236:239], v[32:35], a[108:111], v[236:239]
    s_add_u32 s44, s44, s46
    v_mul_f32 v67, v67, v71
    v_cvt_pk_bf16_f32 v76, v64, v65
    v_mfma_f32_16x16x32_bf16 v[240:243], v[40:43], a[96:99], v[240:243]
    ds_read_b64_tr_b16 v[44:45], v4 offset:14336
    v_cvt_pk_bf16_f32 v77, v66, v67
    v_mfma_f32_16x16x32_bf16 v[244:247], v[40:43], a[100:103], v[244:247]
    v_mul_f32 v49, v149, v149
    v_mul_f32 v50, v150, v150
    v_mfma_f32_16x16x32_bf16 v[248:251], v[40:43], a[104:107], v[248:251]
    ds_read_b64_tr_b16 v[46:47], v4 offset:14592
    v_mul_f32 v51, v151, v151
    v_mfma_f32_16x16x32_bf16 v[252:255], v[40:43], a[108:111], v[252:255]
    s_waitcnt lgkmcnt(4)
    v_fmaak_f32 v48, v48, v118, 0xc0135761
    v_fmaak_f32 v49, v49, v118, 0xc0135761
    v_mfma_f32_16x16x32_bf16 v[192:195], v[20:23], a[112:115], v[192:195]
    ds_read_b64_tr_b16 v[16:17], v1 offset:16384
    v_fmaak_f32 v50, v50, v118, 0xc0135761
    v_mfma_f32_16x16x32_bf16 v[196:199], v[20:23], a[116:119], v[196:199]
    s_add_u32 m0, s48, 57344
    v_fmaak_f32 v51, v51, v118, 0xc0135761
    v_mul_f32 v48, v48, v148
    v_mfma_f32_16x16x32_bf16 v[200:203], v[20:23], a[120:123], v[200:203]
    ds_read_b64_tr_b16 v[18:19], v1 offset:16640
    v_mul_f32 v49, v49, v149
    v_mfma_f32_16x16x32_bf16 v[204:207], v[20:23], a[124:127], v[204:207]
    buffer_load_dwordx4 v10, s[36:39], s45 offen lds
    v_mfma_f32_16x16x32_bf16 v[208:211], v[28:31], a[112:115], v[208:211]
    ds_read_b64_tr_b16 v[24:25], v2 offset:16384
    v_mul_f32 v50, v50, v150
    v_mfma_f32_16x16x32_bf16 v[212:215], v[28:31], a[116:119], v[212:215]
    s_add_u32 s45, s45, s47
    v_exp_f32 v52, v48
    v_mfma_f32_16x16x32_bf16 v[216:219], v[28:31], a[120:123], v[216:219]
    ds_read_b64_tr_b16 v[26:27], v2 offset:16640
    v_mul_f32 v51, v51, v151
    v_mfma_f32_16x16x32_bf16 v[220:223], v[28:31], a[124:127], v[220:223]
    s_waitcnt lgkmcnt(4)
    v_exp_f32 v53, v49
    v_mfma_f32_16x16x32_bf16 v[224:227], v[36:39], a[112:115], v[224:227]
    ds_read_b64_tr_b16 v[32:33], v3 offset:16384
    v_mul_f32 v48, v148, v180
    v_mfma_f32_16x16x32_bf16 v[228:231], v[36:39], a[116:119], v[228:231]
    v_exp_f32 v54, v50
    v_mfma_f32_16x16x32_bf16 v[232:235], v[36:39], a[120:123], v[232:235]
    ds_read_b64_tr_b16 v[34:35], v3 offset:16640
    v_mul_f32 v49, v149, v181
    v_mfma_f32_16x16x32_bf16 v[236:239], v[36:39], a[124:127], v[236:239]
    s_add_u32 m0, s48, 24576
    v_exp_f32 v55, v51
    v_mfma_f32_16x16x32_bf16 v[240:243], v[44:47], a[112:115], v[240:243]
    ds_read_b64_tr_b16 v[40:41], v4 offset:16384
    v_mul_f32 v50, v150, v182
    v_mfma_f32_16x16x32_bf16 v[244:247], v[44:47], a[116:119], v[244:247]
    buffer_load_dwordx4 v9, s[32:35], s44 offen lds
    v_mfma_f32_16x16x32_bf16 v[248:251], v[44:47], a[120:123], v[248:251]
    ds_read_b64_tr_b16 v[42:43], v4 offset:16640
    v_mul_f32 v51, v151, v183
    v_mfma_f32_16x16x32_bf16 v[252:255], v[44:47], a[124:127], v[252:255]
    s_waitcnt lgkmcnt(4)
    s_add_u32 s44, s44, s46
    v_add_f32 v52, 1.0, v52
    v_mfma_f32_16x16x32_bf16 v[192:195], v[16:19], a[128:131], v[192:195]
    ds_read_b64_tr_b16 v[20:21], v1 offset:18432
    v_add_f32 v53, 1.0, v53
    v_mfma_f32_16x16x32_bf16 v[196:199], v[16:19], a[132:135], v[196:199]
    v_rcp_f32 v52, v52
    v_mfma_f32_16x16x32_bf16 v[200:203], v[16:19], a[136:139], v[200:203]
    ds_read_b64_tr_b16 v[22:23], v1 offset:18688
    v_add_f32 v54, 1.0, v54
    v_mfma_f32_16x16x32_bf16 v[204:207], v[16:19], a[140:143], v[204:207]
    v_rcp_f32 v53, v53
    v_mfma_f32_16x16x32_bf16 v[208:211], v[24:27], a[128:131], v[208:211]
    ds_read_b64_tr_b16 v[28:29], v2 offset:18432
    v_add_f32 v55, 1.0, v55
    v_mfma_f32_16x16x32_bf16 v[212:215], v[24:27], a[132:135], v[212:215]
    s_add_u32 m0, s48, 61440
    v_rcp_f32 v54, v54
    v_mul_f32 v48, v48, v52
    v_mfma_f32_16x16x32_bf16 v[216:219], v[24:27], a[136:139], v[216:219]
    ds_read_b64_tr_b16 v[30:31], v2 offset:18688
    v_mul_f32 v49, v49, v53
    v_mfma_f32_16x16x32_bf16 v[220:223], v[24:27], a[140:143], v[220:223]
    s_waitcnt lgkmcnt(4)
    buffer_load_dwordx4 v10, s[36:39], s45 offen lds
    v_mfma_f32_16x16x32_bf16 v[224:227], v[32:35], a[128:131], v[224:227]
    ds_read_b64_tr_b16 v[36:37], v3 offset:18432
    v_mul_f32 v50, v50, v54
    v_mfma_f32_16x16x32_bf16 v[228:231], v[32:35], a[132:135], v[228:231]
    s_add_u32 s45, s45, s47
    v_rcp_f32 v55, v55
    v_mfma_f32_16x16x32_bf16 v[232:235], v[32:35], a[136:139], v[232:235]
    ds_read_b64_tr_b16 v[38:39], v3 offset:18688
    v_mul_f32 v51, v51, v55
    v_mfma_f32_16x16x32_bf16 v[236:239], v[32:35], a[140:143], v[236:239]
    v_cvt_pk_bf16_f32 v78, v48, v49
    v_cvt_pk_bf16_f32 v79, v50, v51
    v_mfma_f32_16x16x32_bf16 v[240:243], v[40:43], a[128:131], v[240:243]
    ds_read_b64_tr_b16 v[44:45], v4 offset:18432
    s_add_u32 s52, s49, 147456
    v_mfma_f32_16x16x32_bf16 v[244:247], v[40:43], a[132:135], v[244:247]
    buffer_store_dwordx4 v[76:79], v15, s[24:27], s52 offen sc1
    v_mfma_f32_16x16x32_bf16 v[248:251], v[40:43], a[136:139], v[248:251]
    ds_read_b64_tr_b16 v[46:47], v4 offset:18688
    v_mul_f32 v56, v136, v136
    v_mfma_f32_16x16x32_bf16 v[252:255], v[40:43], a[140:143], v[252:255]
    s_waitcnt lgkmcnt(4)
    s_add_u32 m0, s48, 28672
    v_mul_f32 v57, v137, v137
    v_mfma_f32_16x16x32_bf16 v[192:195], v[20:23], a[144:147], v[192:195]
    ds_read_b64_tr_b16 v[16:17], v1 offset:20480
    v_mul_f32 v58, v138, v138
    v_mfma_f32_16x16x32_bf16 v[196:199], v[20:23], a[148:151], v[196:199]
    buffer_load_dwordx4 v9, s[32:35], s44 offen lds
    v_mfma_f32_16x16x32_bf16 v[200:203], v[20:23], a[152:155], v[200:203]
    ds_read_b64_tr_b16 v[18:19], v1 offset:20736
    v_mul_f32 v59, v139, v139
    v_mfma_f32_16x16x32_bf16 v[204:207], v[20:23], a[156:159], v[204:207]
    s_add_u32 s44, s44, s46
    v_fmaak_f32 v56, v56, v118, 0xc0135761
    v_fmaak_f32 v57, v57, v118, 0xc0135761
    v_mfma_f32_16x16x32_bf16 v[208:211], v[28:31], a[144:147], v[208:211]
    ds_read_b64_tr_b16 v[24:25], v2 offset:20480
    v_fmaak_f32 v58, v58, v118, 0xc0135761
    v_mfma_f32_16x16x32_bf16 v[212:215], v[28:31], a[148:151], v[212:215]
    v_fmaak_f32 v59, v59, v118, 0xc0135761
    v_mul_f32 v56, v56, v136
    v_mfma_f32_16x16x32_bf16 v[216:219], v[28:31], a[152:155], v[216:219]
    ds_read_b64_tr_b16 v[26:27], v2 offset:20736
    v_mul_f32 v57, v57, v137
    v_mfma_f32_16x16x32_bf16 v[220:223], v[28:31], a[156:159], v[220:223]
    s_waitcnt lgkmcnt(4)
    v_exp_f32 v60, v56
    v_mfma_f32_16x16x32_bf16 v[224:227], v[36:39], a[144:147], v[224:227]
    ds_read_b64_tr_b16 v[32:33], v3 offset:20480
    v_mul_f32 v58, v58, v138
    v_mfma_f32_16x16x32_bf16 v[228:231], v[36:39], a[148:151], v[228:231]
    s_add_u32 m0, s48, 65536
    v_exp_f32 v61, v57
    v_mfma_f32_16x16x32_bf16 v[232:235], v[36:39], a[152:155], v[232:235]
    ds_read_b64_tr_b16 v[34:35], v3 offset:20736
    v_mul_f32 v59, v59, v139
    v_mfma_f32_16x16x32_bf16 v[236:239], v[36:39], a[156:159], v[236:239]
    buffer_load_dwordx4 v10, s[36:39], s45 offen lds
    v_mfma_f32_16x16x32_bf16 v[240:243], v[44:47], a[144:147], v[240:243]
    ds_read_b64_tr_b16 v[40:41], v4 offset:20480
    v_mul_f32 v56, v136, v168
    v_mfma_f32_16x16x32_bf16 v[244:247], v[44:47], a[148:151], v[244:247]
    s_add_u32 s45, s45, s47
    v_exp_f32 v62, v58
    v_mfma_f32_16x16x32_bf16 v[248:251], v[44:47], a[152:155], v[248:251]
    ds_read_b64_tr_b16 v[42:43], v4 offset:20736
    v_mul_f32 v57, v137, v169
    v_mfma_f32_16x16x32_bf16 v[252:255], v[44:47], a[156:159], v[252:255]
    s_waitcnt lgkmcnt(4)
    v_exp_f32 v63, v59
    v_mfma_f32_16x16x32_bf16 v[192:195], v[16:19], a[160:163], v[192:195]
    ds_read_b64_tr_b16 v[20:21], v1 offset:22528
    v_mul_f32 v58, v138, v170
    v_mfma_f32_16x16x32_bf16 v[196:199], v[16:19], a[164:167], v[196:199]
    v_mul_f32 v59, v139, v171
    v_add_f32 v60, 1.0, v60
    v_mfma_f32_16x16x32_bf16 v[200:203], v[16:19], a[168:171], v[200:203]
    ds_read_b64_tr_b16 v[22:23], v1 offset:22784
    v_add_f32 v61, 1.0, v61
    v_mfma_f32_16x16x32_bf16 v[204:207], v[16:19], a[172:175], v[204:207]
    s_add_u32 m0, s48, 32768
    v_rcp_f32 v60, v60
    v_mfma_f32_16x16x32_bf16 v[208:211], v[24:27], a[160:163], v[208:211]
    ds_read_b64_tr_b16 v[28:29], v2 offset:22528
    v_add_f32 v62, 1.0, v62
    v_mfma_f32_16x16x32_bf16 v[212:215], v[24:27], a[164:167], v[212:215]
    buffer_load_dwordx4 v9, s[32:35], s44 offen lds
    v_add_f32 v63, 1.0, v63
    v_mfma_f32_16x16x32_bf16 v[216:219], v[24:27], a[168:171], v[216:219]
    ds_read_b64_tr_b16 v[30:31], v2 offset:22784
    v_mul_f32 v56, v56, v60
    v_mfma_f32_16x16x32_bf16 v[220:223], v[24:27], a[172:175], v[220:223]
    s_waitcnt lgkmcnt(4)
    s_add_u32 s44, s44, s46
    v_mul_f32 v64, v152, v152
    v_mfma_f32_16x16x32_bf16 v[224:227], v[32:35], a[160:163], v[224:227]
    ds_read_b64_tr_b16 v[36:37], v3 offset:22528
    v_mul_f32 v65, v153, v153
    v_mfma_f32_16x16x32_bf16 v[228:231], v[32:35], a[164:167], v[228:231]
    v_rcp_f32 v61, v61
    v_mfma_f32_16x16x32_bf16 v[232:235], v[32:35], a[168:171], v[232:235]
    ds_read_b64_tr_b16 v[38:39], v3 offset:22784
    v_mul_f32 v57, v57, v61
    v_mfma_f32_16x16x32_bf16 v[236:239], v[32:35], a[172:175], v[236:239]
    v_rcp_f32 v62, v62
    v_mfma_f32_16x16x32_bf16 v[240:243], v[40:43], a[160:163], v[240:243]
    ds_read_b64_tr_b16 v[44:45], v4 offset:22528
    v_mul_f32 v58, v58, v62
    v_mfma_f32_16x16x32_bf16 v[244:247], v[40:43], a[164:167], v[244:247]
    s_add_u32 m0, s48, 69632
    v_rcp_f32 v63, v63
    v_mfma_f32_16x16x32_bf16 v[248:251], v[40:43], a[168:171], v[248:251]
    ds_read_b64_tr_b16 v[46:47], v4 offset:22784
    v_mul_f32 v59, v59, v63
    v_mfma_f32_16x16x32_bf16 v[252:255], v[40:43], a[172:175], v[252:255]
    s_waitcnt lgkmcnt(4)
    buffer_load_dwordx4 v10, s[36:39], s45 offen lds
    v_mfma_f32_16x16x32_bf16 v[192:195], v[20:23], a[176:179], v[192:195]
    ds_read_b64_tr_b16 v[16:17], v1 offset:24576
    v_cvt_pk_bf16_f32 v72, v56, v57
    v_mfma_f32_16x16x32_bf16 v[196:199], v[20:23], a[180:183], v[196:199]
    s_add_u32 s45, s45, s47
    v_cvt_pk_bf16_f32 v73, v58, v59
    v_mul_f32 v66, v154, v154
    v_mfma_f32_16x16x32_bf16 v[200:203], v[20:23], a[184:187], v[200:203]
    ds_read_b64_tr_b16 v[18:19], v1 offset:24832
    v_mul_f32 v67, v155, v155
    v_mfma_f32_16x16x32_bf16 v[204:207], v[20:23], a[188:191], v[204:207]
    v_fmaak_f32 v64, v64, v118, 0xc0135761
    v_fmaak_f32 v65, v65, v118, 0xc0135761
    v_mfma_f32_16x16x32_bf16 v[208:211], v[28:31], a[176:179], v[208:211]
    ds_read_b64_tr_b16 v[24:25], v2 offset:24576
    v_fmaak_f32 v66, v66, v118, 0xc0135761
    v_mfma_f32_16x16x32_bf16 v[212:215], v[28:31], a[180:183], v[212:215]
    v_fmaak_f32 v67, v67, v118, 0xc0135761
    v_mul_f32 v64, v64, v152
    v_mfma_f32_16x16x32_bf16 v[216:219], v[28:31], a[184:187], v[216:219]
    ds_read_b64_tr_b16 v[26:27], v2 offset:24832
    v_mul_f32 v65, v65, v153
    v_mfma_f32_16x16x32_bf16 v[220:223], v[28:31], a[188:191], v[220:223]
    s_waitcnt lgkmcnt(4)
    v_exp_f32 v68, v64
    v_mfma_f32_16x16x32_bf16 v[224:227], v[36:39], a[176:179], v[224:227]
    ds_read_b64_tr_b16 v[32:33], v3 offset:24576
    v_mul_f32 v66, v66, v154
    v_mfma_f32_16x16x32_bf16 v[228:231], v[36:39], a[180:183], v[228:231]
    buffer_load_dword v114, v115, s[68:71], s99 offen
    v_mfma_f32_16x16x32_bf16 v[232:235], v[36:39], a[184:187], v[232:235]
    ds_read_b64_tr_b16 v[34:35], v3 offset:24832
    v_mul_f32 v67, v67, v155
    v_mfma_f32_16x16x32_bf16 v[236:239], v[36:39], a[188:191], v[236:239]
    buffer_load_dword v114, v117, s[76:79], s101 offen
    v_mfma_f32_16x16x32_bf16 v[240:243], v[44:47], a[176:179], v[240:243]
    ds_read_b64_tr_b16 v[40:41], v4 offset:24576
    v_mul_f32 v64, v152, v184
    v_mfma_f32_16x16x32_bf16 v[244:247], v[44:47], a[180:183], v[244:247]
    v_exp_f32 v69, v65
    v_mfma_f32_16x16x32_bf16 v[248:251], v[44:47], a[184:187], v[248:251]
    ds_read_b64_tr_b16 v[42:43], v4 offset:24832
    v_mul_f32 v65, v153, v185
    v_mfma_f32_16x16x32_bf16 v[252:255], v[44:47], a[188:191], v[252:255]
    s_waitcnt lgkmcnt(4)
    s_add_u32 s101, s101, 3072
    v_add_f32 v68, 1.0, v68
    v_mfma_f32_16x16x32_bf16 v[192:195], v[16:19], a[192:195], v[192:195]
    ds_read_b64_tr_b16 v[20:21], v1 offset:26624
    v_add_f32 v69, 1.0, v69
    v_mfma_f32_16x16x32_bf16 v[196:199], v[16:19], a[196:199], v[196:199]
    v_exp_f32 v70, v66
    v_mfma_f32_16x16x32_bf16 v[200:203], v[16:19], a[200:203], v[200:203]
    ds_read_b64_tr_b16 v[22:23], v1 offset:26880
    v_mul_f32 v66, v154, v186
    v_mfma_f32_16x16x32_bf16 v[204:207], v[16:19], a[204:207], v[204:207]
    v_exp_f32 v71, v67
    v_mfma_f32_16x16x32_bf16 v[208:211], v[24:27], a[192:195], v[208:211]
    ds_read_b64_tr_b16 v[28:29], v2 offset:26624
    v_rcp_f32 v68, v68
    v_mfma_f32_16x16x32_bf16 v[212:215], v[24:27], a[196:199], v[212:215]
    v_rcp_f32 v69, v69
    v_mfma_f32_16x16x32_bf16 v[216:219], v[24:27], a[200:203], v[216:219]
    ds_read_b64_tr_b16 v[30:31], v2 offset:26880
    v_mul_f32 v67, v155, v187
    v_mfma_f32_16x16x32_bf16 v[220:223], v[24:27], a[204:207], v[220:223]
    s_waitcnt lgkmcnt(4)
    v_add_f32 v70, 1.0, v70
    v_add_f32 v71, 1.0, v71
    v_mfma_f32_16x16x32_bf16 v[224:227], v[32:35], a[192:195], v[224:227]
    ds_read_b64_tr_b16 v[36:37], v3 offset:26624
    v_mul_f32 v64, v64, v68
    v_mfma_f32_16x16x32_bf16 v[228:231], v[32:35], a[196:199], v[228:231]
    v_rcp_f32 v70, v70
    v_mfma_f32_16x16x32_bf16 v[232:235], v[32:35], a[200:203], v[232:235]
    ds_read_b64_tr_b16 v[38:39], v3 offset:26880
    v_mul_f32 v65, v65, v69
    v_mfma_f32_16x16x32_bf16 v[236:239], v[32:35], a[204:207], v[236:239]
    v_rcp_f32 v71, v71
    v_mfma_f32_16x16x32_bf16 v[240:243], v[40:43], a[192:195], v[240:243]
    ds_read_b64_tr_b16 v[44:45], v4 offset:26624
    v_mul_f32 v66, v66, v70
    v_mfma_f32_16x16x32_bf16 v[244:247], v[40:43], a[196:199], v[244:247]
    v_mul_f32 v67, v67, v71
    v_cvt_pk_bf16_f32 v74, v64, v65
    v_mfma_f32_16x16x32_bf16 v[248:251], v[40:43], a[200:203], v[248:251]
    ds_read_b64_tr_b16 v[46:47], v4 offset:26880
    v_cvt_pk_bf16_f32 v75, v66, v67
    v_mfma_f32_16x16x32_bf16 v[252:255], v[40:43], a[204:207], v[252:255]
    s_waitcnt lgkmcnt(4)
    s_add_u32 s52, s49, 294912
    v_mul_f32 v48, v140, v140
    v_mfma_f32_16x16x32_bf16 v[192:195], v[20:23], a[208:211], v[192:195]
    ds_read_b64_tr_b16 v[16:17], v1 offset:28672
    v_mul_f32 v49, v141, v141
    v_mfma_f32_16x16x32_bf16 v[196:199], v[20:23], a[212:215], v[196:199]
    buffer_store_dwordx4 v[72:75], v15, s[24:27], s52 offen sc1
    v_mfma_f32_16x16x32_bf16 v[200:203], v[20:23], a[216:219], v[200:203]
    ds_read_b64_tr_b16 v[18:19], v1 offset:28928
    v_mul_f32 v50, v142, v142
    v_mfma_f32_16x16x32_bf16 v[204:207], v[20:23], a[220:223], v[204:207]
    v_mul_f32 v51, v143, v143
    v_fmaak_f32 v48, v48, v118, 0xc0135761
    v_mfma_f32_16x16x32_bf16 v[208:211], v[28:31], a[208:211], v[208:211]
    ds_read_b64_tr_b16 v[24:25], v2 offset:28672
    v_fmaak_f32 v49, v49, v118, 0xc0135761
    v_mfma_f32_16x16x32_bf16 v[212:215], v[28:31], a[212:215], v[212:215]
    v_fmaak_f32 v50, v50, v118, 0xc0135761
    v_fmaak_f32 v51, v51, v118, 0xc0135761
    v_mfma_f32_16x16x32_bf16 v[216:219], v[28:31], a[216:219], v[216:219]
    ds_read_b64_tr_b16 v[26:27], v2 offset:28928
    v_mul_f32 v48, v48, v140
    v_mfma_f32_16x16x32_bf16 v[220:223], v[28:31], a[220:223], v[220:223]
    s_waitcnt lgkmcnt(4)
    v_exp_f32 v52, v48
    v_mfma_f32_16x16x32_bf16 v[224:227], v[36:39], a[208:211], v[224:227]
    ds_read_b64_tr_b16 v[32:33], v3 offset:28672
    v_mul_f32 v49, v49, v141
    v_mfma_f32_16x16x32_bf16 v[228:231], v[36:39], a[212:215], v[228:231]
    v_exp_f32 v53, v49
    v_mfma_f32_16x16x32_bf16 v[232:235], v[36:39], a[216:219], v[232:235]
    ds_read_b64_tr_b16 v[34:35], v3 offset:28928
    v_mul_f32 v50, v50, v142
    v_mfma_f32_16x16x32_bf16 v[236:239], v[36:39], a[220:223], v[236:239]
    v_exp_f32 v54, v50
    v_mfma_f32_16x16x32_bf16 v[240:243], v[44:47], a[208:211], v[240:243]
    ds_read_b64_tr_b16 v[40:41], v4 offset:28672
    v_mul_f32 v51, v51, v143
    v_mfma_f32_16x16x32_bf16 v[244:247], v[44:47], a[212:215], v[244:247]
    v_exp_f32 v55, v51
    v_mfma_f32_16x16x32_bf16 v[248:251], v[44:47], a[216:219], v[248:251]
    ds_read_b64_tr_b16 v[42:43], v4 offset:28928
    v_mul_f32 v48, v140, v172
    v_mfma_f32_16x16x32_bf16 v[252:255], v[44:47], a[220:223], v[252:255]
    s_waitcnt lgkmcnt(4)
    v_mul_f32 v49, v141, v173
    v_mul_f32 v50, v142, v174
    v_mfma_f32_16x16x32_bf16 v[192:195], v[16:19], a[224:227], v[192:195]
    ds_read_b64_tr_b16 v[20:21], v1 offset:30720
    v_mul_f32 v51, v143, v175
    v_mfma_f32_16x16x32_bf16 v[196:199], v[16:19], a[228:231], v[196:199]
    v_add_f32 v52, 1.0, v52
    v_add_f32 v53, 1.0, v53
    v_mfma_f32_16x16x32_bf16 v[200:203], v[16:19], a[232:235], v[200:203]
    ds_read_b64_tr_b16 v[22:23], v1 offset:30976
    v_add_f32 v54, 1.0, v54
    v_mfma_f32_16x16x32_bf16 v[204:207], v[16:19], a[236:239], v[204:207]
    v_rcp_f32 v52, v52
    v_mfma_f32_16x16x32_bf16 v[208:211], v[24:27], a[224:227], v[208:211]
    ds_read_b64_tr_b16 v[28:29], v2 offset:30720
    v_rcp_f32 v53, v53
    v_mfma_f32_16x16x32_bf16 v[212:215], v[24:27], a[228:231], v[212:215]
    v_rcp_f32 v54, v54
    v_mfma_f32_16x16x32_bf16 v[216:219], v[24:27], a[232:235], v[216:219]
    ds_read_b64_tr_b16 v[30:31], v2 offset:30976
    v_add_f32 v55, 1.0, v55
    v_mfma_f32_16x16x32_bf16 v[220:223], v[24:27], a[236:239], v[220:223]
    s_waitcnt lgkmcnt(4)
    v_rcp_f32 v55, v55
    v_mfma_f32_16x16x32_bf16 v[224:227], v[32:35], a[224:227], v[224:227]
    ds_read_b64_tr_b16 v[36:37], v3 offset:30720
    v_mul_f32 v48, v48, v52
    v_mfma_f32_16x16x32_bf16 v[228:231], v[32:35], a[228:231], v[228:231]
    v_mul_f32 v49, v49, v53
    v_mul_f32 v50, v50, v54
    v_mfma_f32_16x16x32_bf16 v[232:235], v[32:35], a[232:235], v[232:235]
    ds_read_b64_tr_b16 v[38:39], v3 offset:30976
    v_mul_f32 v51, v51, v55
    v_mfma_f32_16x16x32_bf16 v[236:239], v[32:35], a[236:239], v[236:239]
    v_cvt_pk_bf16_f32 v76, v48, v49
    v_cvt_pk_bf16_f32 v77, v50, v51
    v_mfma_f32_16x16x32_bf16 v[240:243], v[40:43], a[224:227], v[240:243]
    ds_read_b64_tr_b16 v[44:45], v4 offset:30720
    v_mul_f32 v56, v156, v156
    v_mfma_f32_16x16x32_bf16 v[244:247], v[40:43], a[228:231], v[244:247]
    v_mul_f32 v57, v157, v157
    v_mul_f32 v58, v158, v158
    v_mfma_f32_16x16x32_bf16 v[248:251], v[40:43], a[232:235], v[248:251]
    ds_read_b64_tr_b16 v[46:47], v4 offset:30976
    v_mul_f32 v59, v159, v159
    v_mfma_f32_16x16x32_bf16 v[252:255], v[40:43], a[236:239], v[252:255]
    s_waitcnt lgkmcnt(4)
    v_fmaak_f32 v56, v56, v118, 0xc0135761
    v_fmaak_f32 v57, v57, v118, 0xc0135761
    v_mfma_f32_16x16x32_bf16 v[192:195], v[20:23], a[240:243], v[192:195]
    ds_read_b64_tr_b16 v[16:17], v1 offset:32768
    v_fmaak_f32 v58, v58, v118, 0xc0135761
    v_mfma_f32_16x16x32_bf16 v[196:199], v[20:23], a[244:247], v[196:199]
    v_fmaak_f32 v59, v59, v118, 0xc0135761
    v_mul_f32 v56, v56, v156
    v_mfma_f32_16x16x32_bf16 v[200:203], v[20:23], a[248:251], v[200:203]
    ds_read_b64_tr_b16 v[18:19], v1 offset:33024
    v_mul_f32 v57, v57, v157
    v_mfma_f32_16x16x32_bf16 v[204:207], v[20:23], a[252:255], v[204:207]
    v_exp_f32 v60, v56
    v_mfma_f32_16x16x32_bf16 v[208:211], v[28:31], a[240:243], v[208:211]
    ds_read_b64_tr_b16 v[24:25], v2 offset:32768
    v_mul_f32 v58, v58, v158
    v_mfma_f32_16x16x32_bf16 v[212:215], v[28:31], a[244:247], v[212:215]
    v_exp_f32 v61, v57
    v_mfma_f32_16x16x32_bf16 v[216:219], v[28:31], a[248:251], v[216:219]
    ds_read_b64_tr_b16 v[26:27], v2 offset:33024
    v_mul_f32 v59, v59, v159
    v_mfma_f32_16x16x32_bf16 v[220:223], v[28:31], a[252:255], v[220:223]
    s_waitcnt lgkmcnt(4)
    v_exp_f32 v62, v58
    v_mfma_f32_16x16x32_bf16 v[224:227], v[36:39], a[240:243], v[224:227]
    ds_read_b64_tr_b16 v[32:33], v3 offset:32768
    v_mul_f32 v56, v156, v188
    v_mfma_f32_16x16x32_bf16 v[228:231], v[36:39], a[244:247], v[228:231]
    v_exp_f32 v63, v59
    v_mfma_f32_16x16x32_bf16 v[232:235], v[36:39], a[248:251], v[232:235]
    ds_read_b64_tr_b16 v[34:35], v3 offset:33024
    v_mul_f32 v57, v157, v189
    v_mfma_f32_16x16x32_bf16 v[236:239], v[36:39], a[252:255], v[236:239]
    v_mul_f32 v58, v158, v190
    v_mul_f32 v59, v159, v191
    v_mfma_f32_16x16x32_bf16 v[240:243], v[44:47], a[240:243], v[240:243]
    ds_read_b64_tr_b16 v[40:41], v4 offset:32768
    v_add_f32 v60, 1.0, v60
    v_mfma_f32_16x16x32_bf16 v[244:247], v[44:47], a[244:247], v[244:247]
    v_rcp_f32 v60, v60
    v_mfma_f32_16x16x32_bf16 v[248:251], v[44:47], a[248:251], v[248:251]
    ds_read_b64_tr_b16 v[42:43], v4 offset:33024
    v_add_f32 v61, 1.0, v61
    v_mfma_f32_16x16x32_bf16 v[252:255], v[44:47], a[252:255], v[252:255]
    s_waitcnt lgkmcnt(4)
    v_rcp_f32 v61, v61
    v_mfma_f32_16x16x32_bf16 v[192:195], v[16:19], v[80:83], v[192:195]
    ds_read_b64_tr_b16 v[20:21], v1 offset:34816
    v_add_f32 v62, 1.0, v62
    v_mfma_f32_16x16x32_bf16 v[196:199], v[16:19], v[84:87], v[196:199]
    v_rcp_f32 v62, v62
    v_mfma_f32_16x16x32_bf16 v[200:203], v[16:19], v[88:91], v[200:203]
    ds_read_b64_tr_b16 v[22:23], v1 offset:35072
    v_add_f32 v63, 1.0, v63
    v_mfma_f32_16x16x32_bf16 v[204:207], v[16:19], v[92:95], v[204:207]
    v_rcp_f32 v63, v63
    v_mul_f32 v56, v56, v60
    v_mfma_f32_16x16x32_bf16 v[208:211], v[24:27], v[80:83], v[208:211]
    ds_read_b64_tr_b16 v[28:29], v2 offset:34816
    v_mul_f32 v57, v57, v61
    v_mfma_f32_16x16x32_bf16 v[212:215], v[24:27], v[84:87], v[212:215]
    v_mul_f32 v58, v58, v62
    v_mul_f32 v59, v59, v63
    v_mfma_f32_16x16x32_bf16 v[216:219], v[24:27], v[88:91], v[216:219]
    ds_read_b64_tr_b16 v[30:31], v2 offset:35072
    v_cvt_pk_bf16_f32 v78, v56, v57
    v_mfma_f32_16x16x32_bf16 v[220:223], v[24:27], v[92:95], v[220:223]
    s_waitcnt lgkmcnt(4)
    v_cvt_pk_bf16_f32 v79, v58, v59
    s_add_u32 s52, s49, 442368
    v_mfma_f32_16x16x32_bf16 v[224:227], v[32:35], v[80:83], v[224:227]
    ds_read_b64_tr_b16 v[36:37], v3 offset:34816
    v_mfma_f32_16x16x32_bf16 v[228:231], v[32:35], v[84:87], v[228:231]
    buffer_store_dwordx4 v[76:79], v15, s[24:27], s52 offen sc1
    v_mfma_f32_16x16x32_bf16 v[232:235], v[32:35], v[88:91], v[232:235]
    ds_read_b64_tr_b16 v[38:39], v3 offset:35072
    v_mfma_f32_16x16x32_bf16 v[236:239], v[32:35], v[92:95], v[236:239]
    v_mfma_f32_16x16x32_bf16 v[240:243], v[40:43], v[80:83], v[240:243]
    ds_read_b64_tr_b16 v[44:45], v4 offset:34816
    v_mfma_f32_16x16x32_bf16 v[244:247], v[40:43], v[84:87], v[244:247]
    v_mfma_f32_16x16x32_bf16 v[248:251], v[40:43], v[88:91], v[248:251]
    ds_read_b64_tr_b16 v[46:47], v4 offset:35072
    v_mfma_f32_16x16x32_bf16 v[252:255], v[40:43], v[92:95], v[252:255]
    s_waitcnt lgkmcnt(4)
    v_mfma_f32_16x16x32_bf16 v[192:195], v[20:23], v[96:99], v[192:195]
    v_mfma_f32_16x16x32_bf16 v[196:199], v[20:23], v[100:103], v[196:199]
    v_mfma_f32_16x16x32_bf16 v[200:203], v[20:23], v[104:107], v[200:203]
    v_mfma_f32_16x16x32_bf16 v[204:207], v[20:23], v[108:111], v[204:207]
    s_waitcnt vmcnt(4) lgkmcnt(0)
    s_barrier
    v_mfma_f32_16x16x32_bf16 v[208:211], v[28:31], v[96:99], v[208:211]
    ds_read_b64_tr_b16 v[16:17], v5 offset:0
    v_mfma_f32_16x16x32_bf16 v[212:215], v[28:31], v[100:103], v[212:215]
    ds_read_b64_tr_b16 v[18:19], v5 offset:256
    v_mfma_f32_16x16x32_bf16 v[216:219], v[28:31], v[104:107], v[216:219]
    ds_read_b64_tr_b16 v[24:25], v6 offset:0
    v_mfma_f32_16x16x32_bf16 v[220:223], v[28:31], v[108:111], v[220:223]
    ds_read_b64_tr_b16 v[26:27], v6 offset:256
    v_mfma_f32_16x16x32_bf16 v[224:227], v[36:39], v[96:99], v[224:227]
    ds_read_b64_tr_b16 v[32:33], v7 offset:0
    v_mfma_f32_16x16x32_bf16 v[228:231], v[36:39], v[100:103], v[228:231]
    ds_read_b64_tr_b16 v[34:35], v7 offset:256
    v_mfma_f32_16x16x32_bf16 v[232:235], v[36:39], v[104:107], v[232:235]
    ds_read_b64_tr_b16 v[40:41], v8 offset:0
    v_mfma_f32_16x16x32_bf16 v[236:239], v[36:39], v[108:111], v[236:239]
    ds_read_b64_tr_b16 v[42:43], v8 offset:256
    v_mfma_f32_16x16x32_bf16 v[240:243], v[44:47], v[96:99], v[240:243]
    v_mfma_f32_16x16x32_bf16 v[244:247], v[44:47], v[100:103], v[244:247]
    v_mfma_f32_16x16x32_bf16 v[248:251], v[44:47], v[104:107], v[248:251]
    v_mfma_f32_16x16x32_bf16 v[252:255], v[44:47], v[108:111], v[252:255]
    v_swap_b32 v1, v5
    v_swap_b32 v2, v6
    v_swap_b32 v3, v7
    v_swap_b32 v4, v8
    s_xor_b32 s48, s48, s54
    s_mov_b32 s49, s73
    s_mov_b32 s73, s74
    s_cmp_eq_u32 s51, 0
    s_cbranch_scc1 L_k1_f2_ffn
    s_mov_b64 s[32:33], s[12:13]
    s_mov_b32 s34, s14
    v_mov_b32 v9, v12
    s_mov_b32 s46, 221184
    s_mul_i32 s44, s40, 55296
    s_lshl_b32 s52, s58, 6
    s_add_u32 s44, s44, s52
    s_mov_b64 s[36:37], s[76:77]
    s_mov_b32 s38, s78
    v_mov_b32 v10, v15
    s_mov_b32 s47, 4096
    s_mov_b32 s45, s75
    s_getpc_b64 s[68:69]
L_k1_pc2:
    s_add_u32 s68, s68, L_k1_qk1 - L_k1_pc2
    s_addc_u32 s69, s69, 0
    s_mov_b32 s70, L_code_end - L_k1_qk1
    v_lshlrev_b32 v115, 7, v0
    s_lshl_b32 s99, s57, 12
    s_mov_b32 s101, 1073741824
    v_bfe_u32 v124, v0, 2, 2
    v_lshl_add_u32 v123, v13, 2, v124
    v_mul_u32_u24 v123, 1152, v123
    v_and_b32 v124, 3, v0
    v_lshl_add_u32 v116, v124, 3, v123
    s_branch L_k1_f2_go
L_k1_f2_ffn:
    s_mul_i32 s44, s40, 147456
    s_lshl_b32 s52, s50, 6
    s_add_u32 s44, s44, s52
    s_mov_b32 s45, s44
    s_lshl_b32 s52, s50, 10
    s_add_u32 s74, s72, s52
    s_add_u32 s50, s50, 28
    s_lshl_b32 s99, s50, 6
L_k1_f2_go:
    s_waitcnt lgkmcnt(4)
    v_mfma_f32_16x16x32_bf16 v[128:131], v[16:19], a[0:3], 0
    ds_read_b64_tr_b16 v[20:21], v1 offset:2048
    v_mfma_f32_16x16x32_bf16 v[132:135], v[16:19], a[4:7], 0
    v_mfma_f32_16x16x32_bf16 v[136:139], v[16:19], a[8:11], 0
    ds_read_b64_tr_b16 v[22:23], v1 offset:2304
    v_mfma_f32_16x16x32_bf16 v[140:143], v[16:19], a[12:15], 0
    s_add_u32 m0, s48, 0
    v_mfma_f32_16x16x32_bf16 v[144:147], v[24:27], a[0:3], 0
    ds_read_b64_tr_b16 v[28:29], v2 offset:2048
    v_mfma_f32_16x16x32_bf16 v[148:151], v[24:27], a[4:7], 0
    buffer_load_dwordx4 v9, s[32:35], s44 offen lds
    v_mfma_f32_16x16x32_bf16 v[152:155], v[24:27], a[8:11], 0
    ds_read_b64_tr_b16 v[30:31], v2 offset:2304
    v_mfma_f32_16x16x32_bf16 v[156:159], v[24:27], a[12:15], 0
    s_waitcnt lgkmcnt(4)
    s_add_u32 s44, s44, s46
    v_mfma_f32_16x16x32_bf16 v[160:163], v[32:35], a[0:3], 0
    ds_read_b64_tr_b16 v[36:37], v3 offset:2048
    v_mul_f32 v48, v192, v192
    v_mfma_f32_16x16x32_bf16 v[164:167], v[32:35], a[4:7], 0
    v_mul_f32 v49, v193, v193
    v_mul_f32 v50, v194, v194
    v_mfma_f32_16x16x32_bf16 v[168:171], v[32:35], a[8:11], 0
    ds_read_b64_tr_b16 v[38:39], v3 offset:2304
    v_mul_f32 v51, v195, v195
    v_mfma_f32_16x16x32_bf16 v[172:175], v[32:35], a[12:15], 0
    v_fmaak_f32 v48, v48, v118, 0xc0135761
    v_fmaak_f32 v49, v49, v118, 0xc0135761
    v_mfma_f32_16x16x32_bf16 v[176:179], v[40:43], a[0:3], 0
    ds_read_b64_tr_b16 v[44:45], v4 offset:2048
    v_fmaak_f32 v50, v50, v118, 0xc0135761
    v_mfma_f32_16x16x32_bf16 v[180:183], v[40:43], a[4:7], 0
    s_add_u32 m0, s48, 36864
    v_fmaak_f32 v51, v51, v118, 0xc0135761
    v_mul_f32 v48, v48, v192
    v_mfma_f32_16x16x32_bf16 v[184:187], v[40:43], a[8:11], 0
    ds_read_b64_tr_b16 v[46:47], v4 offset:2304
    v_mul_f32 v49, v49, v193
    v_mfma_f32_16x16x32_bf16 v[188:191], v[40:43], a[12:15], 0
    s_waitcnt lgkmcnt(4)
    buffer_load_dwordx4 v10, s[36:39], s45 offen lds
    v_mfma_f32_16x16x32_bf16 v[128:131], v[20:23], a[16:19], v[128:131]
    ds_read_b64_tr_b16 v[16:17], v1 offset:4096
    v_mul_f32 v50, v50, v194
    v_mfma_f32_16x16x32_bf16 v[132:135], v[20:23], a[20:23], v[132:135]
    s_add_u32 s45, s45, s47
    v_exp_f32 v52, v48
    v_mfma_f32_16x16x32_bf16 v[136:139], v[20:23], a[24:27], v[136:139]
    ds_read_b64_tr_b16 v[18:19], v1 offset:4352
    v_mul_f32 v51, v51, v195
    v_mfma_f32_16x16x32_bf16 v[140:143], v[20:23], a[28:31], v[140:143]
    v_exp_f32 v53, v49
    v_mfma_f32_16x16x32_bf16 v[144:147], v[28:31], a[16:19], v[144:147]
    ds_read_b64_tr_b16 v[24:25], v2 offset:4096
    v_mul_f32 v48, v192, v224
    v_mfma_f32_16x16x32_bf16 v[148:151], v[28:31], a[20:23], v[148:151]
    v_exp_f32 v54, v50
    v_mfma_f32_16x16x32_bf16 v[152:155], v[28:31], a[24:27], v[152:155]
    ds_read_b64_tr_b16 v[26:27], v2 offset:4352
    v_mul_f32 v49, v193, v225
    v_mfma_f32_16x16x32_bf16 v[156:159], v[28:31], a[28:31], v[156:159]
    s_waitcnt lgkmcnt(4)
    s_add_u32 m0, s48, 4096
    v_mul_f32 v50, v194, v226
    v_mfma_f32_16x16x32_bf16 v[160:163], v[36:39], a[16:19], v[160:163]
    ds_read_b64_tr_b16 v[32:33], v3 offset:4096
    v_add_f32 v52, 1.0, v52
    v_mfma_f32_16x16x32_bf16 v[164:167], v[36:39], a[20:23], v[164:167]
    buffer_load_dwordx4 v9, s[32:35], s44 offen lds
    v_mfma_f32_16x16x32_bf16 v[168:171], v[36:39], a[24:27], v[168:171]
    ds_read_b64_tr_b16 v[34:35], v3 offset:4352
    v_add_f32 v53, 1.0, v53
    v_mfma_f32_16x16x32_bf16 v[172:175], v[36:39], a[28:31], v[172:175]
    s_add_u32 s44, s44, s46
    v_exp_f32 v55, v51
    v_mfma_f32_16x16x32_bf16 v[176:179], v[44:47], a[16:19], v[176:179]
    ds_read_b64_tr_b16 v[40:41], v4 offset:4096
    v_mul_f32 v51, v195, v227
    v_mfma_f32_16x16x32_bf16 v[180:183], v[44:47], a[20:23], v[180:183]
    v_rcp_f32 v52, v52
    v_mfma_f32_16x16x32_bf16 v[184:187], v[44:47], a[24:27], v[184:187]
    ds_read_b64_tr_b16 v[42:43], v4 offset:4352
    v_add_f32 v54, 1.0, v54
    v_mfma_f32_16x16x32_bf16 v[188:191], v[44:47], a[28:31], v[188:191]
    s_waitcnt lgkmcnt(4)
    v_rcp_f32 v53, v53
    v_mfma_f32_16x16x32_bf16 v[128:131], v[16:19], a[32:35], v[128:131]
    ds_read_b64_tr_b16 v[20:21], v1 offset:6144
    v_add_f32 v55, 1.0, v55
    v_mfma_f32_16x16x32_bf16 v[132:135], v[16:19], a[36:39], v[132:135]
    s_add_u32 m0, s48, 40960
    v_rcp_f32 v54, v54
    v_mfma_f32_16x16x32_bf16 v[136:139], v[16:19], a[40:43], v[136:139]
    ds_read_b64_tr_b16 v[22:23], v1 offset:6400
    v_mul_f32 v48, v48, v52
    v_mfma_f32_16x16x32_bf16 v[140:143], v[16:19], a[44:47], v[140:143]
    buffer_load_dwordx4 v10, s[36:39], s45 offen lds
    v_mfma_f32_16x16x32_bf16 v[144:147], v[24:27], a[32:35], v[144:147]
    ds_read_b64_tr_b16 v[28:29], v2 offset:6144
    v_mul_f32 v49, v49, v53
    v_mfma_f32_16x16x32_bf16 v[148:151], v[24:27], a[36:39], v[148:151]
    s_add_u32 s45, s45, s47
    v_rcp_f32 v55, v55
    v_mfma_f32_16x16x32_bf16 v[152:155], v[24:27], a[40:43], v[152:155]
    ds_read_b64_tr_b16 v[30:31], v2 offset:6400
    v_mul_f32 v50, v50, v54
    v_mfma_f32_16x16x32_bf16 v[156:159], v[24:27], a[44:47], v[156:159]
    s_waitcnt lgkmcnt(4)
    v_mul_f32 v51, v51, v55
    v_cvt_pk_bf16_f32 v72, v48, v49
    v_mul_f32 v56, v208, v208
    v_mfma_f32_16x16x32_bf16 v[160:163], v[32:35], a[32:35], v[160:163]
    ds_read_b64_tr_b16 v[36:37], v3 offset:6144
    v_cvt_pk_bf16_f32 v73, v50, v51
    v_mfma_f32_16x16x32_bf16 v[164:167], v[32:35], a[36:39], v[164:167]
    v_mul_f32 v57, v209, v209
    v_mul_f32 v58, v210, v210
    v_mfma_f32_16x16x32_bf16 v[168:171], v[32:35], a[40:43], v[168:171]
    ds_read_b64_tr_b16 v[38:39], v3 offset:6400
    v_mul_f32 v59, v211, v211
    v_mfma_f32_16x16x32_bf16 v[172:175], v[32:35], a[44:47], v[172:175]
    s_add_u32 m0, s48, 8192
    v_fmaak_f32 v56, v56, v118, 0xc0135761
    v_fmaak_f32 v57, v57, v118, 0xc0135761
    v_mfma_f32_16x16x32_bf16 v[176:179], v[40:43], a[32:35], v[176:179]
    ds_read_b64_tr_b16 v[44:45], v4 offset:6144
    v_fmaak_f32 v58, v58, v118, 0xc0135761
    v_mfma_f32_16x16x32_bf16 v[180:183], v[40:43], a[36:39], v[180:183]
    buffer_load_dwordx4 v9, s[32:35], s44 offen lds
    v_mfma_f32_16x16x32_bf16 v[184:187], v[40:43], a[40:43], v[184:187]
    ds_read_b64_tr_b16 v[46:47], v4 offset:6400
    v_fmaak_f32 v59, v59, v118, 0xc0135761
    v_mfma_f32_16x16x32_bf16 v[188:191], v[40:43], a[44:47], v[188:191]
    s_waitcnt lgkmcnt(4)
    s_add_u32 s44, s44, s46
    v_mul_f32 v56, v56, v208
    v_mfma_f32_16x16x32_bf16 v[128:131], v[20:23], a[48:51], v[128:131]
    ds_read_b64_tr_b16 v[16:17], v1 offset:8192
    v_mul_f32 v57, v57, v209
    v_mfma_f32_16x16x32_bf16 v[132:135], v[20:23], a[52:55], v[132:135]
    v_exp_f32 v60, v56
    v_mfma_f32_16x16x32_bf16 v[136:139], v[20:23], a[56:59], v[136:139]
    ds_read_b64_tr_b16 v[18:19], v1 offset:8448
    v_mul_f32 v58, v58, v210
    v_mfma_f32_16x16x32_bf16 v[140:143], v[20:23], a[60:63], v[140:143]
    v_exp_f32 v61, v57
    v_mfma_f32_16x16x32_bf16 v[144:147], v[28:31], a[48:51], v[144:147]
    ds_read_b64_tr_b16 v[24:25], v2 offset:8192
    v_mul_f32 v59, v59, v211
    v_mfma_f32_16x16x32_bf16 v[148:151], v[28:31], a[52:55], v[148:151]
    s_add_u32 m0, s48, 45056
    v_exp_f32 v62, v58
    v_mfma_f32_16x16x32_bf16 v[152:155], v[28:31], a[56:59], v[152:155]
    ds_read_b64_tr_b16 v[26:27], v2 offset:8448
    v_mul_f32 v56, v208, v240
    v_mfma_f32_16x16x32_bf16 v[156:159], v[28:31], a[60:63], v[156:159]
    s_waitcnt lgkmcnt(4)
    buffer_load_dwordx4 v10, s[36:39], s45 offen lds
    v_mfma_f32_16x16x32_bf16 v[160:163], v[36:39], a[48:51], v[160:163]
    ds_read_b64_tr_b16 v[32:33], v3 offset:8192
    v_mul_f32 v57, v209, v241
    v_mfma_f32_16x16x32_bf16 v[164:167], v[36:39], a[52:55], v[164:167]
    s_add_u32 s45, s45, s47
    v_exp_f32 v63, v59
    v_mfma_f32_16x16x32_bf16 v[168:171], v[36:39], a[56:59], v[168:171]
    ds_read_b64_tr_b16 v[34:35], v3 offset:8448
    v_mul_f32 v58, v210, v242
    v_mfma_f32_16x16x32_bf16 v[172:175], v[36:39], a[60:63], v[172:175]
    v_mul_f32 v59, v211, v243
    v_add_f32 v60, 1.0, v60
    v_mfma_f32_16x16x32_bf16 v[176:179], v[44:47], a[48:51], v[176:179]
    ds_read_b64_tr_b16 v[40:41], v4 offset:8192
    v_add_f32 v61, 1.0, v61
    v_mfma_f32_16x16x32_bf16 v[180:183], v[44:47], a[52:55], v[180:183]
    v_rcp_f32 v60, v60
    v_mfma_f32_16x16x32_bf16 v[184:187], v[44:47], a[56:59], v[184:187]
    ds_read_b64_tr_b16 v[42:43], v4 offset:8448
    v_add_f32 v62, 1.0, v62
    v_mfma_f32_16x16x32_bf16 v[188:191], v[44:47], a[60:63], v[188:191]
    s_waitcnt lgkmcnt(4)
    s_add_u32 m0, s48, 12288
    v_add_f32 v63, 1.0, v63
    v_mfma_f32_16x16x32_bf16 v[128:131], v[16:19], a[64:67], v[128:131]
    ds_read_b64_tr_b16 v[20:21], v1 offset:10240
    v_mul_f32 v56, v56, v60
    v_mfma_f32_16x16x32_bf16 v[132:135], v[16:19], a[68:71], v[132:135]
    buffer_load_dwordx4 v9, s[32:35], s44 offen lds
    v_mfma_f32_16x16x32_bf16 v[136:139], v[16:19], a[72:75], v[136:139]
    ds_read_b64_tr_b16 v[22:23], v1 offset:10496
    v_mul_f32 v64, v196, v196
    v_mfma_f32_16x16x32_bf16 v[140:143], v[16:19], a[76:79], v[140:143]
    s_add_u32 s44, s44, s46
    v_rcp_f32 v61, v61
    v_mfma_f32_16x16x32_bf16 v[144:147], v[24:27], a[64:67], v[144:147]
    ds_read_b64_tr_b16 v[28:29], v2 offset:10240
    v_mul_f32 v57, v57, v61
    v_mfma_f32_16x16x32_bf16 v[148:151], v[24:27], a[68:71], v[148:151]
    v_rcp_f32 v62, v62
    v_mfma_f32_16x16x32_bf16 v[152:155], v[24:27], a[72:75], v[152:155]
    ds_read_b64_tr_b16 v[30:31], v2 offset:10496
    v_rcp_f32 v63, v63
    v_mfma_f32_16x16x32_bf16 v[156:159], v[24:27], a[76:79], v[156:159]
    s_waitcnt lgkmcnt(4)
    v_mul_f32 v58, v58, v62
    v_mul_f32 v59, v59, v63
    v_mfma_f32_16x16x32_bf16 v[160:163], v[32:35], a[64:67], v[160:163]
    ds_read_b64_tr_b16 v[36:37], v3 offset:10240
    v_cvt_pk_bf16_f32 v74, v56, v57
    v_mfma_f32_16x16x32_bf16 v[164:167], v[32:35], a[68:71], v[164:167]
    s_add_u32 m0, s48, 49152
    v_cvt_pk_bf16_f32 v75, v58, v59
    v_mul_f32 v65, v197, v197
    v_mfma_f32_16x16x32_bf16 v[168:171], v[32:35], a[72:75], v[168:171]
    ds_read_b64_tr_b16 v[38:39], v3 offset:10496
    v_mul_f32 v66, v198, v198
    v_mfma_f32_16x16x32_bf16 v[172:175], v[32:35], a[76:79], v[172:175]
    buffer_load_dwordx4 v10, s[36:39], s45 offen lds
    v_mfma_f32_16x16x32_bf16 v[176:179], v[40:43], a[64:67], v[176:179]
    ds_read_b64_tr_b16 v[44:45], v4 offset:10240
    v_mul_f32 v67, v199, v199
    v_mfma_f32_16x16x32_bf16 v[180:183], v[40:43], a[68:71], v[180:183]
    s_add_u32 s45, s45, s47
    buffer_store_dwordx4 v[72:75], v15, s[24:27], s49 offen sc1
    v_mfma_f32_16x16x32_bf16 v[184:187], v[40:43], a[72:75], v[184:187]
    ds_read_b64_tr_b16 v[46:47], v4 offset:10496
    v_fmaak_f32 v64, v64, v118, 0xc0135761
    v_mfma_f32_16x16x32_bf16 v[188:191], v[40:43], a[76:79], v[188:191]
    s_waitcnt lgkmcnt(4)
    v_fmaak_f32 v65, v65, v118, 0xc0135761
    v_fmaak_f32 v66, v66, v118, 0xc0135761
    v_mfma_f32_16x16x32_bf16 v[128:131], v[20:23], a[80:83], v[128:131]
    ds_read_b64_tr_b16 v[16:17], v1 offset:12288
    v_fmaak_f32 v67, v67, v118, 0xc0135761
    v_mfma_f32_16x16x32_bf16 v[132:135], v[20:23], a[84:87], v[132:135]
    v_mul_f32 v64, v64, v196
    v_mul_f32 v65, v65, v197
    v_mfma_f32_16x16x32_bf16 v[136:139], v[20:23], a[88:91], v[136:139]
    ds_read_b64_tr_b16 v[18:19], v1 offset:12544
    v_mul_f32 v66, v66, v198
    v_mfma_f32_16x16x32_bf16 v[140:143], v[20:23], a[92:95], v[140:143]
    s_add_u32 m0, s48, 16384
    v_exp_f32 v68, v64
    v_mfma_f32_16x16x32_bf16 v[144:147], v[28:31], a[80:83], v[144:147]
    ds_read_b64_tr_b16 v[24:25], v2 offset:12288
    v_mul_f32 v67, v67, v199
    v_mfma_f32_16x16x32_bf16 v[148:151], v[28:31], a[84:87], v[148:151]
    buffer_load_dwordx4 v9, s[32:35], s44 offen lds
    v_mfma_f32_16x16x32_bf16 v[152:155], v[28:31], a[88:91], v[152:155]
    ds_read_b64_tr_b16 v[26:27], v2 offset:12544
    v_mul_f32 v64, v196, v228
    v_mfma_f32_16x16x32_bf16 v[156:159], v[28:31], a[92:95], v[156:159]
    s_waitcnt lgkmcnt(4)
    s_add_u32 s44, s44, s46
    v_add_f32 v68, 1.0, v68
    v_mfma_f32_16x16x32_bf16 v[160:163], v[36:39], a[80:83], v[160:163]
    ds_read_b64_tr_b16 v[32:33], v3 offset:12288
    v_mul_f32 v48, v212, v212
    v_mfma_f32_16x16x32_bf16 v[164:167], v[36:39], a[84:87], v[164:167]
    v_exp_f32 v69, v65
    v_mfma_f32_16x16x32_bf16 v[168:171], v[36:39], a[88:91], v[168:171]
    ds_read_b64_tr_b16 v[34:35], v3 offset:12544
    v_mul_f32 v65, v197, v229
    v_mfma_f32_16x16x32_bf16 v[172:175], v[36:39], a[92:95], v[172:175]
    v_exp_f32 v70, v66
    v_mfma_f32_16x16x32_bf16 v[176:179], v[44:47], a[80:83], v[176:179]
    ds_read_b64_tr_b16 v[40:41], v4 offset:12288
    v_mul_f32 v66, v198, v230
    v_mfma_f32_16x16x32_bf16 v[180:183], v[44:47], a[84:87], v[180:183]
    s_add_u32 m0, s48, 53248
    v_exp_f32 v71, v67
    v_mfma_f32_16x16x32_bf16 v[184:187], v[44:47], a[88:91], v[184:187]
    ds_read_b64_tr_b16 v[42:43], v4 offset:12544
    v_mul_f32 v67, v199, v231
    v_mfma_f32_16x16x32_bf16 v[188:191], v[44:47], a[92:95], v[188:191]
    s_waitcnt lgkmcnt(4)
    buffer_load_dwordx4 v10, s[36:39], s45 offen lds
    v_mfma_f32_16x16x32_bf16 v[128:131], v[16:19], a[96:99], v[128:131]
    ds_read_b64_tr_b16 v[20:21], v1 offset:14336
    v_add_f32 v69, 1.0, v69
    v_mfma_f32_16x16x32_bf16 v[132:135], v[16:19], a[100:103], v[132:135]
    s_add_u32 s45, s45, s47
    v_rcp_f32 v68, v68
    v_mfma_f32_16x16x32_bf16 v[136:139], v[16:19], a[104:107], v[136:139]
    ds_read_b64_tr_b16 v[22:23], v1 offset:14592
    v_add_f32 v70, 1.0, v70
    v_mfma_f32_16x16x32_bf16 v[140:143], v[16:19], a[108:111], v[140:143]
    v_rcp_f32 v69, v69
    v_mfma_f32_16x16x32_bf16 v[144:147], v[24:27], a[96:99], v[144:147]
    ds_read_b64_tr_b16 v[28:29], v2 offset:14336
    v_add_f32 v71, 1.0, v71
    v_mfma_f32_16x16x32_bf16 v[148:151], v[24:27], a[100:103], v[148:151]
    v_rcp_f32 v70, v70
    v_mfma_f32_16x16x32_bf16 v[152:155], v[24:27], a[104:107], v[152:155]
    ds_read_b64_tr_b16 v[30:31], v2 offset:14592
    v_rcp_f32 v71, v71
    v_mfma_f32_16x16x32_bf16 v[156:159], v[24:27], a[108:111], v[156:159]
    s_waitcnt lgkmcnt(4)
    s_add_u32 m0, s48, 20480
    v_mul_f32 v64, v64, v68
    v_mfma_f32_16x16x32_bf16 v[160:163], v[32:35], a[96:99], v[160:163]
    ds_read_b64_tr_b16 v[36:37], v3 offset:14336
    v_mul_f32 v65, v65, v69
    v_mfma_f32_16x16x32_bf16 v[164:167], v[32:35], a[100:103], v[164:167]
    buffer_load_dwordx4 v9, s[32:35], s44 offen lds
    v_mfma_f32_16x16x32_bf16 v[168:171], v[32:35], a[104:107], v[168:171]
    ds_read_b64_tr_b16 v[38:39], v3 offset:14592
    v_mul_f32 v66, v66, v70
    v_mfma_f32_16x16x32_bf16 v[172:175], v[32:35], a[108:111], v[172:175]
    s_add_u32 s44, s44, s46
    v_mul_f32 v67, v67, v71
    v_cvt_pk_bf16_f32 v76, v64, v65
    v_mfma_f32_16x16x32_bf16 v[176:179], v[40:43], a[96:99], v[176:179]
    ds_read_b64_tr_b16 v[44:45], v4 offset:14336
    v_cvt_pk_bf16_f32 v77, v66, v67
    v_mfma_f32_16x16x32_bf16 v[180:183], v[40:43], a[100:103], v[180:183]
    v_mul_f32 v49, v213, v213
    v_mul_f32 v50, v214, v214
    v_mfma_f32_16x16x32_bf16 v[184:187], v[40:43], a[104:107], v[184:187]
    ds_read_b64_tr_b16 v[46:47], v4 offset:14592
    v_mul_f32 v51, v215, v215
    v_mfma_f32_16x16x32_bf16 v[188:191], v[40:43], a[108:111], v[188:191]
    s_waitcnt lgkmcnt(4)
    v_fmaak_f32 v48, v48, v118, 0xc0135761
    v_fmaak_f32 v49, v49, v118, 0xc0135761
    v_mfma_f32_16x16x32_bf16 v[128:131], v[20:23], a[112:115], v[128:131]
    ds_read_b64_tr_b16 v[16:17], v1 offset:16384
    v_fmaak_f32 v50, v50, v118, 0xc0135761
    v_mfma_f32_16x16x32_bf16 v[132:135], v[20:23], a[116:119], v[132:135]
    s_add_u32 m0, s48, 57344
    v_fmaak_f32 v51, v51, v118, 0xc0135761
    v_mul_f32 v48, v48, v212
    v_mfma_f32_16x16x32_bf16 v[136:139], v[20:23], a[120:123], v[136:139]
    ds_read_b64_tr_b16 v[18:19], v1 offset:16640
    v_mul_f32 v49, v49, v213
    v_mfma_f32_16x16x32_bf16 v[140:143], v[20:23], a[124:127], v[140:143]
    buffer_load_dwordx4 v10, s[36:39], s45 offen lds
    v_mfma_f32_16x16x32_bf16 v[144:147], v[28:31], a[112:115], v[144:147]
    ds_read_b64_tr_b16 v[24:25], v2 offset:16384
    v_mul_f32 v50, v50, v214
    v_mfma_f32_16x16x32_bf16 v[148:151], v[28:31], a[116:119], v[148:151]
    s_add_u32 s45, s45, s47
    v_exp_f32 v52, v48
    v_mfma_f32_16x16x32_bf16 v[152:155], v[28:31], a[120:123], v[152:155]
    ds_read_b64_tr_b16 v[26:27], v2 offset:16640
    v_mul_f32 v51, v51, v215
    v_mfma_f32_16x16x32_bf16 v[156:159], v[28:31], a[124:127], v[156:159]
    s_waitcnt lgkmcnt(4)
    v_exp_f32 v53, v49
    v_mfma_f32_16x16x32_bf16 v[160:163], v[36:39], a[112:115], v[160:163]
    ds_read_b64_tr_b16 v[32:33], v3 offset:16384
    v_mul_f32 v48, v212, v244
    v_mfma_f32_16x16x32_bf16 v[164:167], v[36:39], a[116:119], v[164:167]
    v_exp_f32 v54, v50
    v_mfma_f32_16x16x32_bf16 v[168:171], v[36:39], a[120:123], v[168:171]
    ds_read_b64_tr_b16 v[34:35], v3 offset:16640
    v_mul_f32 v49, v213, v245
    v_mfma_f32_16x16x32_bf16 v[172:175], v[36:39], a[124:127], v[172:175]
    s_add_u32 m0, s48, 24576
    v_exp_f32 v55, v51
    v_mfma_f32_16x16x32_bf16 v[176:179], v[44:47], a[112:115], v[176:179]
    ds_read_b64_tr_b16 v[40:41], v4 offset:16384
    v_mul_f32 v50, v214, v246
    v_mfma_f32_16x16x32_bf16 v[180:183], v[44:47], a[116:119], v[180:183]
    buffer_load_dwordx4 v9, s[32:35], s44 offen lds
    v_mfma_f32_16x16x32_bf16 v[184:187], v[44:47], a[120:123], v[184:187]
    ds_read_b64_tr_b16 v[42:43], v4 offset:16640
    v_mul_f32 v51, v215, v247
    v_mfma_f32_16x16x32_bf16 v[188:191], v[44:47], a[124:127], v[188:191]
    s_waitcnt lgkmcnt(4)
    s_add_u32 s44, s44, s46
    v_add_f32 v52, 1.0, v52
    v_mfma_f32_16x16x32_bf16 v[128:131], v[16:19], a[128:131], v[128:131]
    ds_read_b64_tr_b16 v[20:21], v1 offset:18432
    v_add_f32 v53, 1.0, v53
    v_mfma_f32_16x16x32_bf16 v[132:135], v[16:19], a[132:135], v[132:135]
    v_rcp_f32 v52, v52
    v_mfma_f32_16x16x32_bf16 v[136:139], v[16:19], a[136:139], v[136:139]
    ds_read_b64_tr_b16 v[22:23], v1 offset:18688
    v_add_f32 v54, 1.0, v54
    v_mfma_f32_16x16x32_bf16 v[140:143], v[16:19], a[140:143], v[140:143]
    v_rcp_f32 v53, v53
    v_mfma_f32_16x16x32_bf16 v[144:147], v[24:27], a[128:131], v[144:147]
    ds_read_b64_tr_b16 v[28:29], v2 offset:18432
    v_add_f32 v55, 1.0, v55
    v_mfma_f32_16x16x32_bf16 v[148:151], v[24:27], a[132:135], v[148:151]
    s_add_u32 m0, s48, 61440
    v_rcp_f32 v54, v54
    v_mul_f32 v48, v48, v52
    v_mfma_f32_16x16x32_bf16 v[152:155], v[24:27], a[136:139], v[152:155]
    ds_read_b64_tr_b16 v[30:31], v2 offset:18688
    v_mul_f32 v49, v49, v53
    v_mfma_f32_16x16x32_bf16 v[156:159], v[24:27], a[140:143], v[156:159]
    s_waitcnt lgkmcnt(4)
    buffer_load_dwordx4 v10, s[36:39], s45 offen lds
    v_mfma_f32_16x16x32_bf16 v[160:163], v[32:35], a[128:131], v[160:163]
    ds_read_b64_tr_b16 v[36:37], v3 offset:18432
    v_mul_f32 v50, v50, v54
    v_mfma_f32_16x16x32_bf16 v[164:167], v[32:35], a[132:135], v[164:167]
    s_add_u32 s45, s45, s47
    v_rcp_f32 v55, v55
    v_mfma_f32_16x16x32_bf16 v[168:171], v[32:35], a[136:139], v[168:171]
    ds_read_b64_tr_b16 v[38:39], v3 offset:18688
    v_mul_f32 v51, v51, v55
    v_mfma_f32_16x16x32_bf16 v[172:175], v[32:35], a[140:143], v[172:175]
    v_cvt_pk_bf16_f32 v78, v48, v49
    v_cvt_pk_bf16_f32 v79, v50, v51
    v_mfma_f32_16x16x32_bf16 v[176:179], v[40:43], a[128:131], v[176:179]
    ds_read_b64_tr_b16 v[44:45], v4 offset:18432
    s_add_u32 s52, s49, 147456
    v_mfma_f32_16x16x32_bf16 v[180:183], v[40:43], a[132:135], v[180:183]
    buffer_store_dwordx4 v[76:79], v15, s[24:27], s52 offen sc1
    v_mfma_f32_16x16x32_bf16 v[184:187], v[40:43], a[136:139], v[184:187]
    ds_read_b64_tr_b16 v[46:47], v4 offset:18688
    v_mul_f32 v56, v200, v200
    v_mfma_f32_16x16x32_bf16 v[188:191], v[40:43], a[140:143], v[188:191]
    s_waitcnt lgkmcnt(4)
    s_add_u32 m0, s48, 28672
    v_mul_f32 v57, v201, v201
    v_mfma_f32_16x16x32_bf16 v[128:131], v[20:23], a[144:147], v[128:131]
    ds_read_b64_tr_b16 v[16:17], v1 offset:20480
    v_mul_f32 v58, v202, v202
    v_mfma_f32_16x16x32_bf16 v[132:135], v[20:23], a[148:151], v[132:135]
    buffer_load_dwordx4 v9, s[32:35], s44 offen lds
    v_mfma_f32_16x16x32_bf16 v[136:139], v[20:23], a[152:155], v[136:139]
    ds_read_b64_tr_b16 v[18:19], v1 offset:20736
    v_mul_f32 v59, v203, v203
    v_mfma_f32_16x16x32_bf16 v[140:143], v[20:23], a[156:159], v[140:143]
    s_add_u32 s44, s44, s46
    v_fmaak_f32 v56, v56, v118, 0xc0135761
    v_fmaak_f32 v57, v57, v118, 0xc0135761
    v_mfma_f32_16x16x32_bf16 v[144:147], v[28:31], a[144:147], v[144:147]
    ds_read_b64_tr_b16 v[24:25], v2 offset:20480
    v_fmaak_f32 v58, v58, v118, 0xc0135761
    v_mfma_f32_16x16x32_bf16 v[148:151], v[28:31], a[148:151], v[148:151]
    v_fmaak_f32 v59, v59, v118, 0xc0135761
    v_mul_f32 v56, v56, v200
    v_mfma_f32_16x16x32_bf16 v[152:155], v[28:31], a[152:155], v[152:155]
    ds_read_b64_tr_b16 v[26:27], v2 offset:20736
    v_mul_f32 v57, v57, v201
    v_mfma_f32_16x16x32_bf16 v[156:159], v[28:31], a[156:159], v[156:159]
    s_waitcnt lgkmcnt(4)
    v_exp_f32 v60, v56
    v_mfma_f32_16x16x32_bf16 v[160:163], v[36:39], a[144:147], v[160:163]
    ds_read_b64_tr_b16 v[32:33], v3 offset:20480
    v_mul_f32 v58, v58, v202
    v_mfma_f32_16x16x32_bf16 v[164:167], v[36:39], a[148:151], v[164:167]
    s_add_u32 m0, s48, 65536
    v_exp_f32 v61, v57
    v_mfma_f32_16x16x32_bf16 v[168:171], v[36:39], a[152:155], v[168:171]
    ds_read_b64_tr_b16 v[34:35], v3 offset:20736
    v_mul_f32 v59, v59, v203
    v_mfma_f32_16x16x32_bf16 v[172:175], v[36:39], a[156:159], v[172:175]
    buffer_load_dwordx4 v10, s[36:39], s45 offen lds
    v_mfma_f32_16x16x32_bf16 v[176:179], v[44:47], a[144:147], v[176:179]
    ds_read_b64_tr_b16 v[40:41], v4 offset:20480
    v_mul_f32 v56, v200, v232
    v_mfma_f32_16x16x32_bf16 v[180:183], v[44:47], a[148:151], v[180:183]
    s_add_u32 s45, s45, s47
    v_exp_f32 v62, v58
    v_mfma_f32_16x16x32_bf16 v[184:187], v[44:47], a[152:155], v[184:187]
    ds_read_b64_tr_b16 v[42:43], v4 offset:20736
    v_mul_f32 v57, v201, v233
    v_mfma_f32_16x16x32_bf16 v[188:191], v[44:47], a[156:159], v[188:191]
    s_waitcnt lgkmcnt(4)
    v_exp_f32 v63, v59
    v_mfma_f32_16x16x32_bf16 v[128:131], v[16:19], a[160:163], v[128:131]
    ds_read_b64_tr_b16 v[20:21], v1 offset:22528
    v_mul_f32 v58, v202, v234
    v_mfma_f32_16x16x32_bf16 v[132:135], v[16:19], a[164:167], v[132:135]
    v_mul_f32 v59, v203, v235
    v_add_f32 v60, 1.0, v60
    v_mfma_f32_16x16x32_bf16 v[136:139], v[16:19], a[168:171], v[136:139]
    ds_read_b64_tr_b16 v[22:23], v1 offset:22784
    v_add_f32 v61, 1.0, v61
    v_mfma_f32_16x16x32_bf16 v[140:143], v[16:19], a[172:175], v[140:143]
    s_add_u32 m0, s48, 32768
    v_rcp_f32 v60, v60
    v_mfma_f32_16x16x32_bf16 v[144:147], v[24:27], a[160:163], v[144:147]
    ds_read_b64_tr_b16 v[28:29], v2 offset:22528
    v_add_f32 v62, 1.0, v62
    v_mfma_f32_16x16x32_bf16 v[148:151], v[24:27], a[164:167], v[148:151]
    buffer_load_dwordx4 v9, s[32:35], s44 offen lds
    v_add_f32 v63, 1.0, v63
    v_mfma_f32_16x16x32_bf16 v[152:155], v[24:27], a[168:171], v[152:155]
    ds_read_b64_tr_b16 v[30:31], v2 offset:22784
    v_mul_f32 v56, v56, v60
    v_mfma_f32_16x16x32_bf16 v[156:159], v[24:27], a[172:175], v[156:159]
    s_waitcnt lgkmcnt(4)
    s_add_u32 s44, s44, s46
    v_mul_f32 v64, v216, v216
    v_mfma_f32_16x16x32_bf16 v[160:163], v[32:35], a[160:163], v[160:163]
    ds_read_b64_tr_b16 v[36:37], v3 offset:22528
    v_mul_f32 v65, v217, v217
    v_mfma_f32_16x16x32_bf16 v[164:167], v[32:35], a[164:167], v[164:167]
    v_rcp_f32 v61, v61
    v_mfma_f32_16x16x32_bf16 v[168:171], v[32:35], a[168:171], v[168:171]
    ds_read_b64_tr_b16 v[38:39], v3 offset:22784
    v_mul_f32 v57, v57, v61
    v_mfma_f32_16x16x32_bf16 v[172:175], v[32:35], a[172:175], v[172:175]
    v_rcp_f32 v62, v62
    v_mfma_f32_16x16x32_bf16 v[176:179], v[40:43], a[160:163], v[176:179]
    ds_read_b64_tr_b16 v[44:45], v4 offset:22528
    v_mul_f32 v58, v58, v62
    v_mfma_f32_16x16x32_bf16 v[180:183], v[40:43], a[164:167], v[180:183]
    s_add_u32 m0, s48, 69632
    v_rcp_f32 v63, v63
    v_mfma_f32_16x16x32_bf16 v[184:187], v[40:43], a[168:171], v[184:187]
    ds_read_b64_tr_b16 v[46:47], v4 offset:22784
    v_mul_f32 v59, v59, v63
    v_mfma_f32_16x16x32_bf16 v[188:191], v[40:43], a[172:175], v[188:191]
    s_waitcnt lgkmcnt(4)
    buffer_load_dwordx4 v10, s[36:39], s45 offen lds
    v_mfma_f32_16x16x32_bf16 v[128:131], v[20:23], a[176:179], v[128:131]
    ds_read_b64_tr_b16 v[16:17], v1 offset:24576
    v_cvt_pk_bf16_f32 v72, v56, v57
    v_mfma_f32_16x16x32_bf16 v[132:135], v[20:23], a[180:183], v[132:135]
    s_add_u32 s45, s45, s47
    v_cvt_pk_bf16_f32 v73, v58, v59
    v_mul_f32 v66, v218, v218
    v_mfma_f32_16x16x32_bf16 v[136:139], v[20:23], a[184:187], v[136:139]
    ds_read_b64_tr_b16 v[18:19], v1 offset:24832
    v_mul_f32 v67, v219, v219
    v_mfma_f32_16x16x32_bf16 v[140:143], v[20:23], a[188:191], v[140:143]
    v_fmaak_f32 v64, v64, v118, 0xc0135761
    v_fmaak_f32 v65, v65, v118, 0xc0135761
    v_mfma_f32_16x16x32_bf16 v[144:147], v[28:31], a[176:179], v[144:147]
    ds_read_b64_tr_b16 v[24:25], v2 offset:24576
    v_fmaak_f32 v66, v66, v118, 0xc0135761
    v_mfma_f32_16x16x32_bf16 v[148:151], v[28:31], a[180:183], v[148:151]
    v_fmaak_f32 v67, v67, v118, 0xc0135761
    v_mul_f32 v64, v64, v216
    v_mfma_f32_16x16x32_bf16 v[152:155], v[28:31], a[184:187], v[152:155]
    ds_read_b64_tr_b16 v[26:27], v2 offset:24832
    v_mul_f32 v65, v65, v217
    v_mfma_f32_16x16x32_bf16 v[156:159], v[28:31], a[188:191], v[156:159]
    s_waitcnt lgkmcnt(4)
    v_exp_f32 v68, v64
    v_mfma_f32_16x16x32_bf16 v[160:163], v[36:39], a[176:179], v[160:163]
    ds_read_b64_tr_b16 v[32:33], v3 offset:24576
    v_mul_f32 v66, v66, v218
    v_mfma_f32_16x16x32_bf16 v[164:167], v[36:39], a[180:183], v[164:167]
    buffer_load_dword v114, v115, s[68:71], s99 offen
    v_mfma_f32_16x16x32_bf16 v[168:171], v[36:39], a[184:187], v[168:171]
    ds_read_b64_tr_b16 v[34:35], v3 offset:24832
    v_mul_f32 v67, v67, v219
    v_mfma_f32_16x16x32_bf16 v[172:175], v[36:39], a[188:191], v[172:175]
    buffer_load_dword v114, v117, s[76:79], s101 offen
    v_mfma_f32_16x16x32_bf16 v[176:179], v[44:47], a[176:179], v[176:179]
    ds_read_b64_tr_b16 v[40:41], v4 offset:24576
    v_mul_f32 v64, v216, v248
    v_mfma_f32_16x16x32_bf16 v[180:183], v[44:47], a[180:183], v[180:183]
    v_exp_f32 v69, v65
    v_mfma_f32_16x16x32_bf16 v[184:187], v[44:47], a[184:187], v[184:187]
    ds_read_b64_tr_b16 v[42:43], v4 offset:24832
    v_mul_f32 v65, v217, v249
    v_mfma_f32_16x16x32_bf16 v[188:191], v[44:47], a[188:191], v[188:191]
    s_waitcnt lgkmcnt(4)
    s_add_u32 s101, s101, 3072
    v_add_f32 v68, 1.0, v68
    v_mfma_f32_16x16x32_bf16 v[128:131], v[16:19], a[192:195], v[128:131]
    ds_read_b64_tr_b16 v[20:21], v1 offset:26624
    v_add_f32 v69, 1.0, v69
    v_mfma_f32_16x16x32_bf16 v[132:135], v[16:19], a[196:199], v[132:135]
    v_exp_f32 v70, v66
    v_mfma_f32_16x16x32_bf16 v[136:139], v[16:19], a[200:203], v[136:139]
    ds_read_b64_tr_b16 v[22:23], v1 offset:26880
    v_mul_f32 v66, v218, v250
    v_mfma_f32_16x16x32_bf16 v[140:143], v[16:19], a[204:207], v[140:143]
    v_exp_f32 v71, v67
    v_mfma_f32_16x16x32_bf16 v[144:147], v[24:27], a[192:195], v[144:147]
    ds_read_b64_tr_b16 v[28:29], v2 offset:26624
    v_rcp_f32 v68, v68
    v_mfma_f32_16x16x32_bf16 v[148:151], v[24:27], a[196:199], v[148:151]
    v_rcp_f32 v69, v69
    v_mfma_f32_16x16x32_bf16 v[152:155], v[24:27], a[200:203], v[152:155]
    ds_read_b64_tr_b16 v[30:31], v2 offset:26880
    v_mul_f32 v67, v219, v251
    v_mfma_f32_16x16x32_bf16 v[156:159], v[24:27], a[204:207], v[156:159]
    s_waitcnt lgkmcnt(4)
    v_add_f32 v70, 1.0, v70
    v_add_f32 v71, 1.0, v71
    v_mfma_f32_16x16x32_bf16 v[160:163], v[32:35], a[192:195], v[160:163]
    ds_read_b64_tr_b16 v[36:37], v3 offset:26624
    v_mul_f32 v64, v64, v68
    v_mfma_f32_16x16x32_bf16 v[164:167], v[32:35], a[196:199], v[164:167]
    v_rcp_f32 v70, v70
    v_mfma_f32_16x16x32_bf16 v[168:171], v[32:35], a[200:203], v[168:171]
    ds_read_b64_tr_b16 v[38:39], v3 offset:26880
    v_mul_f32 v65, v65, v69
    v_mfma_f32_16x16x32_bf16 v[172:175], v[32:35], a[204:207], v[172:175]
    v_rcp_f32 v71, v71
    v_mfma_f32_16x16x32_bf16 v[176:179], v[40:43], a[192:195], v[176:179]
    ds_read_b64_tr_b16 v[44:45], v4 offset:26624
    v_mul_f32 v66, v66, v70
    v_mfma_f32_16x16x32_bf16 v[180:183], v[40:43], a[196:199], v[180:183]
    v_mul_f32 v67, v67, v71
    v_cvt_pk_bf16_f32 v74, v64, v65
    v_mfma_f32_16x16x32_bf16 v[184:187], v[40:43], a[200:203], v[184:187]
    ds_read_b64_tr_b16 v[46:47], v4 offset:26880
    v_cvt_pk_bf16_f32 v75, v66, v67
    v_mfma_f32_16x16x32_bf16 v[188:191], v[40:43], a[204:207], v[188:191]
    s_waitcnt lgkmcnt(4)
    s_add_u32 s52, s49, 294912
    v_mul_f32 v48, v204, v204
    v_mfma_f32_16x16x32_bf16 v[128:131], v[20:23], a[208:211], v[128:131]
    ds_read_b64_tr_b16 v[16:17], v1 offset:28672
    v_mul_f32 v49, v205, v205
    v_mfma_f32_16x16x32_bf16 v[132:135], v[20:23], a[212:215], v[132:135]
    buffer_store_dwordx4 v[72:75], v15, s[24:27], s52 offen sc1
    v_mfma_f32_16x16x32_bf16 v[136:139], v[20:23], a[216:219], v[136:139]
    ds_read_b64_tr_b16 v[18:19], v1 offset:28928
    v_mul_f32 v50, v206, v206
    v_mfma_f32_16x16x32_bf16 v[140:143], v[20:23], a[220:223], v[140:143]
    v_mul_f32 v51, v207, v207
    v_fmaak_f32 v48, v48, v118, 0xc0135761
    v_mfma_f32_16x16x32_bf16 v[144:147], v[28:31], a[208:211], v[144:147]
    ds_read_b64_tr_b16 v[24:25], v2 offset:28672
    v_fmaak_f32 v49, v49, v118, 0xc0135761
    v_mfma_f32_16x16x32_bf16 v[148:151], v[28:31], a[212:215], v[148:151]
    v_fmaak_f32 v50, v50, v118, 0xc0135761
    v_fmaak_f32 v51, v51, v118, 0xc0135761
    v_mfma_f32_16x16x32_bf16 v[152:155], v[28:31], a[216:219], v[152:155]
    ds_read_b64_tr_b16 v[26:27], v2 offset:28928
    v_mul_f32 v48, v48, v204
    v_mfma_f32_16x16x32_bf16 v[156:159], v[28:31], a[220:223], v[156:159]
    s_waitcnt lgkmcnt(4)
    v_exp_f32 v52, v48
    v_mfma_f32_16x16x32_bf16 v[160:163], v[36:39], a[208:211], v[160:163]
    ds_read_b64_tr_b16 v[32:33], v3 offset:28672
    v_mul_f32 v49, v49, v205
    v_mfma_f32_16x16x32_bf16 v[164:167], v[36:39], a[212:215], v[164:167]
    v_exp_f32 v53, v49
    v_mfma_f32_16x16x32_bf16 v[168:171], v[36:39], a[216:219], v[168:171]
    ds_read_b64_tr_b16 v[34:35], v3 offset:28928
    v_mul_f32 v50, v50, v206
    v_mfma_f32_16x16x32_bf16 v[172:175], v[36:39], a[220:223], v[172:175]
    v_exp_f32 v54, v50
    v_mfma_f32_16x16x32_bf16 v[176:179], v[44:47], a[208:211], v[176:179]
    ds_read_b64_tr_b16 v[40:41], v4 offset:28672
    v_mul_f32 v51, v51, v207
    v_mfma_f32_16x16x32_bf16 v[180:183], v[44:47], a[212:215], v[180:183]
    v_exp_f32 v55, v51
    v_mfma_f32_16x16x32_bf16 v[184:187], v[44:47], a[216:219], v[184:187]
    ds_read_b64_tr_b16 v[42:43], v4 offset:28928
    v_mul_f32 v48, v204, v236
    v_mfma_f32_16x16x32_bf16 v[188:191], v[44:47], a[220:223], v[188:191]
    s_waitcnt lgkmcnt(4)
    v_mul_f32 v49, v205, v237
    v_mul_f32 v50, v206, v238
    v_mfma_f32_16x16x32_bf16 v[128:131], v[16:19], a[224:227], v[128:131]
    ds_read_b64_tr_b16 v[20:21], v1 offset:30720
    v_mul_f32 v51, v207, v239
    v_mfma_f32_16x16x32_bf16 v[132:135], v[16:19], a[228:231], v[132:135]
    v_add_f32 v52, 1.0, v52
    v_add_f32 v53, 1.0, v53
    v_mfma_f32_16x16x32_bf16 v[136:139], v[16:19], a[232:235], v[136:139]
    ds_read_b64_tr_b16 v[22:23], v1 offset:30976
    v_add_f32 v54, 1.0, v54
    v_mfma_f32_16x16x32_bf16 v[140:143], v[16:19], a[236:239], v[140:143]
    v_rcp_f32 v52, v52
    v_mfma_f32_16x16x32_bf16 v[144:147], v[24:27], a[224:227], v[144:147]
    ds_read_b64_tr_b16 v[28:29], v2 offset:30720
    v_rcp_f32 v53, v53
    v_mfma_f32_16x16x32_bf16 v[148:151], v[24:27], a[228:231], v[148:151]
    v_rcp_f32 v54, v54
    v_mfma_f32_16x16x32_bf16 v[152:155], v[24:27], a[232:235], v[152:155]
    ds_read_b64_tr_b16 v[30:31], v2 offset:30976
    v_add_f32 v55, 1.0, v55
    v_mfma_f32_16x16x32_bf16 v[156:159], v[24:27], a[236:239], v[156:159]
    s_waitcnt lgkmcnt(4)
    v_rcp_f32 v55, v55
    v_mfma_f32_16x16x32_bf16 v[160:163], v[32:35], a[224:227], v[160:163]
    ds_read_b64_tr_b16 v[36:37], v3 offset:30720
    v_mul_f32 v48, v48, v52
    v_mfma_f32_16x16x32_bf16 v[164:167], v[32:35], a[228:231], v[164:167]
    v_mul_f32 v49, v49, v53
    v_mul_f32 v50, v50, v54
    v_mfma_f32_16x16x32_bf16 v[168:171], v[32:35], a[232:235], v[168:171]
    ds_read_b64_tr_b16 v[38:39], v3 offset:30976
    v_mul_f32 v51, v51, v55
    v_mfma_f32_16x16x32_bf16 v[172:175], v[32:35], a[236:239], v[172:175]
    v_cvt_pk_bf16_f32 v76, v48, v49
    v_cvt_pk_bf16_f32 v77, v50, v51
    v_mfma_f32_16x16x32_bf16 v[176:179], v[40:43], a[224:227], v[176:179]
    ds_read_b64_tr_b16 v[44:45], v4 offset:30720
    v_mul_f32 v56, v220, v220
    v_mfma_f32_16x16x32_bf16 v[180:183], v[40:43], a[228:231], v[180:183]
    v_mul_f32 v57, v221, v221
    v_mul_f32 v58, v222, v222
    v_mfma_f32_16x16x32_bf16 v[184:187], v[40:43], a[232:235], v[184:187]
    ds_read_b64_tr_b16 v[46:47], v4 offset:30976
    v_mul_f32 v59, v223, v223
    v_mfma_f32_16x16x32_bf16 v[188:191], v[40:43], a[236:239], v[188:191]
    s_waitcnt lgkmcnt(4)
    v_fmaak_f32 v56, v56, v118, 0xc0135761
    v_fmaak_f32 v57, v57, v118, 0xc0135761
    v_mfma_f32_16x16x32_bf16 v[128:131], v[20:23], a[240:243], v[128:131]
    ds_read_b64_tr_b16 v[16:17], v1 offset:32768
    v_fmaak_f32 v58, v58, v118, 0xc0135761
    v_mfma_f32_16x16x32_bf16 v[132:135], v[20:23], a[244:247], v[132:135]
    v_fmaak_f32 v59, v59, v118, 0xc0135761
    v_mul_f32 v56, v56, v220
    v_mfma_f32_16x16x32_bf16 v[136:139], v[20:23], a[248:251], v[136:139]
    ds_read_b64_tr_b16 v[18:19], v1 offset:33024
    v_mul_f32 v57, v57, v221
    v_mfma_f32_16x16x32_bf16 v[140:143], v[20:23], a[252:255], v[140:143]
    v_exp_f32 v60, v56
    v_mfma_f32_16x16x32_bf16 v[144:147], v[28:31], a[240:243], v[144:147]
    ds_read_b64_tr_b16 v[24:25], v2 offset:32768
    v_mul_f32 v58, v58, v222
    v_mfma_f32_16x16x32_bf16 v[148:151], v[28:31], a[244:247], v[148:151]
    v_exp_f32 v61, v57
    v_mfma_f32_16x16x32_bf16 v[152:155], v[28:31], a[248:251], v[152:155]
    ds_read_b64_tr_b16 v[26:27], v2 offset:33024
    v_mul_f32 v59, v59, v223
    v_mfma_f32_16x16x32_bf16 v[156:159], v[28:31], a[252:255], v[156:159]
    s_waitcnt lgkmcnt(4)
    v_exp_f32 v62, v58
    v_mfma_f32_16x16x32_bf16 v[160:163], v[36:39], a[240:243], v[160:163]
    ds_read_b64_tr_b16 v[32:33], v3 offset:32768
    v_mul_f32 v56, v220, v252
    v_mfma_f32_16x16x32_bf16 v[164:167], v[36:39], a[244:247], v[164:167]
    v_exp_f32 v63, v59
    v_mfma_f32_16x16x32_bf16 v[168:171], v[36:39], a[248:251], v[168:171]
    ds_read_b64_tr_b16 v[34:35], v3 offset:33024
    v_mul_f32 v57, v221, v253
    v_mfma_f32_16x16x32_bf16 v[172:175], v[36:39], a[252:255], v[172:175]
    v_mul_f32 v58, v222, v254
    v_mul_f32 v59, v223, v255
    v_mfma_f32_16x16x32_bf16 v[176:179], v[44:47], a[240:243], v[176:179]
    ds_read_b64_tr_b16 v[40:41], v4 offset:32768
    v_add_f32 v60, 1.0, v60
    v_mfma_f32_16x16x32_bf16 v[180:183], v[44:47], a[244:247], v[180:183]
    v_rcp_f32 v60, v60
    v_mfma_f32_16x16x32_bf16 v[184:187], v[44:47], a[248:251], v[184:187]
    ds_read_b64_tr_b16 v[42:43], v4 offset:33024
    v_add_f32 v61, 1.0, v61
    v_mfma_f32_16x16x32_bf16 v[188:191], v[44:47], a[252:255], v[188:191]
    s_waitcnt lgkmcnt(4)
    v_rcp_f32 v61, v61
    v_mfma_f32_16x16x32_bf16 v[128:131], v[16:19], v[80:83], v[128:131]
    ds_read_b64_tr_b16 v[20:21], v1 offset:34816
    v_add_f32 v62, 1.0, v62
    v_mfma_f32_16x16x32_bf16 v[132:135], v[16:19], v[84:87], v[132:135]
    v_rcp_f32 v62, v62
    v_mfma_f32_16x16x32_bf16 v[136:139], v[16:19], v[88:91], v[136:139]
    ds_read_b64_tr_b16 v[22:23], v1 offset:35072
    v_add_f32 v63, 1.0, v63
    v_mfma_f32_16x16x32_bf16 v[140:143], v[16:19], v[92:95], v[140:143]
    v_rcp_f32 v63, v63
    v_mul_f32 v56, v56, v60
    v_mfma_f32_16x16x32_bf16 v[144:147], v[24:27], v[80:83], v[144:147]
    ds_read_b64_tr_b16 v[28:29], v2 offset:34816
    v_mul_f32 v57, v57, v61
    v_mfma_f32_16x16x32_bf16 v[148:151], v[24:27], v[84:87], v[148:151]
    v_mul_f32 v58, v58, v62
    v_mul_f32 v59, v59, v63
    v_mfma_f32_16x16x32_bf16 v[152:155], v[24:27], v[88:91], v[152:155]
    ds_read_b64_tr_b16 v[30:31], v2 offset:35072
    v_cvt_pk_bf16_f32 v78, v56, v57
    v_mfma_f32_16x16x32_bf16 v[156:159], v[24:27], v[92:95], v[156:159]
    s_waitcnt lgkmcnt(4)
    v_cvt_pk_bf16_f32 v79, v58, v59
    s_add_u32 s52, s49, 442368
    v_mfma_f32_16x16x32_bf16 v[160:163], v[32:35], v[80:83], v[160:163]
    ds_read_b64_tr_b16 v[36:37], v3 offset:34816
    v_mfma_f32_16x16x32_bf16 v[164:167], v[32:35], v[84:87], v[164:167]
    buffer_store_dwordx4 v[76:79], v15, s[24:27], s52 offen sc1
    v_mfma_f32_16x16x32_bf16 v[168:171], v[32:35], v[88:91], v[168:171]
    ds_read_b64_tr_b16 v[38:39], v3 offset:35072
    v_mfma_f32_16x16x32_bf16 v[172:175], v[32:35], v[92:95], v[172:175]
    v_mfma_f32_16x16x32_bf16 v[176:179], v[40:43], v[80:83], v[176:179]
    ds_read_b64_tr_b16 v[44:45], v4 offset:34816
    v_mfma_f32_16x16x32_bf16 v[180:183], v[40:43], v[84:87], v[180:183]
    v_mfma_f32_16x16x32_bf16 v[184:187], v[40:43], v[88:91], v[184:187]
    ds_read_b64_tr_b16 v[46:47], v4 offset:35072
    v_mfma_f32_16x16x32_bf16 v[188:191], v[40:43], v[92:95], v[188:191]
    s_waitcnt lgkmcnt(4)
    v_mfma_f32_16x16x32_bf16 v[128:131], v[20:23], v[96:99], v[128:131]
    v_mfma_f32_16x16x32_bf16 v[132:135], v[20:23], v[100:103], v[132:135]
    v_mfma_f32_16x16x32_bf16 v[136:139], v[20:23], v[104:107], v[136:139]
    v_mfma_f32_16x16x32_bf16 v[140:143], v[20:23], v[108:111], v[140:143]
    s_waitcnt vmcnt(4) lgkmcnt(0)
    s_barrier
    v_mfma_f32_16x16x32_bf16 v[144:147], v[28:31], v[96:99], v[144:147]
    ds_read_b64_tr_b16 v[16:17], v5 offset:0
    v_mfma_f32_16x16x32_bf16 v[148:151], v[28:31], v[100:103], v[148:151]
    ds_read_b64_tr_b16 v[18:19], v5 offset:256
    v_mfma_f32_16x16x32_bf16 v[152:155], v[28:31], v[104:107], v[152:155]
    ds_read_b64_tr_b16 v[24:25], v6 offset:0
    v_mfma_f32_16x16x32_bf16 v[156:159], v[28:31], v[108:111], v[156:159]
    ds_read_b64_tr_b16 v[26:27], v6 offset:256
    v_mfma_f32_16x16x32_bf16 v[160:163], v[36:39], v[96:99], v[160:163]
    ds_read_b64_tr_b16 v[32:33], v7 offset:0
    v_mfma_f32_16x16x32_bf16 v[164:167], v[36:39], v[100:103], v[164:167]
    ds_read_b64_tr_b16 v[34:35], v7 offset:256
    v_mfma_f32_16x16x32_bf16 v[168:171], v[36:39], v[104:107], v[168:171]
    ds_read_b64_tr_b16 v[40:41], v8 offset:0
    v_mfma_f32_16x16x32_bf16 v[172:175], v[36:39], v[108:111], v[172:175]
    ds_read_b64_tr_b16 v[42:43], v8 offset:256
    v_mfma_f32_16x16x32_bf16 v[176:179], v[44:47], v[96:99], v[176:179]
    v_mfma_f32_16x16x32_bf16 v[180:183], v[44:47], v[100:103], v[180:183]
    v_mfma_f32_16x16x32_bf16 v[184:187], v[44:47], v[104:107], v[184:187]
    v_mfma_f32_16x16x32_bf16 v[188:191], v[44:47], v[108:111], v[188:191]
    v_swap_b32 v1, v5
    v_swap_b32 v2, v6
    v_swap_b32 v3, v7
    v_swap_b32 v4, v8
    s_xor_b32 s48, s48, s54
    s_mov_b32 s49, s73
    s_mov_b32 s73, s74
    s_add_u32 s51, s51, 1
    s_cmp_lt_u32 s51, 2
    s_cbranch_scc1 L_k1_loop
L_k1_qk1:
    s_xor_b32 s52, s48, s54
    s_mul_i32 s53, s40, -736
    s_add_u32 s52, s52, s53
    s_add_u32 s52, s52, 36864
    v_add_u32 v123, s52, v116
    s_mov_b32 s82, 5308416
    s_mul_i32 s99, s40, 8192
    s_add_u32 s99, s99, s75
    s_add_u32 s100, s99, 4096
    s_add_u32 s101, s99, 8192
    s_waitcnt lgkmcnt(6)
    v_mfma_f32_16x16x32_bf16 v[192:195], v[16:19], a[0:3], 0
    ds_read_b64_tr_b16 v[20:21], v1 offset:2048
    v_mfma_f32_16x16x32_bf16 v[196:199], v[16:19], a[4:7], 0
    ds_read_b64_tr_b16 v[224:225], v123 offset:0
    v_mfma_f32_16x16x32_bf16 v[200:203], v[16:19], a[8:11], 0
    ds_read_b64_tr_b16 v[22:23], v1 offset:2304
    v_mfma_f32_16x16x32_bf16 v[204:207], v[16:19], a[12:15], 0
    s_waitcnt lgkmcnt(7)
    v_mfma_f32_16x16x32_bf16 v[208:211], v[24:27], a[0:3], 0
    ds_read_b64_tr_b16 v[28:29], v2 offset:2048
    v_mfma_f32_16x16x32_bf16 v[212:215], v[24:27], a[4:7], 0
    ds_read_b64_tr_b16 v[226:227], v123 offset:18432
    v_mfma_f32_16x16x32_bf16 v[216:219], v[24:27], a[8:11], 0
    ds_read_b64_tr_b16 v[30:31], v2 offset:2304
    v_mfma_f32_16x16x32_bf16 v[220:223], v[24:27], a[12:15], 0
    s_waitcnt lgkmcnt(3)
    v_mfma_f32_16x16x32_bf16 v[192:195], v[20:23], a[16:19], v[192:195]
    ds_read_b64_tr_b16 v[16:17], v1 offset:4096
    v_mul_f32 v48, v128, v128
    v_mul_f32 v49, v129, v129
    v_mfma_f32_16x16x32_bf16 v[196:199], v[20:23], a[20:23], v[196:199]
    ds_read_b64_tr_b16 v[228:229], v123 offset:32
    v_mul_f32 v50, v130, v130
    v_mul_f32 v51, v131, v131
    v_fmaak_f32 v48, v48, v118, 0xc0135761
    v_mfma_f32_16x16x32_bf16 v[200:203], v[20:23], a[24:27], v[200:203]
    ds_read_b64_tr_b16 v[18:19], v1 offset:4352
    v_fmaak_f32 v49, v49, v118, 0xc0135761
    v_fmaak_f32 v50, v50, v118, 0xc0135761
    v_mfma_f32_16x16x32_bf16 v[204:207], v[20:23], a[28:31], v[204:207]
    s_waitcnt lgkmcnt(3)
    buffer_store_dwordx4 v[224:227], v15, s[80:83], s99 offen offset:0 sc1
    v_fmaak_f32 v51, v51, v118, 0xc0135761
    v_mul_f32 v48, v48, v128
    v_mfma_f32_16x16x32_bf16 v[208:211], v[28:31], a[16:19], v[208:211]
    ds_read_b64_tr_b16 v[24:25], v2 offset:4096
    v_exp_f32 v52, v48
    v_mfma_f32_16x16x32_bf16 v[212:215], v[28:31], a[20:23], v[212:215]
    ds_read_b64_tr_b16 v[230:231], v123 offset:18464
    v_mul_f32 v49, v49, v129
    v_mul_f32 v50, v50, v130
    v_mul_f32 v51, v51, v131
    v_mfma_f32_16x16x32_bf16 v[216:219], v[28:31], a[24:27], v[216:219]
    ds_read_b64_tr_b16 v[26:27], v2 offset:4352
    v_exp_f32 v53, v49
    v_mfma_f32_16x16x32_bf16 v[220:223], v[28:31], a[28:31], v[220:223]
    s_waitcnt lgkmcnt(3)
    v_exp_f32 v54, v50
    v_exp_f32 v55, v51
    v_mfma_f32_16x16x32_bf16 v[192:195], v[16:19], a[32:35], v[192:195]
    ds_read_b64_tr_b16 v[20:21], v1 offset:6144
    v_mul_f32 v48, v128, v160
    v_mul_f32 v49, v129, v161
    v_mfma_f32_16x16x32_bf16 v[196:199], v[16:19], a[36:39], v[196:199]
    ds_read_b64_tr_b16 v[232:233], v123 offset:64
    v_mul_f32 v50, v130, v162
    v_mul_f32 v51, v131, v163
    v_add_f32 v52, 1.0, v52
    v_mfma_f32_16x16x32_bf16 v[200:203], v[16:19], a[40:43], v[200:203]
    ds_read_b64_tr_b16 v[22:23], v1 offset:6400
    v_rcp_f32 v52, v52
    v_mfma_f32_16x16x32_bf16 v[204:207], v[16:19], a[44:47], v[204:207]
    s_waitcnt lgkmcnt(3)
    buffer_store_dwordx4 v[228:231], v15, s[80:83], s99 offen offset:1024 sc1
    v_add_f32 v53, 1.0, v53
    v_add_f32 v54, 1.0, v54
    v_mfma_f32_16x16x32_bf16 v[208:211], v[24:27], a[32:35], v[208:211]
    ds_read_b64_tr_b16 v[28:29], v2 offset:6144
    v_rcp_f32 v53, v53
    v_mfma_f32_16x16x32_bf16 v[212:215], v[24:27], a[36:39], v[212:215]
    ds_read_b64_tr_b16 v[234:235], v123 offset:18496
    v_rcp_f32 v54, v54
    v_add_f32 v55, 1.0, v55
    v_mfma_f32_16x16x32_bf16 v[216:219], v[24:27], a[40:43], v[216:219]
    ds_read_b64_tr_b16 v[30:31], v2 offset:6400
    v_rcp_f32 v55, v55
    v_mfma_f32_16x16x32_bf16 v[220:223], v[24:27], a[44:47], v[220:223]
    s_waitcnt lgkmcnt(3)
    v_mul_f32 v48, v48, v52
    v_mul_f32 v49, v49, v53
    v_mul_f32 v50, v50, v54
    v_mul_f32 v51, v51, v55
    v_mfma_f32_16x16x32_bf16 v[192:195], v[20:23], a[48:51], v[192:195]
    ds_read_b64_tr_b16 v[16:17], v1 offset:8192
    v_cvt_pk_bf16_f32 v72, v48, v49
    v_cvt_pk_bf16_f32 v73, v50, v51
    v_mfma_f32_16x16x32_bf16 v[196:199], v[20:23], a[52:55], v[196:199]
    ds_read_b64_tr_b16 v[236:237], v123 offset:96
    v_mul_f32 v56, v144, v144
    v_mul_f32 v57, v145, v145
    v_mul_f32 v58, v146, v146
    v_mfma_f32_16x16x32_bf16 v[200:203], v[20:23], a[56:59], v[200:203]
    ds_read_b64_tr_b16 v[18:19], v1 offset:8448
    v_mul_f32 v59, v147, v147
    v_fmaak_f32 v56, v56, v118, 0xc0135761
    v_mfma_f32_16x16x32_bf16 v[204:207], v[20:23], a[60:63], v[204:207]
    s_waitcnt lgkmcnt(3)
    buffer_store_dwordx4 v[232:235], v15, s[80:83], s99 offen offset:2048 sc1
    v_fmaak_f32 v57, v57, v118, 0xc0135761
    v_fmaak_f32 v58, v58, v118, 0xc0135761
    v_mfma_f32_16x16x32_bf16 v[208:211], v[28:31], a[48:51], v[208:211]
    ds_read_b64_tr_b16 v[24:25], v2 offset:8192
    v_fmaak_f32 v59, v59, v118, 0xc0135761
    v_mul_f32 v56, v56, v144
    v_mfma_f32_16x16x32_bf16 v[212:215], v[28:31], a[52:55], v[212:215]
    ds_read_b64_tr_b16 v[238:239], v123 offset:18528
    v_exp_f32 v60, v56
    v_mul_f32 v57, v57, v145
    v_mfma_f32_16x16x32_bf16 v[216:219], v[28:31], a[56:59], v[216:219]
    ds_read_b64_tr_b16 v[26:27], v2 offset:8448
    v_exp_f32 v61, v57
    v_mfma_f32_16x16x32_bf16 v[220:223], v[28:31], a[60:63], v[220:223]
    s_waitcnt lgkmcnt(3)
    v_mul_f32 v58, v58, v146
    v_mul_f32 v59, v59, v147
    v_mul_f32 v56, v144, v176
    v_mul_f32 v57, v145, v177
    v_mfma_f32_16x16x32_bf16 v[192:195], v[16:19], a[64:67], v[192:195]
    ds_read_b64_tr_b16 v[20:21], v1 offset:10240
    v_exp_f32 v62, v58
    v_mfma_f32_16x16x32_bf16 v[196:199], v[16:19], a[68:71], v[196:199]
    ds_read_b64_tr_b16 v[240:241], v123 offset:128
    v_exp_f32 v63, v59
    v_mul_f32 v58, v146, v178
    v_mfma_f32_16x16x32_bf16 v[200:203], v[16:19], a[72:75], v[200:203]
    ds_read_b64_tr_b16 v[22:23], v1 offset:10496
    v_mul_f32 v59, v147, v179
    v_add_f32 v60, 1.0, v60
    v_mfma_f32_16x16x32_bf16 v[204:207], v[16:19], a[76:79], v[204:207]
    s_waitcnt lgkmcnt(3)
    buffer_store_dwordx4 v[236:239], v15, s[80:83], s99 offen offset:3072 sc1
    v_rcp_f32 v60, v60
    v_mfma_f32_16x16x32_bf16 v[208:211], v[24:27], a[64:67], v[208:211]
    ds_read_b64_tr_b16 v[28:29], v2 offset:10240
    v_add_f32 v61, 1.0, v61
    v_add_f32 v62, 1.0, v62
    v_mfma_f32_16x16x32_bf16 v[212:215], v[24:27], a[68:71], v[212:215]
    ds_read_b64_tr_b16 v[242:243], v123 offset:18560
    v_rcp_f32 v61, v61
    v_add_f32 v63, 1.0, v63
    v_mfma_f32_16x16x32_bf16 v[216:219], v[24:27], a[72:75], v[216:219]
    ds_read_b64_tr_b16 v[30:31], v2 offset:10496
    v_rcp_f32 v62, v62
    v_mfma_f32_16x16x32_bf16 v[220:223], v[24:27], a[76:79], v[220:223]
    s_waitcnt lgkmcnt(3)
    v_rcp_f32 v63, v63
    v_mul_f32 v56, v56, v60
    v_mul_f32 v57, v57, v61
    v_mfma_f32_16x16x32_bf16 v[192:195], v[20:23], a[80:83], v[192:195]
    ds_read_b64_tr_b16 v[16:17], v1 offset:12288
    v_mul_f32 v58, v58, v62
    v_mul_f32 v59, v59, v63
    v_mfma_f32_16x16x32_bf16 v[196:199], v[20:23], a[84:87], v[196:199]
    ds_read_b64_tr_b16 v[244:245], v123 offset:160
    v_cvt_pk_bf16_f32 v74, v56, v57
    v_cvt_pk_bf16_f32 v75, v58, v59
    v_mul_f32 v64, v132, v132
    v_mfma_f32_16x16x32_bf16 v[200:203], v[20:23], a[88:91], v[200:203]
    ds_read_b64_tr_b16 v[18:19], v1 offset:12544
    buffer_store_dwordx4 v[72:75], v15, s[24:27], s49 offen sc1
    v_mfma_f32_16x16x32_bf16 v[204:207], v[20:23], a[92:95], v[204:207]
    s_waitcnt lgkmcnt(3)
    buffer_store_dwordx4 v[240:243], v15, s[80:83], s100 offen offset:0 sc1
    v_mul_f32 v65, v133, v133
    v_mul_f32 v66, v134, v134
    v_mfma_f32_16x16x32_bf16 v[208:211], v[28:31], a[80:83], v[208:211]
    ds_read_b64_tr_b16 v[24:25], v2 offset:12288
    v_mul_f32 v67, v135, v135
    v_fmaak_f32 v64, v64, v118, 0xc0135761
    v_mfma_f32_16x16x32_bf16 v[212:215], v[28:31], a[84:87], v[212:215]
    ds_read_b64_tr_b16 v[246:247], v123 offset:18592
    v_fmaak_f32 v65, v65, v118, 0xc0135761
    v_fmaak_f32 v66, v66, v118, 0xc0135761
    v_fmaak_f32 v67, v67, v118, 0xc0135761
    v_mfma_f32_16x16x32_bf16 v[216:219], v[28:31], a[88:91], v[216:219]
    ds_read_b64_tr_b16 v[26:27], v2 offset:12544
    v_mul_f32 v64, v64, v132
    v_mul_f32 v65, v65, v133
    v_mfma_f32_16x16x32_bf16 v[220:223], v[28:31], a[92:95], v[220:223]
    s_waitcnt lgkmcnt(3)
    v_exp_f32 v68, v64
    v_exp_f32 v69, v65
    v_mfma_f32_16x16x32_bf16 v[192:195], v[16:19], a[96:99], v[192:195]
    ds_read_b64_tr_b16 v[20:21], v1 offset:14336
    v_mul_f32 v66, v66, v134
    v_mul_f32 v67, v67, v135
    v_mfma_f32_16x16x32_bf16 v[196:199], v[16:19], a[100:103], v[196:199]
    ds_read_b64_tr_b16 v[248:249], v123 offset:192
    v_exp_f32 v70, v66
    v_mul_f32 v64, v132, v164
    v_mfma_f32_16x16x32_bf16 v[200:203], v[16:19], a[104:107], v[200:203]
    ds_read_b64_tr_b16 v[22:23], v1 offset:14592
    v_exp_f32 v71, v67
    v_mfma_f32_16x16x32_bf16 v[204:207], v[16:19], a[108:111], v[204:207]
    s_waitcnt lgkmcnt(3)
    buffer_store_dwordx4 v[244:247], v15, s[80:83], s100 offen offset:1024 sc1
    v_mul_f32 v65, v133, v165
    v_mul_f32 v66, v134, v166
    v_mfma_f32_16x16x32_bf16 v[208:211], v[24:27], a[96:99], v[208:211]
    ds_read_b64_tr_b16 v[28:29], v2 offset:14336
    v_mul_f32 v67, v135, v167
    v_add_f32 v68, 1.0, v68
    v_mfma_f32_16x16x32_bf16 v[212:215], v[24:27], a[100:103], v[212:215]
    ds_read_b64_tr_b16 v[250:251], v123 offset:18624
    v_rcp_f32 v68, v68
    v_add_f32 v69, 1.0, v69
    v_mfma_f32_16x16x32_bf16 v[216:219], v[24:27], a[104:107], v[216:219]
    ds_read_b64_tr_b16 v[30:31], v2 offset:14592
    v_rcp_f32 v69, v69
    v_mfma_f32_16x16x32_bf16 v[220:223], v[24:27], a[108:111], v[220:223]
    s_waitcnt lgkmcnt(3)
    v_add_f32 v70, 1.0, v70
    v_add_f32 v71, 1.0, v71
    v_mul_f32 v64, v64, v68
    v_mul_f32 v65, v65, v69
    v_mfma_f32_16x16x32_bf16 v[192:195], v[20:23], a[112:115], v[192:195]
    ds_read_b64_tr_b16 v[16:17], v1 offset:16384
    v_rcp_f32 v70, v70
    v_mfma_f32_16x16x32_bf16 v[196:199], v[20:23], a[116:119], v[196:199]
    ds_read_b64_tr_b16 v[252:253], v123 offset:224
    v_rcp_f32 v71, v71
    v_mul_f32 v66, v66, v70
    v_mfma_f32_16x16x32_bf16 v[200:203], v[20:23], a[120:123], v[200:203]
    ds_read_b64_tr_b16 v[18:19], v1 offset:16640
    v_mul_f32 v67, v67, v71
    v_cvt_pk_bf16_f32 v76, v64, v65
    v_mfma_f32_16x16x32_bf16 v[204:207], v[20:23], a[124:127], v[204:207]
    s_waitcnt lgkmcnt(3)
    buffer_store_dwordx4 v[248:251], v15, s[80:83], s100 offen offset:2048 sc1
    v_cvt_pk_bf16_f32 v77, v66, v67
    v_mul_f32 v48, v148, v148
    v_mfma_f32_16x16x32_bf16 v[208:211], v[28:31], a[112:115], v[208:211]
    ds_read_b64_tr_b16 v[24:25], v2 offset:16384
    v_mul_f32 v49, v149, v149
    v_mul_f32 v50, v150, v150
    v_mfma_f32_16x16x32_bf16 v[212:215], v[28:31], a[116:119], v[212:215]
    ds_read_b64_tr_b16 v[254:255], v123 offset:18656
    v_mul_f32 v51, v151, v151
    v_fmaak_f32 v48, v48, v118, 0xc0135761
    v_fmaak_f32 v49, v49, v118, 0xc0135761
    v_mfma_f32_16x16x32_bf16 v[216:219], v[28:31], a[120:123], v[216:219]
    ds_read_b64_tr_b16 v[26:27], v2 offset:16640
    v_fmaak_f32 v50, v50, v118, 0xc0135761
    v_fmaak_f32 v51, v51, v118, 0xc0135761
    v_mfma_f32_16x16x32_bf16 v[220:223], v[28:31], a[124:127], v[220:223]
    s_waitcnt lgkmcnt(3)
    v_mul_f32 v48, v48, v148
    v_mul_f32 v49, v49, v149
    v_mul_f32 v50, v50, v150
    v_mul_f32 v51, v51, v151
    v_mfma_f32_16x16x32_bf16 v[192:195], v[16:19], a[128:131], v[192:195]
    ds_read_b64_tr_b16 v[20:21], v1 offset:18432
    v_exp_f32 v52, v48
    v_mfma_f32_16x16x32_bf16 v[196:199], v[16:19], a[132:135], v[196:199]
    ds_read_b64_tr_b16 v[36:37], v123 offset:256
    v_exp_f32 v53, v49
    v_mul_f32 v48, v148, v180
    v_mfma_f32_16x16x32_bf16 v[200:203], v[16:19], a[136:139], v[200:203]
    ds_read_b64_tr_b16 v[22:23], v1 offset:18688
    v_exp_f32 v54, v50
    v_mfma_f32_16x16x32_bf16 v[204:207], v[16:19], a[140:143], v[204:207]
    s_waitcnt lgkmcnt(3)
    buffer_store_dwordx4 v[252:255], v15, s[80:83], s100 offen offset:3072 sc1
    v_exp_f32 v55, v51
    v_mfma_f32_16x16x32_bf16 v[208:211], v[24:27], a[128:131], v[208:211]
    ds_read_b64_tr_b16 v[28:29], v2 offset:18432
    v_mul_f32 v49, v149, v181
    v_mul_f32 v50, v150, v182
    v_mfma_f32_16x16x32_bf16 v[212:215], v[24:27], a[132:135], v[212:215]
    ds_read_b64_tr_b16 v[38:39], v123 offset:18688
    v_mul_f32 v51, v151, v183
    v_add_f32 v52, 1.0, v52
    v_add_f32 v53, 1.0, v53
    v_mfma_f32_16x16x32_bf16 v[216:219], v[24:27], a[136:139], v[216:219]
    ds_read_b64_tr_b16 v[30:31], v2 offset:18688
    v_rcp_f32 v52, v52
    v_mfma_f32_16x16x32_bf16 v[220:223], v[24:27], a[140:143], v[220:223]
    s_waitcnt lgkmcnt(3)
    v_rcp_f32 v53, v53
    v_add_f32 v54, 1.0, v54
    v_add_f32 v55, 1.0, v55
    v_mfma_f32_16x16x32_bf16 v[192:195], v[20:23], a[144:147], v[192:195]
    ds_read_b64_tr_b16 v[16:17], v1 offset:20480
    v_rcp_f32 v54, v54
    v_mfma_f32_16x16x32_bf16 v[196:199], v[20:23], a[148:151], v[196:199]
    v_rcp_f32 v55, v55
    v_mul_f32 v48, v48, v52
    v_mul_f32 v49, v49, v53
    v_mfma_f32_16x16x32_bf16 v[200:203], v[20:23], a[152:155], v[200:203]
    ds_read_b64_tr_b16 v[18:19], v1 offset:20736
    v_mul_f32 v50, v50, v54
    v_mul_f32 v51, v51, v55
    v_mfma_f32_16x16x32_bf16 v[204:207], v[20:23], a[156:159], v[204:207]
    s_waitcnt lgkmcnt(2)
    buffer_store_dwordx4 v[36:39], v15, s[80:83], s101 offen offset:0 sc1
    v_cvt_pk_bf16_f32 v78, v48, v49
    v_cvt_pk_bf16_f32 v79, v50, v51
    v_mfma_f32_16x16x32_bf16 v[208:211], v[28:31], a[144:147], v[208:211]
    ds_read_b64_tr_b16 v[24:25], v2 offset:20480
    s_add_u32 s52, s49, 147456
    v_mul_f32 v56, v136, v136
    v_mfma_f32_16x16x32_bf16 v[212:215], v[28:31], a[148:151], v[212:215]
    buffer_store_dwordx4 v[76:79], v15, s[24:27], s52 offen sc1
    v_mul_f32 v57, v137, v137
    v_mul_f32 v58, v138, v138
    v_mfma_f32_16x16x32_bf16 v[216:219], v[28:31], a[152:155], v[216:219]
    ds_read_b64_tr_b16 v[26:27], v2 offset:20736
    v_mul_f32 v59, v139, v139
    v_fmaak_f32 v56, v56, v118, 0xc0135761
    v_mfma_f32_16x16x32_bf16 v[220:223], v[28:31], a[156:159], v[220:223]
    s_waitcnt lgkmcnt(2)
    v_fmaak_f32 v57, v57, v118, 0xc0135761
    v_fmaak_f32 v58, v58, v118, 0xc0135761
    v_fmaak_f32 v59, v59, v118, 0xc0135761
    v_mul_f32 v56, v56, v136
    v_mfma_f32_16x16x32_bf16 v[192:195], v[16:19], a[160:163], v[192:195]
    ds_read_b64_tr_b16 v[20:21], v1 offset:22528
    v_exp_f32 v60, v56
    v_mfma_f32_16x16x32_bf16 v[196:199], v[16:19], a[164:167], v[196:199]
    v_mul_f32 v57, v57, v137
    v_mul_f32 v58, v58, v138
    v_mul_f32 v59, v59, v139
    v_mul_f32 v56, v136, v168
    v_mfma_f32_16x16x32_bf16 v[200:203], v[16:19], a[168:171], v[200:203]
    ds_read_b64_tr_b16 v[22:23], v1 offset:22784
    v_exp_f32 v61, v57
    v_mfma_f32_16x16x32_bf16 v[204:207], v[16:19], a[172:175], v[204:207]
    s_waitcnt lgkmcnt(2)
    v_exp_f32 v62, v58
    v_exp_f32 v63, v59
    v_mfma_f32_16x16x32_bf16 v[208:211], v[24:27], a[160:163], v[208:211]
    ds_read_b64_tr_b16 v[28:29], v2 offset:22528
    v_mul_f32 v57, v137, v169
    v_mul_f32 v58, v138, v170
    v_mfma_f32_16x16x32_bf16 v[212:215], v[24:27], a[164:167], v[212:215]
    v_mul_f32 v59, v139, v171
    v_add_f32 v60, 1.0, v60
    v_add_f32 v61, 1.0, v61
    v_add_f32 v62, 1.0, v62
    v_mfma_f32_16x16x32_bf16 v[216:219], v[24:27], a[168:171], v[216:219]
    ds_read_b64_tr_b16 v[30:31], v2 offset:22784
    v_rcp_f32 v60, v60
    v_mfma_f32_16x16x32_bf16 v[220:223], v[24:27], a[172:175], v[220:223]
    s_waitcnt lgkmcnt(2)
    v_rcp_f32 v61, v61
    v_rcp_f32 v62, v62
    v_mfma_f32_16x16x32_bf16 v[192:195], v[20:23], a[176:179], v[192:195]
    ds_read_b64_tr_b16 v[16:17], v1 offset:24576
    v_add_f32 v63, 1.0, v63
    v_mul_f32 v56, v56, v60
    v_mfma_f32_16x16x32_bf16 v[196:199], v[20:23], a[180:183], v[196:199]
    v_rcp_f32 v63, v63
    v_mul_f32 v57, v57, v61
    v_mul_f32 v58, v58, v62
    v_mfma_f32_16x16x32_bf16 v[200:203], v[20:23], a[184:187], v[200:203]
    ds_read_b64_tr_b16 v[18:19], v1 offset:24832
    v_mul_f32 v59, v59, v63
    v_cvt_pk_bf16_f32 v72, v56, v57
    v_mfma_f32_16x16x32_bf16 v[204:207], v[20:23], a[188:191], v[204:207]
    s_waitcnt lgkmcnt(2)
    v_cvt_pk_bf16_f32 v73, v58, v59
    v_mul_f32 v64, v152, v152
    v_mul_f32 v65, v153, v153
    v_mul_f32 v66, v154, v154
    v_mfma_f32_16x16x32_bf16 v[208:211], v[28:31], a[176:179], v[208:211]
    ds_read_b64_tr_b16 v[24:25], v2 offset:24576
    v_mul_f32 v67, v155, v155
    v_fmaak_f32 v64, v64, v118, 0xc0135761
    v_mfma_f32_16x16x32_bf16 v[212:215], v[28:31], a[180:183], v[212:215]
    v_fmaak_f32 v65, v65, v118, 0xc0135761
    v_fmaak_f32 v66, v66, v118, 0xc0135761
    v_fmaak_f32 v67, v67, v118, 0xc0135761
    v_mul_f32 v64, v64, v152
    v_mfma_f32_16x16x32_bf16 v[216:219], v[28:31], a[184:187], v[216:219]
    ds_read_b64_tr_b16 v[26:27], v2 offset:24832
    v_exp_f32 v68, v64
    v_mfma_f32_16x16x32_bf16 v[220:223], v[28:31], a[188:191], v[220:223]
    s_waitcnt lgkmcnt(2)
    v_mul_f32 v65, v65, v153
    v_mul_f32 v66, v66, v154
    v_mul_f32 v67, v67, v155
    v_mul_f32 v64, v152, v184
    v_mfma_f32_16x16x32_bf16 v[192:195], v[16:19], a[192:195], v[192:195]
    ds_read_b64_tr_b16 v[20:21], v1 offset:26624
    v_exp_f32 v69, v65
    v_mfma_f32_16x16x32_bf16 v[196:199], v[16:19], a[196:199], v[196:199]
    v_exp_f32 v70, v66
    v_exp_f32 v71, v67
    v_mfma_f32_16x16x32_bf16 v[200:203], v[16:19], a[200:203], v[200:203]
    ds_read_b64_tr_b16 v[22:23], v1 offset:26880
    v_mul_f32 v65, v153, v185
    v_mul_f32 v66, v154, v186
    v_mfma_f32_16x16x32_bf16 v[204:207], v[16:19], a[204:207], v[204:207]
    s_waitcnt lgkmcnt(2)
    v_mul_f32 v67, v155, v187
    v_add_f32 v68, 1.0, v68
    v_add_f32 v69, 1.0, v69
    v_add_f32 v70, 1.0, v70
    v_mfma_f32_16x16x32_bf16 v[208:211], v[24:27], a[192:195], v[208:211]
    ds_read_b64_tr_b16 v[28:29], v2 offset:26624
    v_rcp_f32 v68, v68
    v_mfma_f32_16x16x32_bf16 v[212:215], v[24:27], a[196:199], v[212:215]
    v_rcp_f32 v69, v69
    v_rcp_f32 v70, v70
    v_mfma_f32_16x16x32_bf16 v[216:219], v[24:27], a[200:203], v[216:219]
    ds_read_b64_tr_b16 v[30:31], v2 offset:26880
    v_add_f32 v71, 1.0, v71
    v_mul_f32 v64, v64, v68
    v_mfma_f32_16x16x32_bf16 v[220:223], v[24:27], a[204:207], v[220:223]
    s_waitcnt lgkmcnt(2)
    v_rcp_f32 v71, v71
    v_mul_f32 v65, v65, v69
    v_mul_f32 v66, v66, v70
    v_mfma_f32_16x16x32_bf16 v[192:195], v[20:23], a[208:211], v[192:195]
    ds_read_b64_tr_b16 v[16:17], v1 offset:28672
    v_mul_f32 v67, v67, v71
    v_cvt_pk_bf16_f32 v74, v64, v65
    v_mfma_f32_16x16x32_bf16 v[196:199], v[20:23], a[212:215], v[196:199]
    v_cvt_pk_bf16_f32 v75, v66, v67
    s_add_u32 s52, s49, 294912
    v_mul_f32 v48, v140, v140
    v_mul_f32 v49, v141, v141
    v_mfma_f32_16x16x32_bf16 v[200:203], v[20:23], a[216:219], v[200:203]
    ds_read_b64_tr_b16 v[18:19], v1 offset:28928
    buffer_store_dwordx4 v[72:75], v15, s[24:27], s52 offen sc1
    v_mfma_f32_16x16x32_bf16 v[204:207], v[20:23], a[220:223], v[204:207]
    s_waitcnt lgkmcnt(2)
    v_mul_f32 v50, v142, v142
    v_mul_f32 v51, v143, v143
    v_fmaak_f32 v48, v48, v118, 0xc0135761
    v_fmaak_f32 v49, v49, v118, 0xc0135761
    v_mfma_f32_16x16x32_bf16 v[208:211], v[28:31], a[208:211], v[208:211]
    ds_read_b64_tr_b16 v[24:25], v2 offset:28672
    v_fmaak_f32 v50, v50, v118, 0xc0135761
    v_fmaak_f32 v51, v51, v118, 0xc0135761
    v_mfma_f32_16x16x32_bf16 v[212:215], v[28:31], a[212:215], v[212:215]
    v_mul_f32 v48, v48, v140
    v_mul_f32 v49, v49, v141
    v_mul_f32 v50, v50, v142
    v_mul_f32 v51, v51, v143
    v_mfma_f32_16x16x32_bf16 v[216:219], v[28:31], a[216:219], v[216:219]
    ds_read_b64_tr_b16 v[26:27], v2 offset:28928
    v_exp_f32 v52, v48
    v_mfma_f32_16x16x32_bf16 v[220:223], v[28:31], a[220:223], v[220:223]
    s_waitcnt lgkmcnt(2)
    v_exp_f32 v53, v49
    v_exp_f32 v54, v50
    v_mfma_f32_16x16x32_bf16 v[192:195], v[16:19], a[224:227], v[192:195]
    ds_read_b64_tr_b16 v[20:21], v1 offset:30720
    v_exp_f32 v55, v51
    v_mfma_f32_16x16x32_bf16 v[196:199], v[16:19], a[228:231], v[196:199]
    v_mul_f32 v48, v140, v172
    v_mul_f32 v49, v141, v173
    v_mul_f32 v50, v142, v174
    v_mul_f32 v51, v143, v175
    v_mfma_f32_16x16x32_bf16 v[200:203], v[16:19], a[232:235], v[200:203]
    ds_read_b64_tr_b16 v[22:23], v1 offset:30976
    v_add_f32 v52, 1.0, v52
    v_add_f32 v53, 1.0, v53
    v_mfma_f32_16x16x32_bf16 v[204:207], v[16:19], a[236:239], v[204:207]
    s_waitcnt lgkmcnt(2)
    v_rcp_f32 v52, v52
    v_rcp_f32 v53, v53
    v_mfma_f32_16x16x32_bf16 v[208:211], v[24:27], a[224:227], v[208:211]
    ds_read_b64_tr_b16 v[28:29], v2 offset:30720
    v_add_f32 v54, 1.0, v54
    v_add_f32 v55, 1.0, v55
    v_mfma_f32_16x16x32_bf16 v[212:215], v[24:27], a[228:231], v[212:215]
    v_rcp_f32 v54, v54
    v_rcp_f32 v55, v55
    v_mfma_f32_16x16x32_bf16 v[216:219], v[24:27], a[232:235], v[216:219]
    ds_read_b64_tr_b16 v[30:31], v2 offset:30976
    v_mul_f32 v48, v48, v52
    v_mul_f32 v49, v49, v53
    v_mfma_f32_16x16x32_bf16 v[220:223], v[24:27], a[236:239], v[220:223]
    s_waitcnt lgkmcnt(2)
    v_mul_f32 v50, v50, v54
    v_mul_f32 v51, v51, v55
    v_cvt_pk_bf16_f32 v76, v48, v49
    v_mul_f32 v56, v156, v156
    v_mfma_f32_16x16x32_bf16 v[192:195], v[20:23], a[240:243], v[192:195]
    ds_read_b64_tr_b16 v[16:17], v1 offset:32768
    v_cvt_pk_bf16_f32 v77, v50, v51
    v_mul_f32 v57, v157, v157
    v_mfma_f32_16x16x32_bf16 v[196:199], v[20:23], a[244:247], v[196:199]
    v_mul_f32 v58, v158, v158
    v_mul_f32 v59, v159, v159
    v_fmaak_f32 v56, v56, v118, 0xc0135761
    v_fmaak_f32 v57, v57, v118, 0xc0135761
    v_mfma_f32_16x16x32_bf16 v[200:203], v[20:23], a[248:251], v[200:203]
    ds_read_b64_tr_b16 v[18:19], v1 offset:33024
    v_fmaak_f32 v58, v58, v118, 0xc0135761
    v_fmaak_f32 v59, v59, v118, 0xc0135761
    v_mfma_f32_16x16x32_bf16 v[204:207], v[20:23], a[252:255], v[204:207]
    s_waitcnt lgkmcnt(2)
    v_mul_f32 v56, v56, v156
    v_mul_f32 v57, v57, v157
    v_mul_f32 v58, v58, v158
    v_mul_f32 v59, v59, v159
    v_mfma_f32_16x16x32_bf16 v[208:211], v[28:31], a[240:243], v[208:211]
    ds_read_b64_tr_b16 v[24:25], v2 offset:32768
    v_exp_f32 v60, v56
    v_mfma_f32_16x16x32_bf16 v[212:215], v[28:31], a[244:247], v[212:215]
    v_exp_f32 v61, v57
    v_exp_f32 v62, v58
    v_mfma_f32_16x16x32_bf16 v[216:219], v[28:31], a[248:251], v[216:219]
    ds_read_b64_tr_b16 v[26:27], v2 offset:33024
    v_exp_f32 v63, v59
    v_mfma_f32_16x16x32_bf16 v[220:223], v[28:31], a[252:255], v[220:223]
    s_waitcnt lgkmcnt(2)
    v_mul_f32 v56, v156, v188
    v_mul_f32 v57, v157, v189
    v_mul_f32 v58, v158, v190
    v_mul_f32 v59, v159, v191
    v_mfma_f32_16x16x32_bf16 v[192:195], v[16:19], v[80:83], v[192:195]
    ds_read_b64_tr_b16 v[20:21], v1 offset:34816
    v_add_f32 v60, 1.0, v60
    v_add_f32 v61, 1.0, v61
    v_mfma_f32_16x16x32_bf16 v[196:199], v[16:19], v[84:87], v[196:199]
    v_rcp_f32 v60, v60
    v_rcp_f32 v61, v61
    v_mfma_f32_16x16x32_bf16 v[200:203], v[16:19], v[88:91], v[200:203]
    ds_read_b64_tr_b16 v[22:23], v1 offset:35072
    v_add_f32 v62, 1.0, v62
    v_add_f32 v63, 1.0, v63
    v_mfma_f32_16x16x32_bf16 v[204:207], v[16:19], v[92:95], v[204:207]
    s_waitcnt lgkmcnt(2)
    v_rcp_f32 v62, v62
    v_rcp_f32 v63, v63
    v_mfma_f32_16x16x32_bf16 v[208:211], v[24:27], v[80:83], v[208:211]
    ds_read_b64_tr_b16 v[28:29], v2 offset:34816
    v_mul_f32 v56, v56, v60
    v_mul_f32 v57, v57, v61
    v_mfma_f32_16x16x32_bf16 v[212:215], v[24:27], v[84:87], v[212:215]
    v_mul_f32 v58, v58, v62
    v_mul_f32 v59, v59, v63
    v_cvt_pk_bf16_f32 v78, v56, v57
    s_add_u32 s52, s49, 442368
    v_mfma_f32_16x16x32_bf16 v[216:219], v[24:27], v[88:91], v[216:219]
    ds_read_b64_tr_b16 v[30:31], v2 offset:35072
    v_cvt_pk_bf16_f32 v79, v58, v59
    v_mfma_f32_16x16x32_bf16 v[220:223], v[24:27], v[92:95], v[220:223]
    s_waitcnt lgkmcnt(2)
    buffer_store_dwordx4 v[76:79], v15, s[24:27], s52 offen sc1
    v_mfma_f32_16x16x32_bf16 v[192:195], v[20:23], v[96:99], v[192:195]
    v_mfma_f32_16x16x32_bf16 v[196:199], v[20:23], v[100:103], v[196:199]
    s_waitcnt lgkmcnt(0)
    s_barrier
    v_mfma_f32_16x16x32_bf16 v[200:203], v[20:23], v[104:107], v[200:203]
    ds_read_b64_tr_b16 v[16:17], v5 offset:0
    ds_read_b64_tr_b16 v[18:19], v5 offset:256
    v_mfma_f32_16x16x32_bf16 v[204:207], v[20:23], v[108:111], v[204:207]
    ds_read_b64_tr_b16 v[24:25], v6 offset:0
    ds_read_b64_tr_b16 v[26:27], v6 offset:256
    v_mfma_f32_16x16x32_bf16 v[208:211], v[28:31], v[96:99], v[208:211]
    ds_read_b64_tr_b16 v[32:33], v7 offset:0
    v_mfma_f32_16x16x32_bf16 v[212:215], v[28:31], v[100:103], v[212:215]
    ds_read_b64_tr_b16 v[34:35], v7 offset:256
    v_mfma_f32_16x16x32_bf16 v[216:219], v[28:31], v[104:107], v[216:219]
    ds_read_b64_tr_b16 v[40:41], v8 offset:0
    v_mfma_f32_16x16x32_bf16 v[220:223], v[28:31], v[108:111], v[220:223]
    ds_read_b64_tr_b16 v[42:43], v8 offset:256
    v_swap_b32 v1, v5
    v_swap_b32 v2, v6
    v_swap_b32 v3, v7
    v_swap_b32 v4, v8
    s_xor_b32 s48, s48, s54
    s_mov_b32 s49, s73
    s_mov_b32 s73, s74
    s_lshl_b32 s52, s40, 11
    s_add_u32 s52, s52, s62
    s_lshr_b32 s53, s40, 1
    s_lshl_b32 s53, s53, 9
    s_add_u32 s53, s53, s62
    s_and_b32 s55, s40, 1
    s_lshl_b32 s55, s55, 3
    s_add_u32 s53, s53, s55
    s_add_u32 s53, s53, 8192
    s_add_u32 s55, s53, s60
    v_mul_f32 v192, s56, v192
    v_mul_f32 v193, s56, v193
    v_mul_f32 v194, s56, v194
    v_mul_f32 v195, s56, v195
    v_cvt_pk_bf16_f32 v48, v192, v193
    v_cvt_pk_bf16_f32 v49, v194, v195
    buffer_store_dwordx2 v[48:49], v120, s[28:31], s52 offen offset:0
    v_mul_f32 v208, s56, v208
    v_mul_f32 v209, s56, v209
    v_mul_f32 v210, s56, v210
    v_mul_f32 v211, s56, v211
    v_cvt_pk_bf16_f32 v50, v208, v209
    v_cvt_pk_bf16_f32 v51, v210, v211
    buffer_store_dwordx2 v[50:51], v121, s[28:31], s52 offen offset:0
    v_cndmask_b32 v52, v48, v50, s[66:67]
    v_cndmask_b32 v53, v49, v51, s[66:67]
    buffer_store_dword v52, v122, s[28:31], s53 offen offset:0
    buffer_store_dword v53, v122, s[28:31], s55 offen offset:0
    v_mul_f32 v196, s56, v196
    v_mul_f32 v197, s56, v197
    v_mul_f32 v198, s56, v198
    v_mul_f32 v199, s56, v199
    v_cvt_pk_bf16_f32 v54, v196, v197
    v_cvt_pk_bf16_f32 v55, v198, v199
    buffer_store_dwordx2 v[54:55], v120, s[28:31], s52 offen offset:256
    v_mul_f32 v212, s56, v212
    v_mul_f32 v213, s56, v213
    v_mul_f32 v214, s56, v214
    v_mul_f32 v215, s56, v215
    v_cvt_pk_bf16_f32 v56, v212, v213
    v_cvt_pk_bf16_f32 v57, v214, v215
    buffer_store_dwordx2 v[56:57], v121, s[28:31], s52 offen offset:256
    v_cndmask_b32 v58, v54, v56, s[66:67]
    v_cndmask_b32 v59, v55, v57, s[66:67]
    buffer_store_dword v58, v122, s[28:31], s53 offen offset:256
    buffer_store_dword v59, v122, s[28:31], s55 offen offset:256
    v_mul_f32 v200, s56, v200
    v_mul_f32 v201, s56, v201
    v_mul_f32 v202, s56, v202
    v_mul_f32 v203, s56, v203
    v_cvt_pk_bf16_f32 v60, v200, v201
    v_cvt_pk_bf16_f32 v61, v202, v203
    buffer_store_dwordx2 v[60:61], v120, s[28:31], s52 offen offset:1024
    v_mul_f32 v216, s56, v216
    v_mul_f32 v217, s56, v217
    v_mul_f32 v218, s56, v218
    v_mul_f32 v219, s56, v219
    v_cvt_pk_bf16_f32 v62, v216, v217
    v_cvt_pk_bf16_f32 v63, v218, v219
    buffer_store_dwordx2 v[62:63], v121, s[28:31], s52 offen offset:1024
    v_cndmask_b32 v64, v60, v62, s[66:67]
    v_cndmask_b32 v65, v61, v63, s[66:67]
    buffer_store_dword v64, v122, s[28:31], s53 offen offset:4
    buffer_store_dword v65, v122, s[28:31], s55 offen offset:4
    v_mul_f32 v204, s56, v204
    v_mul_f32 v205, s56, v205
    v_mul_f32 v206, s56, v206
    v_mul_f32 v207, s56, v207
    v_cvt_pk_bf16_f32 v66, v204, v205
    v_cvt_pk_bf16_f32 v67, v206, v207
    buffer_store_dwordx2 v[66:67], v120, s[28:31], s52 offen offset:1280
    v_mul_f32 v220, s56, v220
    v_mul_f32 v221, s56, v221
    v_mul_f32 v222, s56, v222
    v_mul_f32 v223, s56, v223
    v_cvt_pk_bf16_f32 v68, v220, v221
    v_cvt_pk_bf16_f32 v69, v222, v223
    buffer_store_dwordx2 v[68:69], v121, s[28:31], s52 offen offset:1280
    v_cndmask_b32 v70, v66, v68, s[66:67]
    v_cndmask_b32 v71, v67, v69, s[66:67]
    buffer_store_dword v70, v122, s[28:31], s53 offen offset:260
    buffer_store_dword v71, v122, s[28:31], s55 offen offset:260
    s_branch L_k1_end
L_k1_special:
    s_mov_b32 s50, s58
    s_lshl_b32 s59, s42, 2
    s_sub_u32 s59, s59, 70
    s_sub_u32 s58, s59, 4
    s_cmp_eq_u32 s42, 28
    s_cselect_b32 s58, 36, s58
    s_mul_i32 s44, s40, 55296
    s_lshl_b32 s52, s58, 6
    s_add_u32 s44, s44, s52
    s_add_u32 s45, s44, 64
    s_add_u32 s99, s99, 128
    s_waitcnt lgkmcnt(4)
    v_mfma_f32_16x16x32_bf16 v[192:195], v[16:19], a[96:99], v[192:195]
    ds_read_b64_tr_b16 v[20:21], v1 offset:14336
    v_mfma_f32_16x16x32_bf16 v[196:199], v[16:19], a[100:103], v[196:199]
    v_mfma_f32_16x16x32_bf16 v[200:203], v[16:19], a[104:107], v[200:203]
    ds_read_b64_tr_b16 v[22:23], v1 offset:14592
    v_mfma_f32_16x16x32_bf16 v[204:207], v[16:19], a[108:111], v[204:207]
    s_add_u32 m0, s48, 0
    v_mfma_f32_16x16x32_bf16 v[208:211], v[24:27], a[96:99], v[208:211]
    ds_read_b64_tr_b16 v[28:29], v2 offset:14336
    v_mfma_f32_16x16x32_bf16 v[212:215], v[24:27], a[100:103], v[212:215]
    buffer_load_dwordx4 v9, s[32:35], s44 offen lds
    v_mfma_f32_16x16x32_bf16 v[216:219], v[24:27], a[104:107], v[216:219]
    ds_read_b64_tr_b16 v[30:31], v2 offset:14592
    v_mfma_f32_16x16x32_bf16 v[220:223], v[24:27], a[108:111], v[220:223]
    s_waitcnt lgkmcnt(4)
    s_add_u32 s44, s44, s46
    v_mfma_f32_16x16x32_bf16 v[224:227], v[32:35], a[96:99], v[224:227]
    ds_read_b64_tr_b16 v[36:37], v3 offset:14336
    v_mul_f32 v48, v128, v128
    v_mfma_f32_16x16x32_bf16 v[228:231], v[32:35], a[100:103], v[228:231]
    s_add_u32 m0, s48, 36864
    v_mul_f32 v49, v129, v129
    v_mul_f32 v50, v130, v130
    v_mul_f32 v51, v131, v131
    v_mfma_f32_16x16x32_bf16 v[232:235], v[32:35], a[104:107], v[232:235]
    ds_read_b64_tr_b16 v[38:39], v3 offset:14592
    v_fmaak_f32 v48, v48, v118, 0xc0135761
    v_fmaak_f32 v49, v49, v118, 0xc0135761
    v_mfma_f32_16x16x32_bf16 v[236:239], v[32:35], a[108:111], v[236:239]
    buffer_load_dwordx4 v10, s[36:39], s45 offen lds
    v_fmaak_f32 v50, v50, v118, 0xc0135761
    v_mfma_f32_16x16x32_bf16 v[240:243], v[40:43], a[96:99], v[240:243]
    ds_read_b64_tr_b16 v[44:45], v4 offset:14336
    v_fmaak_f32 v51, v51, v118, 0xc0135761
    v_mul_f32 v48, v48, v128
    v_mfma_f32_16x16x32_bf16 v[244:247], v[40:43], a[100:103], v[244:247]
    s_add_u32 s45, s45, s47
    v_exp_f32 v52, v48
    v_mul_f32 v49, v49, v129
    v_mfma_f32_16x16x32_bf16 v[248:251], v[40:43], a[104:107], v[248:251]
    ds_read_b64_tr_b16 v[46:47], v4 offset:14592
    v_mul_f32 v50, v50, v130
    v_mfma_f32_16x16x32_bf16 v[252:255], v[40:43], a[108:111], v[252:255]
    s_waitcnt lgkmcnt(4)
    s_add_u32 m0, s48, 4096
    v_exp_f32 v53, v49
    v_mfma_f32_16x16x32_bf16 v[192:195], v[20:23], a[112:115], v[192:195]
    ds_read_b64_tr_b16 v[16:17], v1 offset:16384
    v_exp_f32 v54, v50
    v_mfma_f32_16x16x32_bf16 v[196:199], v[20:23], a[116:119], v[196:199]
    buffer_load_dwordx4 v9, s[32:35], s44 offen lds
    v_mul_f32 v51, v51, v131
    v_mfma_f32_16x16x32_bf16 v[200:203], v[20:23], a[120:123], v[200:203]
    ds_read_b64_tr_b16 v[18:19], v1 offset:16640
    v_exp_f32 v55, v51
    v_mfma_f32_16x16x32_bf16 v[204:207], v[20:23], a[124:127], v[204:207]
    s_add_u32 s44, s44, s46
    v_mul_f32 v48, v128, v160
    v_mul_f32 v49, v129, v161
    v_mul_f32 v50, v130, v162
    v_mfma_f32_16x16x32_bf16 v[208:211], v[28:31], a[112:115], v[208:211]
    ds_read_b64_tr_b16 v[24:25], v2 offset:16384
    v_mul_f32 v51, v131, v163
    v_mfma_f32_16x16x32_bf16 v[212:215], v[28:31], a[116:119], v[212:215]
    s_add_u32 m0, s48, 40960
    v_add_f32 v52, 1.0, v52
    v_add_f32 v53, 1.0, v53
    v_add_f32 v54, 1.0, v54
    v_mfma_f32_16x16x32_bf16 v[216:219], v[28:31], a[120:123], v[216:219]
    ds_read_b64_tr_b16 v[26:27], v2 offset:16640
    v_rcp_f32 v52, v52
    v_mfma_f32_16x16x32_bf16 v[220:223], v[28:31], a[124:127], v[220:223]
    s_waitcnt lgkmcnt(4)
    buffer_load_dwordx4 v10, s[36:39], s45 offen lds
    v_add_f32 v55, 1.0, v55
    v_mfma_f32_16x16x32_bf16 v[224:227], v[36:39], a[112:115], v[224:227]
    ds_read_b64_tr_b16 v[32:33], v3 offset:16384
    v_rcp_f32 v53, v53
    v_mfma_f32_16x16x32_bf16 v[228:231], v[36:39], a[116:119], v[228:231]
    s_add_u32 s45, s45, s47
    v_rcp_f32 v54, v54
    v_mul_f32 v48, v48, v52
    v_mfma_f32_16x16x32_bf16 v[232:235], v[36:39], a[120:123], v[232:235]
    ds_read_b64_tr_b16 v[34:35], v3 offset:16640
    v_mul_f32 v49, v49, v53
    v_mfma_f32_16x16x32_bf16 v[236:239], v[36:39], a[124:127], v[236:239]
    s_add_u32 m0, s48, 8192
    v_rcp_f32 v55, v55
    v_mul_f32 v50, v50, v54
    v_mfma_f32_16x16x32_bf16 v[240:243], v[44:47], a[112:115], v[240:243]
    ds_read_b64_tr_b16 v[40:41], v4 offset:16384
    v_mul_f32 v51, v51, v55
    v_cvt_pk_bf16_f32 v72, v48, v49
    v_mfma_f32_16x16x32_bf16 v[244:247], v[44:47], a[116:119], v[244:247]
    buffer_load_dwordx4 v9, s[32:35], s44 offen lds
    v_cvt_pk_bf16_f32 v73, v50, v51
    v_mfma_f32_16x16x32_bf16 v[248:251], v[44:47], a[120:123], v[248:251]
    ds_read_b64_tr_b16 v[42:43], v4 offset:16640
    v_mul_f32 v56, v144, v144
    v_mul_f32 v57, v145, v145
    v_mfma_f32_16x16x32_bf16 v[252:255], v[44:47], a[124:127], v[252:255]
    s_waitcnt lgkmcnt(4)
    s_add_u32 s44, s44, s46
    v_mul_f32 v58, v146, v146
    v_mul_f32 v59, v147, v147
    v_mfma_f32_16x16x32_bf16 v[192:195], v[16:19], a[128:131], v[192:195]
    ds_read_b64_tr_b16 v[20:21], v1 offset:18432
    v_fmaak_f32 v56, v56, v118, 0xc0135761
    v_mfma_f32_16x16x32_bf16 v[196:199], v[16:19], a[132:135], v[196:199]
    s_add_u32 m0, s48, 45056
    v_fmaak_f32 v57, v57, v118, 0xc0135761
    v_fmaak_f32 v58, v58, v118, 0xc0135761
    v_fmaak_f32 v59, v59, v118, 0xc0135761
    v_mfma_f32_16x16x32_bf16 v[200:203], v[16:19], a[136:139], v[200:203]
    ds_read_b64_tr_b16 v[22:23], v1 offset:18688
    v_mul_f32 v56, v56, v144
    v_mul_f32 v57, v57, v145
    v_mfma_f32_16x16x32_bf16 v[204:207], v[16:19], a[140:143], v[204:207]
    buffer_load_dwordx4 v10, s[36:39], s45 offen lds
    v_mul_f32 v58, v58, v146
    v_mfma_f32_16x16x32_bf16 v[208:211], v[24:27], a[128:131], v[208:211]
    ds_read_b64_tr_b16 v[28:29], v2 offset:18432
    v_exp_f32 v60, v56
    v_mfma_f32_16x16x32_bf16 v[212:215], v[24:27], a[132:135], v[212:215]
    s_add_u32 s45, s45, s47
    v_exp_f32 v61, v57
    v_mul_f32 v59, v59, v147
    v_mfma_f32_16x16x32_bf16 v[216:219], v[24:27], a[136:139], v[216:219]
    ds_read_b64_tr_b16 v[30:31], v2 offset:18688
    v_mul_f32 v56, v144, v176
    v_mfma_f32_16x16x32_bf16 v[220:223], v[24:27], a[140:143], v[220:223]
    s_waitcnt lgkmcnt(4)
    s_add_u32 m0, s48, 12288
    v_exp_f32 v62, v58
    v_mfma_f32_16x16x32_bf16 v[224:227], v[32:35], a[128:131], v[224:227]
    ds_read_b64_tr_b16 v[36:37], v3 offset:18432
    v_exp_f32 v63, v59
    v_mfma_f32_16x16x32_bf16 v[228:231], v[32:35], a[132:135], v[228:231]
    buffer_load_dwordx4 v9, s[32:35], s44 offen lds
    v_mul_f32 v57, v145, v177
    v_mfma_f32_16x16x32_bf16 v[232:235], v[32:35], a[136:139], v[232:235]
    ds_read_b64_tr_b16 v[38:39], v3 offset:18688
    v_mul_f32 v58, v146, v178
    v_mul_f32 v59, v147, v179
    v_mfma_f32_16x16x32_bf16 v[236:239], v[32:35], a[140:143], v[236:239]
    s_add_u32 s44, s44, s46
    v_add_f32 v60, 1.0, v60
    v_add_f32 v61, 1.0, v61
    v_add_f32 v62, 1.0, v62
    v_mfma_f32_16x16x32_bf16 v[240:243], v[40:43], a[128:131], v[240:243]
    ds_read_b64_tr_b16 v[44:45], v4 offset:18432
    v_add_f32 v63, 1.0, v63
    v_mfma_f32_16x16x32_bf16 v[244:247], v[40:43], a[132:135], v[244:247]
    s_add_u32 m0, s48, 49152
    v_rcp_f32 v60, v60
    v_mul_f32 v64, v132, v132
    v_mfma_f32_16x16x32_bf16 v[248:251], v[40:43], a[136:139], v[248:251]
    ds_read_b64_tr_b16 v[46:47], v4 offset:18688
    v_rcp_f32 v61, v61
    v_mfma_f32_16x16x32_bf16 v[252:255], v[40:43], a[140:143], v[252:255]
    s_waitcnt lgkmcnt(4)
    buffer_load_dwordx4 v10, s[36:39], s45 offen lds
    v_mul_f32 v56, v56, v60
    v_mfma_f32_16x16x32_bf16 v[192:195], v[20:23], a[144:147], v[192:195]
    ds_read_b64_tr_b16 v[16:17], v1 offset:20480
    v_rcp_f32 v62, v62
    v_mfma_f32_16x16x32_bf16 v[196:199], v[20:23], a[148:151], v[196:199]
    s_add_u32 s45, s45, s47
    v_rcp_f32 v63, v63
    v_mul_f32 v57, v57, v61
    v_mfma_f32_16x16x32_bf16 v[200:203], v[20:23], a[152:155], v[200:203]
    ds_read_b64_tr_b16 v[18:19], v1 offset:20736
    v_mul_f32 v58, v58, v62
    v_mul_f32 v59, v59, v63
    v_mfma_f32_16x16x32_bf16 v[204:207], v[20:23], a[156:159], v[204:207]
    s_add_u32 m0, s48, 16384
    v_cvt_pk_bf16_f32 v74, v56, v57
    v_cvt_pk_bf16_f32 v75, v58, v59
    v_mfma_f32_16x16x32_bf16 v[208:211], v[28:31], a[144:147], v[208:211]
    ds_read_b64_tr_b16 v[24:25], v2 offset:20480
    buffer_store_dwordx4 v[72:75], v15, s[24:27], s49 offen sc1
    v_mfma_f32_16x16x32_bf16 v[212:215], v[28:31], a[148:151], v[212:215]
    buffer_load_dwordx4 v9, s[32:35], s44 offen lds
    v_mul_f32 v65, v133, v133
    v_mfma_f32_16x16x32_bf16 v[216:219], v[28:31], a[152:155], v[216:219]
    ds_read_b64_tr_b16 v[26:27], v2 offset:20736
    v_mul_f32 v66, v134, v134
    v_mul_f32 v67, v135, v135
    v_mfma_f32_16x16x32_bf16 v[220:223], v[28:31], a[156:159], v[220:223]
    s_waitcnt lgkmcnt(4)
    s_add_u32 s44, s44, s46
    v_fmaak_f32 v64, v64, v118, 0xc0135761
    v_fmaak_f32 v65, v65, v118, 0xc0135761
    v_mfma_f32_16x16x32_bf16 v[224:227], v[36:39], a[144:147], v[224:227]
    ds_read_b64_tr_b16 v[32:33], v3 offset:20480
    v_fmaak_f32 v66, v66, v118, 0xc0135761
    v_fmaak_f32 v67, v67, v118, 0xc0135761
    v_mfma_f32_16x16x32_bf16 v[228:231], v[36:39], a[148:151], v[228:231]
    s_add_u32 m0, s48, 53248
    v_mul_f32 v64, v64, v132
    v_mul_f32 v65, v65, v133
    v_mfma_f32_16x16x32_bf16 v[232:235], v[36:39], a[152:155], v[232:235]
    ds_read_b64_tr_b16 v[34:35], v3 offset:20736
    v_exp_f32 v68, v64
    v_mfma_f32_16x16x32_bf16 v[236:239], v[36:39], a[156:159], v[236:239]
    buffer_load_dwordx4 v10, s[36:39], s45 offen lds
    v_mul_f32 v66, v66, v134
    v_mfma_f32_16x16x32_bf16 v[240:243], v[44:47], a[144:147], v[240:243]
    ds_read_b64_tr_b16 v[40:41], v4 offset:20480
    v_exp_f32 v69, v65
    v_mfma_f32_16x16x32_bf16 v[244:247], v[44:47], a[148:151], v[244:247]
    s_add_u32 s45, s45, s47
    v_exp_f32 v70, v66
    v_mul_f32 v67, v67, v135
    v_mfma_f32_16x16x32_bf16 v[248:251], v[44:47], a[152:155], v[248:251]
    ds_read_b64_tr_b16 v[42:43], v4 offset:20736
    v_exp_f32 v71, v67
    v_mfma_f32_16x16x32_bf16 v[252:255], v[44:47], a[156:159], v[252:255]
    s_waitcnt lgkmcnt(4)
    s_add_u32 m0, s48, 20480
    v_mul_f32 v64, v132, v164
    v_mfma_f32_16x16x32_bf16 v[192:195], v[16:19], a[160:163], v[192:195]
    ds_read_b64_tr_b16 v[20:21], v1 offset:22528
    v_mul_f32 v65, v133, v165
    v_mul_f32 v66, v134, v166
    v_mfma_f32_16x16x32_bf16 v[196:199], v[16:19], a[164:167], v[196:199]
    buffer_load_dwordx4 v9, s[32:35], s44 offen lds
    v_mul_f32 v67, v135, v167
    v_mfma_f32_16x16x32_bf16 v[200:203], v[16:19], a[168:171], v[200:203]
    ds_read_b64_tr_b16 v[22:23], v1 offset:22784
    v_add_f32 v68, 1.0, v68
    v_add_f32 v69, 1.0, v69
    v_mfma_f32_16x16x32_bf16 v[204:207], v[16:19], a[172:175], v[204:207]
    s_add_u32 s44, s44, s46
    v_rcp_f32 v68, v68
    v_add_f32 v70, 1.0, v70
    v_mfma_f32_16x16x32_bf16 v[208:211], v[24:27], a[160:163], v[208:211]
    ds_read_b64_tr_b16 v[28:29], v2 offset:22528
    v_rcp_f32 v69, v69
    v_mfma_f32_16x16x32_bf16 v[212:215], v[24:27], a[164:167], v[212:215]
    s_add_u32 m0, s48, 57344
    v_rcp_f32 v70, v70
    v_mfma_f32_16x16x32_bf16 v[216:219], v[24:27], a[168:171], v[216:219]
    ds_read_b64_tr_b16 v[30:31], v2 offset:22784
    v_add_f32 v71, 1.0, v71
    v_mul_f32 v64, v64, v68
    v_mfma_f32_16x16x32_bf16 v[220:223], v[24:27], a[172:175], v[220:223]
    s_waitcnt lgkmcnt(4)
    buffer_load_dwordx4 v10, s[36:39], s45 offen lds
    v_mul_f32 v65, v65, v69
    v_mfma_f32_16x16x32_bf16 v[224:227], v[32:35], a[160:163], v[224:227]
    ds_read_b64_tr_b16 v[36:37], v3 offset:22528
    v_rcp_f32 v71, v71
    v_mfma_f32_16x16x32_bf16 v[228:231], v[32:35], a[164:167], v[228:231]
    s_add_u32 s45, s45, s47
    v_mul_f32 v66, v66, v70
    v_mul_f32 v67, v67, v71
    v_cvt_pk_bf16_f32 v76, v64, v65
    v_mfma_f32_16x16x32_bf16 v[232:235], v[32:35], a[168:171], v[232:235]
    ds_read_b64_tr_b16 v[38:39], v3 offset:22784
    v_cvt_pk_bf16_f32 v77, v66, v67
    v_mul_f32 v48, v148, v148
    v_mfma_f32_16x16x32_bf16 v[236:239], v[32:35], a[172:175], v[236:239]
    s_add_u32 m0, s48, 24576
    v_mul_f32 v49, v149, v149
    v_mul_f32 v50, v150, v150
    v_mfma_f32_16x16x32_bf16 v[240:243], v[40:43], a[160:163], v[240:243]
    ds_read_b64_tr_b16 v[44:45], v4 offset:22528
    v_mul_f32 v51, v151, v151
    v_fmaak_f32 v48, v48, v118, 0xc0135761
    v_mfma_f32_16x16x32_bf16 v[244:247], v[40:43], a[164:167], v[244:247]
    buffer_load_dwordx4 v9, s[32:35], s44 offen lds
    v_fmaak_f32 v49, v49, v118, 0xc0135761
    v_mfma_f32_16x16x32_bf16 v[248:251], v[40:43], a[168:171], v[248:251]
    ds_read_b64_tr_b16 v[46:47], v4 offset:22784
    v_fmaak_f32 v50, v50, v118, 0xc0135761
    v_fmaak_f32 v51, v51, v118, 0xc0135761
    v_mfma_f32_16x16x32_bf16 v[252:255], v[40:43], a[172:175], v[252:255]
    s_waitcnt lgkmcnt(4)
    s_add_u32 s44, s44, s46
    v_mul_f32 v48, v48, v148
    v_mul_f32 v49, v49, v149
    v_mfma_f32_16x16x32_bf16 v[192:195], v[20:23], a[176:179], v[192:195]
    ds_read_b64_tr_b16 v[16:17], v1 offset:24576
    v_exp_f32 v52, v48
    v_mfma_f32_16x16x32_bf16 v[196:199], v[20:23], a[180:183], v[196:199]
    s_add_u32 m0, s48, 61440
    v_exp_f32 v53, v49
    v_mfma_f32_16x16x32_bf16 v[200:203], v[20:23], a[184:187], v[200:203]
    ds_read_b64_tr_b16 v[18:19], v1 offset:24832
    v_mul_f32 v50, v50, v150
    v_mul_f32 v51, v51, v151
    v_mfma_f32_16x16x32_bf16 v[204:207], v[20:23], a[188:191], v[204:207]
    buffer_load_dwordx4 v10, s[36:39], s45 offen lds
    v_mul_f32 v48, v148, v180
    v_mfma_f32_16x16x32_bf16 v[208:211], v[28:31], a[176:179], v[208:211]
    ds_read_b64_tr_b16 v[24:25], v2 offset:24576
    v_exp_f32 v54, v50
    v_mfma_f32_16x16x32_bf16 v[212:215], v[28:31], a[180:183], v[212:215]
    s_add_u32 s45, s45, s47
    v_exp_f32 v55, v51
    v_mul_f32 v49, v149, v181
    v_mfma_f32_16x16x32_bf16 v[216:219], v[28:31], a[184:187], v[216:219]
    ds_read_b64_tr_b16 v[26:27], v2 offset:24832
    v_mul_f32 v50, v150, v182
    v_mul_f32 v51, v151, v183
    v_mfma_f32_16x16x32_bf16 v[220:223], v[28:31], a[188:191], v[220:223]
    s_waitcnt lgkmcnt(4)
    s_add_u32 m0, s48, 28672
    v_add_f32 v52, 1.0, v52
    v_add_f32 v53, 1.0, v53
    v_mfma_f32_16x16x32_bf16 v[224:227], v[36:39], a[176:179], v[224:227]
    ds_read_b64_tr_b16 v[32:33], v3 offset:24576
    v_add_f32 v54, 1.0, v54
    v_mfma_f32_16x16x32_bf16 v[228:231], v[36:39], a[180:183], v[228:231]
    buffer_load_dwordx4 v9, s[32:35], s44 offen lds
    v_add_f32 v55, 1.0, v55
    v_mfma_f32_16x16x32_bf16 v[232:235], v[36:39], a[184:187], v[232:235]
    ds_read_b64_tr_b16 v[34:35], v3 offset:24832
    v_rcp_f32 v52, v52
    v_mfma_f32_16x16x32_bf16 v[236:239], v[36:39], a[188:191], v[236:239]
    s_add_u32 s44, s44, s46
    v_rcp_f32 v53, v53
    v_mul_f32 v48, v48, v52
    v_mfma_f32_16x16x32_bf16 v[240:243], v[44:47], a[176:179], v[240:243]
    ds_read_b64_tr_b16 v[40:41], v4 offset:24576
    v_rcp_f32 v54, v54
    v_mfma_f32_16x16x32_bf16 v[244:247], v[44:47], a[180:183], v[244:247]
    s_add_u32 m0, s48, 65536
    v_rcp_f32 v55, v55
    v_mul_f32 v49, v49, v53
    v_mfma_f32_16x16x32_bf16 v[248:251], v[44:47], a[184:187], v[248:251]
    ds_read_b64_tr_b16 v[42:43], v4 offset:24832
    v_mul_f32 v50, v50, v54
    v_mfma_f32_16x16x32_bf16 v[252:255], v[44:47], a[188:191], v[252:255]
    s_waitcnt lgkmcnt(4)
    buffer_load_dwordx4 v10, s[36:39], s45 offen lds
    v_mul_f32 v51, v51, v55
    v_mfma_f32_16x16x32_bf16 v[192:195], v[16:19], a[192:195], v[192:195]
    ds_read_b64_tr_b16 v[20:21], v1 offset:26624
    v_cvt_pk_bf16_f32 v78, v48, v49
    v_cvt_pk_bf16_f32 v79, v50, v51
    v_mfma_f32_16x16x32_bf16 v[196:199], v[16:19], a[196:199], v[196:199]
    s_add_u32 s45, s45, s47
    s_add_u32 s52, s49, 147456
    v_mul_f32 v56, v136, v136
    v_mul_f32 v57, v137, v137
    v_mfma_f32_16x16x32_bf16 v[200:203], v[16:19], a[200:203], v[200:203]
    ds_read_b64_tr_b16 v[22:23], v1 offset:26880
    buffer_store_dwordx4 v[76:79], v15, s[24:27], s52 offen sc1
    v_mfma_f32_16x16x32_bf16 v[204:207], v[16:19], a[204:207], v[204:207]
    s_add_u32 m0, s48, 32768
    v_mul_f32 v58, v138, v138
    v_mul_f32 v59, v139, v139
    v_fmaak_f32 v56, v56, v118, 0xc0135761
    v_mfma_f32_16x16x32_bf16 v[208:211], v[24:27], a[192:195], v[208:211]
    ds_read_b64_tr_b16 v[28:29], v2 offset:26624
    v_fmaak_f32 v57, v57, v118, 0xc0135761
    v_mfma_f32_16x16x32_bf16 v[212:215], v[24:27], a[196:199], v[212:215]
    buffer_load_dwordx4 v9, s[32:35], s44 offen lds
    v_fmaak_f32 v58, v58, v118, 0xc0135761
    v_mfma_f32_16x16x32_bf16 v[216:219], v[24:27], a[200:203], v[216:219]
    ds_read_b64_tr_b16 v[30:31], v2 offset:26880
    v_fmaak_f32 v59, v59, v118, 0xc0135761
    v_mul_f32 v56, v56, v136
    v_mfma_f32_16x16x32_bf16 v[220:223], v[24:27], a[204:207], v[220:223]
    s_waitcnt lgkmcnt(4)
    s_add_u32 s44, s44, s46
    v_exp_f32 v60, v56
    v_mfma_f32_16x16x32_bf16 v[224:227], v[32:35], a[192:195], v[224:227]
    ds_read_b64_tr_b16 v[36:37], v3 offset:26624
    v_mul_f32 v57, v57, v137
    v_mul_f32 v58, v58, v138
    v_mfma_f32_16x16x32_bf16 v[228:231], v[32:35], a[196:199], v[228:231]
    s_add_u32 m0, s48, 69632
    v_exp_f32 v61, v57
    v_mul_f32 v59, v59, v139
    v_mfma_f32_16x16x32_bf16 v[232:235], v[32:35], a[200:203], v[232:235]
    ds_read_b64_tr_b16 v[38:39], v3 offset:26880
    v_mul_f32 v56, v136, v168
    v_mfma_f32_16x16x32_bf16 v[236:239], v[32:35], a[204:207], v[236:239]
    buffer_load_dwordx4 v10, s[36:39], s45 offen lds
    v_mul_f32 v57, v137, v169
    v_mfma_f32_16x16x32_bf16 v[240:243], v[40:43], a[192:195], v[240:243]
    ds_read_b64_tr_b16 v[44:45], v4 offset:26624
    v_exp_f32 v62, v58
    v_mfma_f32_16x16x32_bf16 v[244:247], v[40:43], a[196:199], v[244:247]
    s_add_u32 s45, s45, s47
    v_exp_f32 v63, v59
    v_mul_f32 v58, v138, v170
    v_mfma_f32_16x16x32_bf16 v[248:251], v[40:43], a[200:203], v[248:251]
    ds_read_b64_tr_b16 v[46:47], v4 offset:26880
    v_mul_f32 v59, v139, v171
    v_add_f32 v60, 1.0, v60
    v_mfma_f32_16x16x32_bf16 v[252:255], v[40:43], a[204:207], v[252:255]
    s_waitcnt lgkmcnt(4)
    v_rcp_f32 v60, v60
    v_add_f32 v61, 1.0, v61
    v_mfma_f32_16x16x32_bf16 v[192:195], v[20:23], a[208:211], v[192:195]
    ds_read_b64_tr_b16 v[16:17], v1 offset:28672
    v_add_f32 v62, 1.0, v62
    v_mfma_f32_16x16x32_bf16 v[196:199], v[20:23], a[212:215], v[196:199]
    buffer_load_dword v114, v115, s[68:71], s99 offen
    v_add_f32 v63, 1.0, v63
    v_mfma_f32_16x16x32_bf16 v[200:203], v[20:23], a[216:219], v[200:203]
    ds_read_b64_tr_b16 v[18:19], v1 offset:28928
    v_rcp_f32 v61, v61
    v_mfma_f32_16x16x32_bf16 v[204:207], v[20:23], a[220:223], v[204:207]
    v_rcp_f32 v62, v62
    v_mul_f32 v56, v56, v60
    v_mfma_f32_16x16x32_bf16 v[208:211], v[28:31], a[208:211], v[208:211]
    ds_read_b64_tr_b16 v[24:25], v2 offset:28672
    v_rcp_f32 v63, v63
    v_mfma_f32_16x16x32_bf16 v[212:215], v[28:31], a[212:215], v[212:215]
    v_mul_f32 v57, v57, v61
    v_mul_f32 v58, v58, v62
    v_mul_f32 v59, v59, v63
    v_mfma_f32_16x16x32_bf16 v[216:219], v[28:31], a[216:219], v[216:219]
    ds_read_b64_tr_b16 v[26:27], v2 offset:28928
    v_cvt_pk_bf16_f32 v72, v56, v57
    v_mfma_f32_16x16x32_bf16 v[220:223], v[28:31], a[220:223], v[220:223]
    s_waitcnt lgkmcnt(4)
    v_cvt_pk_bf16_f32 v73, v58, v59
    v_mul_f32 v64, v152, v152
    v_mul_f32 v65, v153, v153
    v_mfma_f32_16x16x32_bf16 v[224:227], v[36:39], a[208:211], v[224:227]
    ds_read_b64_tr_b16 v[32:33], v3 offset:28672
    v_mul_f32 v66, v154, v154
    v_mul_f32 v67, v155, v155
    v_mfma_f32_16x16x32_bf16 v[228:231], v[36:39], a[212:215], v[228:231]
    v_fmaak_f32 v64, v64, v118, 0xc0135761
    v_fmaak_f32 v65, v65, v118, 0xc0135761
    v_fmaak_f32 v66, v66, v118, 0xc0135761
    v_mfma_f32_16x16x32_bf16 v[232:235], v[36:39], a[216:219], v[232:235]
    ds_read_b64_tr_b16 v[34:35], v3 offset:28928
    v_fmaak_f32 v67, v67, v118, 0xc0135761
    v_mul_f32 v64, v64, v152
    v_mfma_f32_16x16x32_bf16 v[236:239], v[36:39], a[220:223], v[236:239]
    v_exp_f32 v68, v64
    v_mul_f32 v65, v65, v153
    v_mfma_f32_16x16x32_bf16 v[240:243], v[44:47], a[208:211], v[240:243]
    ds_read_b64_tr_b16 v[40:41], v4 offset:28672
    v_mul_f32 v66, v66, v154
    v_mfma_f32_16x16x32_bf16 v[244:247], v[44:47], a[212:215], v[244:247]
    v_exp_f32 v69, v65
    v_mul_f32 v67, v67, v155
    v_mfma_f32_16x16x32_bf16 v[248:251], v[44:47], a[216:219], v[248:251]
    ds_read_b64_tr_b16 v[42:43], v4 offset:28928
    v_exp_f32 v70, v66
    v_mfma_f32_16x16x32_bf16 v[252:255], v[44:47], a[220:223], v[252:255]
    s_waitcnt lgkmcnt(4)
    v_exp_f32 v71, v67
    v_mul_f32 v64, v152, v184
    v_mfma_f32_16x16x32_bf16 v[192:195], v[16:19], a[224:227], v[192:195]
    ds_read_b64_tr_b16 v[20:21], v1 offset:30720
    v_mul_f32 v65, v153, v185
    v_mul_f32 v66, v154, v186
    v_mfma_f32_16x16x32_bf16 v[196:199], v[16:19], a[228:231], v[196:199]
    v_mul_f32 v67, v155, v187
    v_add_f32 v68, 1.0, v68
    v_add_f32 v69, 1.0, v69
    v_mfma_f32_16x16x32_bf16 v[200:203], v[16:19], a[232:235], v[200:203]
    ds_read_b64_tr_b16 v[22:23], v1 offset:30976
    v_rcp_f32 v68, v68
    v_mfma_f32_16x16x32_bf16 v[204:207], v[16:19], a[236:239], v[204:207]
    v_rcp_f32 v69, v69
    v_mfma_f32_16x16x32_bf16 v[208:211], v[24:27], a[224:227], v[208:211]
    ds_read_b64_tr_b16 v[28:29], v2 offset:30720
    v_add_f32 v70, 1.0, v70
    v_add_f32 v71, 1.0, v71
    v_mfma_f32_16x16x32_bf16 v[212:215], v[24:27], a[228:231], v[212:215]
    v_rcp_f32 v70, v70
    v_mul_f32 v64, v64, v68
    v_mfma_f32_16x16x32_bf16 v[216:219], v[24:27], a[232:235], v[216:219]
    ds_read_b64_tr_b16 v[30:31], v2 offset:30976
    v_rcp_f32 v71, v71
    v_mfma_f32_16x16x32_bf16 v[220:223], v[24:27], a[236:239], v[220:223]
    s_waitcnt lgkmcnt(4)
    v_mul_f32 v65, v65, v69
    v_mul_f32 v66, v66, v70
    v_mul_f32 v67, v67, v71
    v_mfma_f32_16x16x32_bf16 v[224:227], v[32:35], a[224:227], v[224:227]
    ds_read_b64_tr_b16 v[36:37], v3 offset:30720
    v_cvt_pk_bf16_f32 v74, v64, v65
    v_cvt_pk_bf16_f32 v75, v66, v67
    v_mfma_f32_16x16x32_bf16 v[228:231], v[32:35], a[228:231], v[228:231]
    s_add_u32 s52, s49, 294912
    v_mul_f32 v48, v140, v140
    v_mfma_f32_16x16x32_bf16 v[232:235], v[32:35], a[232:235], v[232:235]
    ds_read_b64_tr_b16 v[38:39], v3 offset:30976
    buffer_store_dwordx4 v[72:75], v15, s[24:27], s52 offen sc1
    v_mfma_f32_16x16x32_bf16 v[236:239], v[32:35], a[236:239], v[236:239]
    v_mul_f32 v49, v141, v141
    v_mul_f32 v50, v142, v142
    v_mul_f32 v51, v143, v143
    v_mfma_f32_16x16x32_bf16 v[240:243], v[40:43], a[224:227], v[240:243]
    ds_read_b64_tr_b16 v[44:45], v4 offset:30720
    v_fmaak_f32 v48, v48, v118, 0xc0135761
    v_fmaak_f32 v49, v49, v118, 0xc0135761
    v_mfma_f32_16x16x32_bf16 v[244:247], v[40:43], a[228:231], v[244:247]
    v_fmaak_f32 v50, v50, v118, 0xc0135761
    v_fmaak_f32 v51, v51, v118, 0xc0135761
    v_mul_f32 v48, v48, v140
    v_mfma_f32_16x16x32_bf16 v[248:251], v[40:43], a[232:235], v[248:251]
    ds_read_b64_tr_b16 v[46:47], v4 offset:30976
    v_exp_f32 v52, v48
    v_mfma_f32_16x16x32_bf16 v[252:255], v[40:43], a[236:239], v[252:255]
    s_waitcnt lgkmcnt(4)
    v_mul_f32 v49, v49, v141
    v_mul_f32 v50, v50, v142
    v_mfma_f32_16x16x32_bf16 v[192:195], v[20:23], a[240:243], v[192:195]
    ds_read_b64_tr_b16 v[16:17], v1 offset:32768
    v_exp_f32 v53, v49
    v_mfma_f32_16x16x32_bf16 v[196:199], v[20:23], a[244:247], v[196:199]
    v_exp_f32 v54, v50
    v_mul_f32 v51, v51, v143
    v_mfma_f32_16x16x32_bf16 v[200:203], v[20:23], a[248:251], v[200:203]
    ds_read_b64_tr_b16 v[18:19], v1 offset:33024
    v_exp_f32 v55, v51
    v_mfma_f32_16x16x32_bf16 v[204:207], v[20:23], a[252:255], v[204:207]
    v_mul_f32 v48, v140, v172
    v_mul_f32 v49, v141, v173
    v_mul_f32 v50, v142, v174
    v_mfma_f32_16x16x32_bf16 v[208:211], v[28:31], a[240:243], v[208:211]
    ds_read_b64_tr_b16 v[24:25], v2 offset:32768
    v_mul_f32 v51, v143, v175
    v_add_f32 v52, 1.0, v52
    v_mfma_f32_16x16x32_bf16 v[212:215], v[28:31], a[244:247], v[212:215]
    v_rcp_f32 v52, v52
    v_mfma_f32_16x16x32_bf16 v[216:219], v[28:31], a[248:251], v[216:219]
    ds_read_b64_tr_b16 v[26:27], v2 offset:33024
    v_add_f32 v53, 1.0, v53
    v_add_f32 v54, 1.0, v54
    v_mfma_f32_16x16x32_bf16 v[220:223], v[28:31], a[252:255], v[220:223]
    s_waitcnt lgkmcnt(4)
    v_rcp_f32 v53, v53
    v_add_f32 v55, 1.0, v55
    v_mfma_f32_16x16x32_bf16 v[224:227], v[36:39], a[240:243], v[224:227]
    ds_read_b64_tr_b16 v[32:33], v3 offset:32768
    v_rcp_f32 v54, v54
    v_mfma_f32_16x16x32_bf16 v[228:231], v[36:39], a[244:247], v[228:231]
    v_rcp_f32 v55, v55
    v_mul_f32 v48, v48, v52
    v_mfma_f32_16x16x32_bf16 v[232:235], v[36:39], a[248:251], v[232:235]
    ds_read_b64_tr_b16 v[34:35], v3 offset:33024
    v_mul_f32 v49, v49, v53
    v_mul_f32 v50, v50, v54
    v_mfma_f32_16x16x32_bf16 v[236:239], v[36:39], a[252:255], v[236:239]
    v_mul_f32 v51, v51, v55
    v_cvt_pk_bf16_f32 v76, v48, v49
    v_mfma_f32_16x16x32_bf16 v[240:243], v[44:47], a[240:243], v[240:243]
    ds_read_b64_tr_b16 v[40:41], v4 offset:32768
    v_cvt_pk_bf16_f32 v77, v50, v51
    v_mul_f32 v56, v156, v156
    v_mfma_f32_16x16x32_bf16 v[244:247], v[44:47], a[244:247], v[244:247]
    v_mul_f32 v57, v157, v157
    v_mul_f32 v58, v158, v158
    v_mul_f32 v59, v159, v159
    v_mfma_f32_16x16x32_bf16 v[248:251], v[44:47], a[248:251], v[248:251]
    ds_read_b64_tr_b16 v[42:43], v4 offset:33024
    v_fmaak_f32 v56, v56, v118, 0xc0135761
    v_fmaak_f32 v57, v57, v118, 0xc0135761
    v_mfma_f32_16x16x32_bf16 v[252:255], v[44:47], a[252:255], v[252:255]
    s_waitcnt lgkmcnt(4)
    v_fmaak_f32 v58, v58, v118, 0xc0135761
    v_fmaak_f32 v59, v59, v118, 0xc0135761
    v_mul_f32 v56, v56, v156
    v_mfma_f32_16x16x32_bf16 v[192:195], v[16:19], v[80:83], v[192:195]
    ds_read_b64_tr_b16 v[20:21], v1 offset:34816
    v_exp_f32 v60, v56
    v_mfma_f32_16x16x32_bf16 v[196:199], v[16:19], v[84:87], v[196:199]
    v_mul_f32 v57, v57, v157
    v_mul_f32 v58, v58, v158
    v_mfma_f32_16x16x32_bf16 v[200:203], v[16:19], v[88:91], v[200:203]
    ds_read_b64_tr_b16 v[22:23], v1 offset:35072
    v_exp_f32 v61, v57
    v_mfma_f32_16x16x32_bf16 v[204:207], v[16:19], v[92:95], v[204:207]
    v_exp_f32 v62, v58
    v_mul_f32 v59, v59, v159
    v_mfma_f32_16x16x32_bf16 v[208:211], v[24:27], v[80:83], v[208:211]
    ds_read_b64_tr_b16 v[28:29], v2 offset:34816
    v_exp_f32 v63, v59
    v_mfma_f32_16x16x32_bf16 v[212:215], v[24:27], v[84:87], v[212:215]
    v_mul_f32 v56, v156, v188
    v_mul_f32 v57, v157, v189
    v_mul_f32 v58, v158, v190
    v_mfma_f32_16x16x32_bf16 v[216:219], v[24:27], v[88:91], v[216:219]
    ds_read_b64_tr_b16 v[30:31], v2 offset:35072
    v_mul_f32 v59, v159, v191
    v_add_f32 v60, 1.0, v60
    v_mfma_f32_16x16x32_bf16 v[220:223], v[24:27], v[92:95], v[220:223]
    s_waitcnt lgkmcnt(4)
    v_rcp_f32 v60, v60
    v_add_f32 v61, 1.0, v61
    v_mfma_f32_16x16x32_bf16 v[224:227], v[32:35], v[80:83], v[224:227]
    ds_read_b64_tr_b16 v[36:37], v3 offset:34816
    v_add_f32 v62, 1.0, v62
    v_mfma_f32_16x16x32_bf16 v[228:231], v[32:35], v[84:87], v[228:231]
    v_rcp_f32 v61, v61
    v_add_f32 v63, 1.0, v63
    v_mfma_f32_16x16x32_bf16 v[232:235], v[32:35], v[88:91], v[232:235]
    ds_read_b64_tr_b16 v[38:39], v3 offset:35072
    v_rcp_f32 v62, v62
    v_mfma_f32_16x16x32_bf16 v[236:239], v[32:35], v[92:95], v[236:239]
    v_rcp_f32 v63, v63
    v_mul_f32 v56, v56, v60
    v_mfma_f32_16x16x32_bf16 v[240:243], v[40:43], v[80:83], v[240:243]
    ds_read_b64_tr_b16 v[44:45], v4 offset:34816
    v_mul_f32 v57, v57, v61
    v_mul_f32 v58, v58, v62
    v_mfma_f32_16x16x32_bf16 v[244:247], v[40:43], v[84:87], v[244:247]
    v_mul_f32 v59, v59, v63
    v_cvt_pk_bf16_f32 v78, v56, v57
    s_add_u32 s52, s49, 442368
    v_mfma_f32_16x16x32_bf16 v[248:251], v[40:43], v[88:91], v[248:251]
    ds_read_b64_tr_b16 v[46:47], v4 offset:35072
    v_cvt_pk_bf16_f32 v79, v58, v59
    v_mfma_f32_16x16x32_bf16 v[252:255], v[40:43], v[92:95], v[252:255]
    s_waitcnt lgkmcnt(4)
    buffer_store_dwordx4 v[76:79], v15, s[24:27], s52 offen sc1
    v_mfma_f32_16x16x32_bf16 v[192:195], v[20:23], v[96:99], v[192:195]
    v_mfma_f32_16x16x32_bf16 v[196:199], v[20:23], v[100:103], v[196:199]
    v_mfma_f32_16x16x32_bf16 v[200:203], v[20:23], v[104:107], v[200:203]
    v_mfma_f32_16x16x32_bf16 v[204:207], v[20:23], v[108:111], v[204:207]
    s_waitcnt vmcnt(3) lgkmcnt(0)
    s_barrier
    v_mfma_f32_16x16x32_bf16 v[208:211], v[28:31], v[96:99], v[208:211]
    ds_read_b64_tr_b16 v[16:17], v5 offset:0
    v_mfma_f32_16x16x32_bf16 v[212:215], v[28:31], v[100:103], v[212:215]
    ds_read_b64_tr_b16 v[18:19], v5 offset:256
    v_mfma_f32_16x16x32_bf16 v[216:219], v[28:31], v[104:107], v[216:219]
    ds_read_b64_tr_b16 v[24:25], v6 offset:0
    v_mfma_f32_16x16x32_bf16 v[220:223], v[28:31], v[108:111], v[220:223]
    ds_read_b64_tr_b16 v[26:27], v6 offset:256
    v_mfma_f32_16x16x32_bf16 v[224:227], v[36:39], v[96:99], v[224:227]
    ds_read_b64_tr_b16 v[32:33], v7 offset:0
    v_mfma_f32_16x16x32_bf16 v[228:231], v[36:39], v[100:103], v[228:231]
    ds_read_b64_tr_b16 v[34:35], v7 offset:256
    v_mfma_f32_16x16x32_bf16 v[232:235], v[36:39], v[104:107], v[232:235]
    ds_read_b64_tr_b16 v[40:41], v8 offset:0
    v_mfma_f32_16x16x32_bf16 v[236:239], v[36:39], v[108:111], v[236:239]
    ds_read_b64_tr_b16 v[42:43], v8 offset:256
    v_mfma_f32_16x16x32_bf16 v[240:243], v[44:47], v[96:99], v[240:243]
    v_mfma_f32_16x16x32_bf16 v[244:247], v[44:47], v[100:103], v[244:247]
    v_mfma_f32_16x16x32_bf16 v[248:251], v[44:47], v[104:107], v[248:251]
    v_mfma_f32_16x16x32_bf16 v[252:255], v[44:47], v[108:111], v[252:255]
    v_swap_b32 v1, v5
    v_swap_b32 v2, v6
    v_swap_b32 v3, v7
    v_swap_b32 v4, v8
    s_xor_b32 s48, s48, s54
    s_mov_b32 s49, s73
    s_mov_b32 s73, s74
    s_lshl_b32 s52, s40, 11
    s_add_u32 s52, s52, s62
    s_lshr_b32 s53, s40, 1
    s_lshl_b32 s53, s53, 9
    s_add_u32 s53, s53, s62
    s_and_b32 s55, s40, 1
    s_lshl_b32 s55, s55, 3
    s_add_u32 s53, s53, s55
    s_add_u32 s53, s53, 8192
    s_add_u32 s55, s53, s60
    v_mul_f32 v192, s56, v192
    v_mul_f32 v193, s56, v193
    v_mul_f32 v194, s56, v194
    v_mul_f32 v195, s56, v195
    v_cvt_pk_bf16_f32 v48, v192, v193
    v_cvt_pk_bf16_f32 v49, v194, v195
    buffer_store_dwordx2 v[48:49], v120, s[28:31], s52 offen offset:0
    v_mul_f32 v208, s56, v208
    v_mul_f32 v209, s56, v209
    v_mul_f32 v210, s56, v210
    v_mul_f32 v211, s56, v211
    v_cvt_pk_bf16_f32 v50, v208, v209
    v_cvt_pk_bf16_f32 v51, v210, v211
    buffer_store_dwordx2 v[50:51], v121, s[28:31], s52 offen offset:0
    v_cndmask_b32 v52, v48, v50, s[66:67]
    v_cndmask_b32 v53, v49, v51, s[66:67]
    buffer_store_dword v52, v122, s[28:31], s53 offen offset:0
    buffer_store_dword v53, v122, s[28:31], s55 offen offset:0
    v_mul_f32 v196, s56, v196
    v_mul_f32 v197, s56, v197
    v_mul_f32 v198, s56, v198
    v_mul_f32 v199, s56, v199
    v_cvt_pk_bf16_f32 v54, v196, v197
    v_cvt_pk_bf16_f32 v55, v198, v199
    buffer_store_dwordx2 v[54:55], v120, s[28:31], s52 offen offset:256
    v_mul_f32 v212, s56, v212
    v_mul_f32 v213, s56, v213
    v_mul_f32 v214, s56, v214
    v_mul_f32 v215, s56, v215
    v_cvt_pk_bf16_f32 v56, v212, v213
    v_cvt_pk_bf16_f32 v57, v214, v215
    buffer_store_dwordx2 v[56:57], v121, s[28:31], s52 offen offset:256
    v_cndmask_b32 v58, v54, v56, s[66:67]
    v_cndmask_b32 v59, v55, v57, s[66:67]
    buffer_store_dword v58, v122, s[28:31], s53 offen offset:256
    buffer_store_dword v59, v122, s[28:31], s55 offen offset:256
    v_mul_f32 v200, s56, v200
    v_mul_f32 v201, s56, v201
    v_mul_f32 v202, s56, v202
    v_mul_f32 v203, s56, v203
    v_cvt_pk_bf16_f32 v60, v200, v201
    v_cvt_pk_bf16_f32 v61, v202, v203
    buffer_store_dwordx2 v[60:61], v120, s[28:31], s52 offen offset:1024
    v_mul_f32 v216, s56, v216
    v_mul_f32 v217, s56, v217
    v_mul_f32 v218, s56, v218
    v_mul_f32 v219, s56, v219
    v_cvt_pk_bf16_f32 v62, v216, v217
    v_cvt_pk_bf16_f32 v63, v218, v219
    buffer_store_dwordx2 v[62:63], v121, s[28:31], s52 offen offset:1024
    v_cndmask_b32 v64, v60, v62, s[66:67]
    v_cndmask_b32 v65, v61, v63, s[66:67]
    buffer_store_dword v64, v122, s[28:31], s53 offen offset:4
    buffer_store_dword v65, v122, s[28:31], s55 offen offset:4
    v_mul_f32 v204, s56, v204
    v_mul_f32 v205, s56, v205
    v_mul_f32 v206, s56, v206
    v_mul_f32 v207, s56, v207
    v_cvt_pk_bf16_f32 v66, v204, v205
    v_cvt_pk_bf16_f32 v67, v206, v207
    buffer_store_dwordx2 v[66:67], v120, s[28:31], s52 offen offset:1280
    v_mul_f32 v220, s56, v220
    v_mul_f32 v221, s56, v221
    v_mul_f32 v222, s56, v222
    v_mul_f32 v223, s56, v223
    v_cvt_pk_bf16_f32 v68, v220, v221
    v_cvt_pk_bf16_f32 v69, v222, v223
    buffer_store_dwordx2 v[68:69], v121, s[28:31], s52 offen offset:1280
    v_cndmask_b32 v70, v66, v68, s[66:67]
    v_cndmask_b32 v71, v67, v69, s[66:67]
    buffer_store_dword v70, v122, s[28:31], s53 offen offset:260
    buffer_store_dword v71, v122, s[28:31], s55 offen offset:260
    s_add_u32 s61, s61, 8
    v_mov_b32 v122, v119
    v_add3_u32 v48, v13, s61, 0
    v_mul_u32_u24 v49, 57, v48
    v_lshrrev_b32 v49, 9, v49
    v_mad_i32_i24 v50, v49, -9, v48
    v_cmp_lt_u32 vcc, 4, v50
    v_cmp_eq_u32 s[64:65], 4, v50
    v_subrev_u32 v51, 5, v50
    v_lshlrev_b32 v49, 1, v49
    v_cndmask_b32 v50, v50, v51, vcc
    v_cndmask_b32 v51, 0, 1, vcc
    v_add_u32 v49, v49, v51
    v_mul_u32_u24 v49, s60, v49
    v_add_u32 v49, v49, v14
    v_cndmask_b32 v122, v122, v49, s[64:65]
    v_and_b32 v51, 1, v50
    v_lshl_add_u32 v49, v51, 9, v49
    v_lshrrev_b32 v51, 1, v50
    v_lshl_add_u32 v49, v51, 3, v49
    v_cndmask_b32 v120, v49, v119, s[64:65]
    v_add3_u32 v48, v13, s61, 4
    v_mul_u32_u24 v49, 57, v48
    v_lshrrev_b32 v49, 9, v49
    v_mad_i32_i24 v50, v49, -9, v48
    v_cmp_lt_u32 vcc, 4, v50
    v_cmp_eq_u32 s[66:67], 4, v50
    v_subrev_u32 v51, 5, v50
    v_lshlrev_b32 v49, 1, v49
    v_cndmask_b32 v50, v50, v51, vcc
    v_cndmask_b32 v51, 0, 1, vcc
    v_add_u32 v49, v49, v51
    v_mul_u32_u24 v49, s60, v49
    v_add_u32 v49, v49, v14
    v_cndmask_b32 v122, v122, v49, s[66:67]
    v_and_b32 v51, 1, v50
    v_lshl_add_u32 v49, v51, 9, v49
    v_lshrrev_b32 v51, 1, v50
    v_lshl_add_u32 v49, v51, 3, v49
    v_cndmask_b32 v121, v49, v119, s[66:67]
    s_lshl_b32 s52, s40, 11
    s_add_u32 s52, s52, s62
    s_lshr_b32 s53, s40, 1
    s_lshl_b32 s53, s53, 9
    s_add_u32 s53, s53, s62
    s_and_b32 s55, s40, 1
    s_lshl_b32 s55, s55, 3
    s_add_u32 s53, s53, s55
    s_add_u32 s53, s53, 8192
    s_add_u32 s55, s53, s60
    v_mul_f32 v224, s56, v224
    v_mul_f32 v225, s56, v225
    v_mul_f32 v226, s56, v226
    v_mul_f32 v227, s56, v227
    v_cvt_pk_bf16_f32 v48, v224, v225
    v_cvt_pk_bf16_f32 v49, v226, v227
    buffer_store_dwordx2 v[48:49], v120, s[28:31], s52 offen offset:0
    v_mul_f32 v240, s56, v240
    v_mul_f32 v241, s56, v241
    v_mul_f32 v242, s56, v242
    v_mul_f32 v243, s56, v243
    v_cvt_pk_bf16_f32 v50, v240, v241
    v_cvt_pk_bf16_f32 v51, v242, v243
    buffer_store_dwordx2 v[50:51], v121, s[28:31], s52 offen offset:0
    v_cndmask_b32 v52, v48, v50, s[66:67]
    v_cndmask_b32 v53, v49, v51, s[66:67]
    buffer_store_dword v52, v122, s[28:31], s53 offen offset:0
    buffer_store_dword v53, v122, s[28:31], s55 offen offset:0
    v_mul_f32 v228, s56, v228
    v_mul_f32 v229, s56, v229
    v_mul_f32 v230, s56, v230
    v_mul_f32 v231, s56, v231
    v_cvt_pk_bf16_f32 v54, v228, v229
    v_cvt_pk_bf16_f32 v55, v230, v231
    buffer_store_dwordx2 v[54:55], v120, s[28:31], s52 offen offset:256
    v_mul_f32 v244, s56, v244
    v_mul_f32 v245, s56, v245
    v_mul_f32 v246, s56, v246
    v_mul_f32 v247, s56, v247
    v_cvt_pk_bf16_f32 v56, v244, v245
    v_cvt_pk_bf16_f32 v57, v246, v247
    buffer_store_dwordx2 v[56:57], v121, s[28:31], s52 offen offset:256
    v_cndmask_b32 v58, v54, v56, s[66:67]
    v_cndmask_b32 v59, v55, v57, s[66:67]
    buffer_store_dword v58, v122, s[28:31], s53 offen offset:256
    buffer_store_dword v59, v122, s[28:31], s55 offen offset:256
    v_mul_f32 v232, s56, v232
    v_mul_f32 v233, s56, v233
    v_mul_f32 v234, s56, v234
    v_mul_f32 v235, s56, v235
    v_cvt_pk_bf16_f32 v60, v232, v233
    v_cvt_pk_bf16_f32 v61, v234, v235
    buffer_store_dwordx2 v[60:61], v120, s[28:31], s52 offen offset:1024
    v_mul_f32 v248, s56, v248
    v_mul_f32 v249, s56, v249
    v_mul_f32 v250, s56, v250
    v_mul_f32 v251, s56, v251
    v_cvt_pk_bf16_f32 v62, v248, v249
    v_cvt_pk_bf16_f32 v63, v250, v251
    buffer_store_dwordx2 v[62:63], v121, s[28:31], s52 offen offset:1024
    v_cndmask_b32 v64, v60, v62, s[66:67]
    v_cndmask_b32 v65, v61, v63, s[66:67]
    buffer_store_dword v64, v122, s[28:31], s53 offen offset:4
    buffer_store_dword v65, v122, s[28:31], s55 offen offset:4
    v_mul_f32 v236, s56, v236
    v_mul_f32 v237, s56, v237
    v_mul_f32 v238, s56, v238
    v_mul_f32 v239, s56, v239
    v_cvt_pk_bf16_f32 v66, v236, v237
    v_cvt_pk_bf16_f32 v67, v238, v239
    buffer_store_dwordx2 v[66:67], v120, s[28:31], s52 offen offset:1280
    v_mul_f32 v252, s56, v252
    v_mul_f32 v253, s56, v253
    v_mul_f32 v254, s56, v254
    v_mul_f32 v255, s56, v255
    v_cvt_pk_bf16_f32 v68, v252, v253
    v_cvt_pk_bf16_f32 v69, v254, v255
    buffer_store_dwordx2 v[68:69], v121, s[28:31], s52 offen offset:1280
    v_cndmask_b32 v70, v66, v68, s[66:67]
    v_cndmask_b32 v71, v67, v69, s[66:67]
    buffer_store_dword v70, v122, s[28:31], s53 offen offset:260
    buffer_store_dword v71, v122, s[28:31], s55 offen offset:260
L_k1_vloop:
    s_mov_b32 s50, s58
    s_add_u32 s58, s58, 2
    s_mul_i32 s44, s40, 55296
    s_lshl_b32 s52, s58, 6
    s_add_u32 s44, s44, s52
    s_add_u32 s45, s44, 64
    s_cmp_lt_u32 s58, s59
    s_cbranch_scc1 L_k1_vgo
    s_mov_b64 s[32:33], s[76:77]
    s_mov_b32 s34, s78
    v_mov_b32 v9, v15
    s_mov_b32 s46, 4096
    s_add_u32 s44, s75, 0
    s_mov_b64 s[36:37], s[76:77]
    s_mov_b32 s38, s78
    v_mov_b32 v10, v15
    s_mov_b32 s47, 4096
    s_add_u32 s45, s75, 20736
    s_cmp_eq_u32 s42, 28
    s_cselect_b32 s34, 0, s34
    s_cmp_eq_u32 s42, 29
    s_cselect_b32 s38, s38, 0
L_k1_vgo:
    s_add_u32 s99, s99, 128
    s_waitcnt lgkmcnt(4)
    v_mfma_f32_16x16x32_bf16 v[192:195], a[0:3], v[16:19], 0
    ds_read_b64_tr_b16 v[20:21], v1 offset:2048
    v_mfma_f32_16x16x32_bf16 v[196:199], a[4:7], v[16:19], 0
    v_mfma_f32_16x16x32_bf16 v[200:203], a[8:11], v[16:19], 0
    ds_read_b64_tr_b16 v[22:23], v1 offset:2304
    v_mfma_f32_16x16x32_bf16 v[204:207], a[12:15], v[16:19], 0
    s_add_u32 m0, s48, 0
    v_mfma_f32_16x16x32_bf16 v[208:211], a[0:3], v[24:27], 0
    ds_read_b64_tr_b16 v[28:29], v2 offset:2048
    v_mfma_f32_16x16x32_bf16 v[212:215], a[4:7], v[24:27], 0
    buffer_load_dwordx4 v9, s[32:35], s44 offen lds
    v_mfma_f32_16x16x32_bf16 v[216:219], a[8:11], v[24:27], 0
    ds_read_b64_tr_b16 v[30:31], v2 offset:2304
    v_mfma_f32_16x16x32_bf16 v[220:223], a[12:15], v[24:27], 0
    s_waitcnt lgkmcnt(4)
    s_add_u32 s44, s44, s46
    v_mfma_f32_16x16x32_bf16 v[224:227], a[0:3], v[32:35], 0
    ds_read_b64_tr_b16 v[36:37], v3 offset:2048
    v_mfma_f32_16x16x32_bf16 v[228:231], a[4:7], v[32:35], 0
    v_mfma_f32_16x16x32_bf16 v[232:235], a[8:11], v[32:35], 0
    ds_read_b64_tr_b16 v[38:39], v3 offset:2304
    v_mfma_f32_16x16x32_bf16 v[236:239], a[12:15], v[32:35], 0
    v_mfma_f32_16x16x32_bf16 v[240:243], a[0:3], v[40:43], 0
    ds_read_b64_tr_b16 v[44:45], v4 offset:2048
    v_mfma_f32_16x16x32_bf16 v[244:247], a[4:7], v[40:43], 0
    s_add_u32 m0, s48, 36864
    v_mfma_f32_16x16x32_bf16 v[248:251], a[8:11], v[40:43], 0
    ds_read_b64_tr_b16 v[46:47], v4 offset:2304
    v_mfma_f32_16x16x32_bf16 v[252:255], a[12:15], v[40:43], 0
    s_waitcnt lgkmcnt(4)
    buffer_load_dwordx4 v10, s[36:39], s45 offen lds
    v_mfma_f32_16x16x32_bf16 v[192:195], a[16:19], v[20:23], v[192:195]
    ds_read_b64_tr_b16 v[16:17], v1 offset:4096
    v_mfma_f32_16x16x32_bf16 v[196:199], a[20:23], v[20:23], v[196:199]
    s_add_u32 s45, s45, s47
    v_mfma_f32_16x16x32_bf16 v[200:203], a[24:27], v[20:23], v[200:203]
    ds_read_b64_tr_b16 v[18:19], v1 offset:4352
    v_mfma_f32_16x16x32_bf16 v[204:207], a[28:31], v[20:23], v[204:207]
    v_mfma_f32_16x16x32_bf16 v[208:211], a[16:19], v[28:31], v[208:211]
    ds_read_b64_tr_b16 v[24:25], v2 offset:4096
    v_mfma_f32_16x16x32_bf16 v[212:215], a[20:23], v[28:31], v[212:215]
    v_mfma_f32_16x16x32_bf16 v[216:219], a[24:27], v[28:31], v[216:219]
    ds_read_b64_tr_b16 v[26:27], v2 offset:4352
    v_mfma_f32_16x16x32_bf16 v[220:223], a[28:31], v[28:31], v[220:223]
    s_waitcnt lgkmcnt(4)
    s_add_u32 m0, s48, 4096
    v_mfma_f32_16x16x32_bf16 v[224:227], a[16:19], v[36:39], v[224:227]
    ds_read_b64_tr_b16 v[32:33], v3 offset:4096
    v_mfma_f32_16x16x32_bf16 v[228:231], a[20:23], v[36:39], v[228:231]
    buffer_load_dwordx4 v9, s[32:35], s44 offen lds
    v_mfma_f32_16x16x32_bf16 v[232:235], a[24:27], v[36:39], v[232:235]
    ds_read_b64_tr_b16 v[34:35], v3 offset:4352
    v_mfma_f32_16x16x32_bf16 v[236:239], a[28:31], v[36:39], v[236:239]
    s_add_u32 s44, s44, s46
    v_mfma_f32_16x16x32_bf16 v[240:243], a[16:19], v[44:47], v[240:243]
    ds_read_b64_tr_b16 v[40:41], v4 offset:4096
    v_mfma_f32_16x16x32_bf16 v[244:247], a[20:23], v[44:47], v[244:247]
    v_mfma_f32_16x16x32_bf16 v[248:251], a[24:27], v[44:47], v[248:251]
    ds_read_b64_tr_b16 v[42:43], v4 offset:4352
    v_mfma_f32_16x16x32_bf16 v[252:255], a[28:31], v[44:47], v[252:255]
    s_waitcnt lgkmcnt(4)
    v_mfma_f32_16x16x32_bf16 v[192:195], a[32:35], v[16:19], v[192:195]
    ds_read_b64_tr_b16 v[20:21], v1 offset:6144
    v_mfma_f32_16x16x32_bf16 v[196:199], a[36:39], v[16:19], v[196:199]
    s_add_u32 m0, s48, 40960
    v_mfma_f32_16x16x32_bf16 v[200:203], a[40:43], v[16:19], v[200:203]
    ds_read_b64_tr_b16 v[22:23], v1 offset:6400
    v_mfma_f32_16x16x32_bf16 v[204:207], a[44:47], v[16:19], v[204:207]
    buffer_load_dwordx4 v10, s[36:39], s45 offen lds
    v_mfma_f32_16x16x32_bf16 v[208:211], a[32:35], v[24:27], v[208:211]
    ds_read_b64_tr_b16 v[28:29], v2 offset:6144
    v_mfma_f32_16x16x32_bf16 v[212:215], a[36:39], v[24:27], v[212:215]
    s_add_u32 s45, s45, s47
    v_mfma_f32_16x16x32_bf16 v[216:219], a[40:43], v[24:27], v[216:219]
    ds_read_b64_tr_b16 v[30:31], v2 offset:6400
    v_mfma_f32_16x16x32_bf16 v[220:223], a[44:47], v[24:27], v[220:223]
    s_waitcnt lgkmcnt(4)
    v_mfma_f32_16x16x32_bf16 v[224:227], a[32:35], v[32:35], v[224:227]
    ds_read_b64_tr_b16 v[36:37], v3 offset:6144
    v_mfma_f32_16x16x32_bf16 v[228:231], a[36:39], v[32:35], v[228:231]
    v_mfma_f32_16x16x32_bf16 v[232:235], a[40:43], v[32:35], v[232:235]
    ds_read_b64_tr_b16 v[38:39], v3 offset:6400
    v_mfma_f32_16x16x32_bf16 v[236:239], a[44:47], v[32:35], v[236:239]
    s_add_u32 m0, s48, 8192
    v_mfma_f32_16x16x32_bf16 v[240:243], a[32:35], v[40:43], v[240:243]
    ds_read_b64_tr_b16 v[44:45], v4 offset:6144
    v_mfma_f32_16x16x32_bf16 v[244:247], a[36:39], v[40:43], v[244:247]
    buffer_load_dwordx4 v9, s[32:35], s44 offen lds
    v_mfma_f32_16x16x32_bf16 v[248:251], a[40:43], v[40:43], v[248:251]
    ds_read_b64_tr_b16 v[46:47], v4 offset:6400
    v_mfma_f32_16x16x32_bf16 v[252:255], a[44:47], v[40:43], v[252:255]
    s_waitcnt lgkmcnt(4)
    s_add_u32 s44, s44, s46
    v_mfma_f32_16x16x32_bf16 v[192:195], a[48:51], v[20:23], v[192:195]
    ds_read_b64_tr_b16 v[16:17], v1 offset:8192
    v_mfma_f32_16x16x32_bf16 v[196:199], a[52:55], v[20:23], v[196:199]
    v_mfma_f32_16x16x32_bf16 v[200:203], a[56:59], v[20:23], v[200:203]
    ds_read_b64_tr_b16 v[18:19], v1 offset:8448
    v_mfma_f32_16x16x32_bf16 v[204:207], a[60:63], v[20:23], v[204:207]
    v_mfma_f32_16x16x32_bf16 v[208:211], a[48:51], v[28:31], v[208:211]
    ds_read_b64_tr_b16 v[24:25], v2 offset:8192
    v_mfma_f32_16x16x32_bf16 v[212:215], a[52:55], v[28:31], v[212:215]
    s_add_u32 m0, s48, 45056
    v_mfma_f32_16x16x32_bf16 v[216:219], a[56:59], v[28:31], v[216:219]
    ds_read_b64_tr_b16 v[26:27], v2 offset:8448
    v_mfma_f32_16x16x32_bf16 v[220:223], a[60:63], v[28:31], v[220:223]
    s_waitcnt lgkmcnt(4)
    buffer_load_dwordx4 v10, s[36:39], s45 offen lds
    v_mfma_f32_16x16x32_bf16 v[224:227], a[48:51], v[36:39], v[224:227]
    ds_read_b64_tr_b16 v[32:33], v3 offset:8192
    v_mfma_f32_16x16x32_bf16 v[228:231], a[52:55], v[36:39], v[228:231]
    s_add_u32 s45, s45, s47
    v_mfma_f32_16x16x32_bf16 v[232:235], a[56:59], v[36:39], v[232:235]
    ds_read_b64_tr_b16 v[34:35], v3 offset:8448
    v_mfma_f32_16x16x32_bf16 v[236:239], a[60:63], v[36:39], v[236:239]
    v_mfma_f32_16x16x32_bf16 v[240:243], a[48:51], v[44:47], v[240:243]
    ds_read_b64_tr_b16 v[40:41], v4 offset:8192
    v_mfma_f32_16x16x32_bf16 v[244:247], a[52:55], v[44:47], v[244:247]
    v_mfma_f32_16x16x32_bf16 v[248:251], a[56:59], v[44:47], v[248:251]
    ds_read_b64_tr_b16 v[42:43], v4 offset:8448
    v_mfma_f32_16x16x32_bf16 v[252:255], a[60:63], v[44:47], v[252:255]
    s_waitcnt lgkmcnt(4)
    s_add_u32 m0, s48, 12288
    v_mfma_f32_16x16x32_bf16 v[192:195], a[64:67], v[16:19], v[192:195]
    ds_read_b64_tr_b16 v[20:21], v1 offset:10240
    v_mfma_f32_16x16x32_bf16 v[196:199], a[68:71], v[16:19], v[196:199]
    buffer_load_dwordx4 v9, s[32:35], s44 offen lds
    v_mfma_f32_16x16x32_bf16 v[200:203], a[72:75], v[16:19], v[200:203]
    ds_read_b64_tr_b16 v[22:23], v1 offset:10496
    v_mfma_f32_16x16x32_bf16 v[204:207], a[76:79], v[16:19], v[204:207]
    s_add_u32 s44, s44, s46
    v_mfma_f32_16x16x32_bf16 v[208:211], a[64:67], v[24:27], v[208:211]
    ds_read_b64_tr_b16 v[28:29], v2 offset:10240
    v_mfma_f32_16x16x32_bf16 v[212:215], a[68:71], v[24:27], v[212:215]
    v_mfma_f32_16x16x32_bf16 v[216:219], a[72:75], v[24:27], v[216:219]
    ds_read_b64_tr_b16 v[30:31], v2 offset:10496
    v_mfma_f32_16x16x32_bf16 v[220:223], a[76:79], v[24:27], v[220:223]
    s_waitcnt lgkmcnt(4)
    v_mfma_f32_16x16x32_bf16 v[224:227], a[64:67], v[32:35], v[224:227]
    ds_read_b64_tr_b16 v[36:37], v3 offset:10240
    v_mfma_f32_16x16x32_bf16 v[228:231], a[68:71], v[32:35], v[228:231]
    s_add_u32 m0, s48, 49152
    v_mfma_f32_16x16x32_bf16 v[232:235], a[72:75], v[32:35], v[232:235]
    ds_read_b64_tr_b16 v[38:39], v3 offset:10496
    v_mfma_f32_16x16x32_bf16 v[236:239], a[76:79], v[32:35], v[236:239]
    buffer_load_dwordx4 v10, s[36:39], s45 offen lds
    v_mfma_f32_16x16x32_bf16 v[240:243], a[64:67], v[40:43], v[240:243]
    ds_read_b64_tr_b16 v[44:45], v4 offset:10240
    v_mfma_f32_16x16x32_bf16 v[244:247], a[68:71], v[40:43], v[244:247]
    s_add_u32 s45, s45, s47
    v_mfma_f32_16x16x32_bf16 v[248:251], a[72:75], v[40:43], v[248:251]
    ds_read_b64_tr_b16 v[46:47], v4 offset:10496
    v_mfma_f32_16x16x32_bf16 v[252:255], a[76:79], v[40:43], v[252:255]
    s_waitcnt lgkmcnt(4)
    v_mfma_f32_16x16x32_bf16 v[192:195], a[80:83], v[20:23], v[192:195]
    ds_read_b64_tr_b16 v[16:17], v1 offset:12288
    v_mfma_f32_16x16x32_bf16 v[196:199], a[84:87], v[20:23], v[196:199]
    v_mfma_f32_16x16x32_bf16 v[200:203], a[88:91], v[20:23], v[200:203]
    ds_read_b64_tr_b16 v[18:19], v1 offset:12544
    v_mfma_f32_16x16x32_bf16 v[204:207], a[92:95], v[20:23], v[204:207]
    s_add_u32 m0, s48, 16384
    v_mfma_f32_16x16x32_bf16 v[208:211], a[80:83], v[28:31], v[208:211]
    ds_read_b64_tr_b16 v[24:25], v2 offset:12288
    v_mfma_f32_16x16x32_bf16 v[212:215], a[84:87], v[28:31], v[212:215]
    buffer_load_dwordx4 v9, s[32:35], s44 offen lds
    v_mfma_f32_16x16x32_bf16 v[216:219], a[88:91], v[28:31], v[216:219]
    ds_read_b64_tr_b16 v[26:27], v2 offset:12544
    v_mfma_f32_16x16x32_bf16 v[220:223], a[92:95], v[28:31], v[220:223]
    s_waitcnt lgkmcnt(4)
    s_add_u32 s44, s44, s46
    v_mfma_f32_16x16x32_bf16 v[224:227], a[80:83], v[36:39], v[224:227]
    ds_read_b64_tr_b16 v[32:33], v3 offset:12288
    v_mfma_f32_16x16x32_bf16 v[228:231], a[84:87], v[36:39], v[228:231]
    v_mfma_f32_16x16x32_bf16 v[232:235], a[88:91], v[36:39], v[232:235]
    ds_read_b64_tr_b16 v[34:35], v3 offset:12544
    v_mfma_f32_16x16x32_bf16 v[236:239], a[92:95], v[36:39], v[236:239]
    v_mfma_f32_16x16x32_bf16 v[240:243], a[80:83], v[44:47], v[240:243]
    ds_read_b64_tr_b16 v[40:41], v4 offset:12288
    v_mfma_f32_16x16x32_bf16 v[244:247], a[84:87], v[44:47], v[244:247]
    s_add_u32 m0, s48, 53248
    v_mfma_f32_16x16x32_bf16 v[248:251], a[88:91], v[44:47], v[248:251]
    ds_read_b64_tr_b16 v[42:43], v4 offset:12544
    v_mfma_f32_16x16x32_bf16 v[252:255], a[92:95], v[44:47], v[252:255]
    s_waitcnt lgkmcnt(4)
    buffer_load_dwordx4 v10, s[36:39], s45 offen lds
    v_mfma_f32_16x16x32_bf16 v[192:195], a[96:99], v[16:19], v[192:195]
    ds_read_b64_tr_b16 v[20:21], v1 offset:14336
    v_mfma_f32_16x16x32_bf16 v[196:199], a[100:103], v[16:19], v[196:199]
    s_add_u32 s45, s45, s47
    v_mfma_f32_16x16x32_bf16 v[200:203], a[104:107], v[16:19], v[200:203]
    ds_read_b64_tr_b16 v[22:23], v1 offset:14592
    v_mfma_f32_16x16x32_bf16 v[204:207], a[108:111], v[16:19], v[204:207]
    v_mfma_f32_16x16x32_bf16 v[208:211], a[96:99], v[24:27], v[208:211]
    ds_read_b64_tr_b16 v[28:29], v2 offset:14336
    v_mfma_f32_16x16x32_bf16 v[212:215], a[100:103], v[24:27], v[212:215]
    v_mfma_f32_16x16x32_bf16 v[216:219], a[104:107], v[24:27], v[216:219]
    ds_read_b64_tr_b16 v[30:31], v2 offset:14592
    v_mfma_f32_16x16x32_bf16 v[220:223], a[108:111], v[24:27], v[220:223]
    s_waitcnt lgkmcnt(4)
    s_add_u32 m0, s48, 20480
    v_mfma_f32_16x16x32_bf16 v[224:227], a[96:99], v[32:35], v[224:227]
    ds_read_b64_tr_b16 v[36:37], v3 offset:14336
    v_mfma_f32_16x16x32_bf16 v[228:231], a[100:103], v[32:35], v[228:231]
    buffer_load_dwordx4 v9, s[32:35], s44 offen lds
    v_mfma_f32_16x16x32_bf16 v[232:235], a[104:107], v[32:35], v[232:235]
    ds_read_b64_tr_b16 v[38:39], v3 offset:14592
    v_mfma_f32_16x16x32_bf16 v[236:239], a[108:111], v[32:35], v[236:239]
    s_add_u32 s44, s44, s46
    v_mfma_f32_16x16x32_bf16 v[240:243], a[96:99], v[40:43], v[240:243]
    ds_read_b64_tr_b16 v[44:45], v4 offset:14336
    v_mfma_f32_16x16x32_bf16 v[244:247], a[100:103], v[40:43], v[244:247]
    v_mfma_f32_16x16x32_bf16 v[248:251], a[104:107], v[40:43], v[248:251]
    ds_read_b64_tr_b16 v[46:47], v4 offset:14592
    v_mfma_f32_16x16x32_bf16 v[252:255], a[108:111], v[40:43], v[252:255]
    s_waitcnt lgkmcnt(4)
    v_mfma_f32_16x16x32_bf16 v[192:195], a[112:115], v[20:23], v[192:195]
    ds_read_b64_tr_b16 v[16:17], v1 offset:16384
    v_mfma_f32_16x16x32_bf16 v[196:199], a[116:119], v[20:23], v[196:199]
    s_add_u32 m0, s48, 57344
    v_mfma_f32_16x16x32_bf16 v[200:203], a[120:123], v[20:23], v[200:203]
    ds_read_b64_tr_b16 v[18:19], v1 offset:16640
    v_mfma_f32_16x16x32_bf16 v[204:207], a[124:127], v[20:23], v[204:207]
    buffer_load_dwordx4 v10, s[36:39], s45 offen lds
    v_mfma_f32_16x16x32_bf16 v[208:211], a[112:115], v[28:31], v[208:211]
    ds_read_b64_tr_b16 v[24:25], v2 offset:16384
    v_mfma_f32_16x16x32_bf16 v[212:215], a[116:119], v[28:31], v[212:215]
    s_add_u32 s45, s45, s47
    v_mfma_f32_16x16x32_bf16 v[216:219], a[120:123], v[28:31], v[216:219]
    ds_read_b64_tr_b16 v[26:27], v2 offset:16640
    v_mfma_f32_16x16x32_bf16 v[220:223], a[124:127], v[28:31], v[220:223]
    s_waitcnt lgkmcnt(4)
    v_mfma_f32_16x16x32_bf16 v[224:227], a[112:115], v[36:39], v[224:227]
    ds_read_b64_tr_b16 v[32:33], v3 offset:16384
    v_mfma_f32_16x16x32_bf16 v[228:231], a[116:119], v[36:39], v[228:231]
    v_mfma_f32_16x16x32_bf16 v[232:235], a[120:123], v[36:39], v[232:235]
    ds_read_b64_tr_b16 v[34:35], v3 offset:16640
    v_mfma_f32_16x16x32_bf16 v[236:239], a[124:127], v[36:39], v[236:239]
    s_add_u32 m0, s48, 24576
    v_mfma_f32_16x16x32_bf16 v[240:243], a[112:115], v[44:47], v[240:243]
    ds_read_b64_tr_b16 v[40:41], v4 offset:16384
    v_mfma_f32_16x16x32_bf16 v[244:247], a[116:119], v[44:47], v[244:247]
    buffer_load_dwordx4 v9, s[32:35], s44 offen lds
    v_mfma_f32_16x16x32_bf16 v[248:251], a[120:123], v[44:47], v[248:251]
    ds_read_b64_tr_b16 v[42:43], v4 offset:16640
    v_mfma_f32_16x16x32_bf16 v[252:255], a[124:127], v[44:47], v[252:255]
    s_waitcnt lgkmcnt(4)
    s_add_u32 s44, s44, s46
    v_mfma_f32_16x16x32_bf16 v[192:195], a[128:131], v[16:19], v[192:195]
    ds_read_b64_tr_b16 v[20:21], v1 offset:18432
    v_mfma_f32_16x16x32_bf16 v[196:199], a[132:135], v[16:19], v[196:199]
    v_mfma_f32_16x16x32_bf16 v[200:203], a[136:139], v[16:19], v[200:203]
    ds_read_b64_tr_b16 v[22:23], v1 offset:18688
    v_mfma_f32_16x16x32_bf16 v[204:207], a[140:143], v[16:19], v[204:207]
    v_mfma_f32_16x16x32_bf16 v[208:211], a[128:131], v[24:27], v[208:211]
    ds_read_b64_tr_b16 v[28:29], v2 offset:18432
    v_mfma_f32_16x16x32_bf16 v[212:215], a[132:135], v[24:27], v[212:215]
    s_add_u32 m0, s48, 61440
    v_mfma_f32_16x16x32_bf16 v[216:219], a[136:139], v[24:27], v[216:219]
    ds_read_b64_tr_b16 v[30:31], v2 offset:18688
    v_mfma_f32_16x16x32_bf16 v[220:223], a[140:143], v[24:27], v[220:223]
    s_waitcnt lgkmcnt(4)
    buffer_load_dwordx4 v10, s[36:39], s45 offen lds
    v_mfma_f32_16x16x32_bf16 v[224:227], a[128:131], v[32:35], v[224:227]
    ds_read_b64_tr_b16 v[36:37], v3 offset:18432
    v_mfma_f32_16x16x32_bf16 v[228:231], a[132:135], v[32:35], v[228:231]
    s_add_u32 s45, s45, s47
    v_mfma_f32_16x16x32_bf16 v[232:235], a[136:139], v[32:35], v[232:235]
    ds_read_b64_tr_b16 v[38:39], v3 offset:18688
    v_mfma_f32_16x16x32_bf16 v[236:239], a[140:143], v[32:35], v[236:239]
    v_mfma_f32_16x16x32_bf16 v[240:243], a[128:131], v[40:43], v[240:243]
    ds_read_b64_tr_b16 v[44:45], v4 offset:18432
    v_mfma_f32_16x16x32_bf16 v[244:247], a[132:135], v[40:43], v[244:247]
    v_mfma_f32_16x16x32_bf16 v[248:251], a[136:139], v[40:43], v[248:251]
    ds_read_b64_tr_b16 v[46:47], v4 offset:18688
    v_mfma_f32_16x16x32_bf16 v[252:255], a[140:143], v[40:43], v[252:255]
    s_waitcnt lgkmcnt(4)
    s_add_u32 m0, s48, 28672
    v_mfma_f32_16x16x32_bf16 v[192:195], a[144:147], v[20:23], v[192:195]
    ds_read_b64_tr_b16 v[16:17], v1 offset:20480
    v_mfma_f32_16x16x32_bf16 v[196:199], a[148:151], v[20:23], v[196:199]
    buffer_load_dwordx4 v9, s[32:35], s44 offen lds
    v_mfma_f32_16x16x32_bf16 v[200:203], a[152:155], v[20:23], v[200:203]
    ds_read_b64_tr_b16 v[18:19], v1 offset:20736
    v_mfma_f32_16x16x32_bf16 v[204:207], a[156:159], v[20:23], v[204:207]
    s_add_u32 s44, s44, s46
    v_mfma_f32_16x16x32_bf16 v[208:211], a[144:147], v[28:31], v[208:211]
    ds_read_b64_tr_b16 v[24:25], v2 offset:20480
    v_mfma_f32_16x16x32_bf16 v[212:215], a[148:151], v[28:31], v[212:215]
    v_mfma_f32_16x16x32_bf16 v[216:219], a[152:155], v[28:31], v[216:219]
    ds_read_b64_tr_b16 v[26:27], v2 offset:20736
    v_mfma_f32_16x16x32_bf16 v[220:223], a[156:159], v[28:31], v[220:223]
    s_waitcnt lgkmcnt(4)
    v_mfma_f32_16x16x32_bf16 v[224:227], a[144:147], v[36:39], v[224:227]
    ds_read_b64_tr_b16 v[32:33], v3 offset:20480
    v_mfma_f32_16x16x32_bf16 v[228:231], a[148:151], v[36:39], v[228:231]
    s_add_u32 m0, s48, 65536
    v_mfma_f32_16x16x32_bf16 v[232:235], a[152:155], v[36:39], v[232:235]
    ds_read_b64_tr_b16 v[34:35], v3 offset:20736
    v_mfma_f32_16x16x32_bf16 v[236:239], a[156:159], v[36:39], v[236:239]
    buffer_load_dwordx4 v10, s[36:39], s45 offen lds
    v_mfma_f32_16x16x32_bf16 v[240:243], a[144:147], v[44:47], v[240:243]
    ds_read_b64_tr_b16 v[40:41], v4 offset:20480
    v_mfma_f32_16x16x32_bf16 v[244:247], a[148:151], v[44:47], v[244:247]
    s_add_u32 s45, s45, s47
    v_mfma_f32_16x16x32_bf16 v[248:251], a[152:155], v[44:47], v[248:251]
    ds_read_b64_tr_b16 v[42:43], v4 offset:20736
    v_mfma_f32_16x16x32_bf16 v[252:255], a[156:159], v[44:47], v[252:255]
    s_waitcnt lgkmcnt(4)
    v_mfma_f32_16x16x32_bf16 v[192:195], a[160:163], v[16:19], v[192:195]
    ds_read_b64_tr_b16 v[20:21], v1 offset:22528
    v_mfma_f32_16x16x32_bf16 v[196:199], a[164:167], v[16:19], v[196:199]
    v_mfma_f32_16x16x32_bf16 v[200:203], a[168:171], v[16:19], v[200:203]
    ds_read_b64_tr_b16 v[22:23], v1 offset:22784
    v_mfma_f32_16x16x32_bf16 v[204:207], a[172:175], v[16:19], v[204:207]
    s_add_u32 m0, s48, 32768
    v_mfma_f32_16x16x32_bf16 v[208:211], a[160:163], v[24:27], v[208:211]
    ds_read_b64_tr_b16 v[28:29], v2 offset:22528
    v_mfma_f32_16x16x32_bf16 v[212:215], a[164:167], v[24:27], v[212:215]
    buffer_load_dwordx4 v9, s[32:35], s44 offen lds
    v_mfma_f32_16x16x32_bf16 v[216:219], a[168:171], v[24:27], v[216:219]
    ds_read_b64_tr_b16 v[30:31], v2 offset:22784
    v_mfma_f32_16x16x32_bf16 v[220:223], a[172:175], v[24:27], v[220:223]
    s_waitcnt lgkmcnt(4)
    s_add_u32 s44, s44, s46
    v_mfma_f32_16x16x32_bf16 v[224:227], a[160:163], v[32:35], v[224:227]
    ds_read_b64_tr_b16 v[36:37], v3 offset:22528
    v_mfma_f32_16x16x32_bf16 v[228:231], a[164:167], v[32:35], v[228:231]
    v_mfma_f32_16x16x32_bf16 v[232:235], a[168:171], v[32:35], v[232:235]
    ds_read_b64_tr_b16 v[38:39], v3 offset:22784
    v_mfma_f32_16x16x32_bf16 v[236:239], a[172:175], v[32:35], v[236:239]
    v_mfma_f32_16x16x32_bf16 v[240:243], a[160:163], v[40:43], v[240:243]
    ds_read_b64_tr_b16 v[44:45], v4 offset:22528
    v_mfma_f32_16x16x32_bf16 v[244:247], a[164:167], v[40:43], v[244:247]
    s_add_u32 m0, s48, 69632
    v_mfma_f32_16x16x32_bf16 v[248:251], a[168:171], v[40:43], v[248:251]
    ds_read_b64_tr_b16 v[46:47], v4 offset:22784
    v_mfma_f32_16x16x32_bf16 v[252:255], a[172:175], v[40:43], v[252:255]
    s_waitcnt lgkmcnt(4)
    buffer_load_dwordx4 v10, s[36:39], s45 offen lds
    v_mfma_f32_16x16x32_bf16 v[192:195], a[176:179], v[20:23], v[192:195]
    ds_read_b64_tr_b16 v[16:17], v1 offset:24576
    v_mfma_f32_16x16x32_bf16 v[196:199], a[180:183], v[20:23], v[196:199]
    s_add_u32 s45, s45, s47
    v_mfma_f32_16x16x32_bf16 v[200:203], a[184:187], v[20:23], v[200:203]
    ds_read_b64_tr_b16 v[18:19], v1 offset:24832
    v_mfma_f32_16x16x32_bf16 v[204:207], a[188:191], v[20:23], v[204:207]
    v_mfma_f32_16x16x32_bf16 v[208:211], a[176:179], v[28:31], v[208:211]
    ds_read_b64_tr_b16 v[24:25], v2 offset:24576
    v_mfma_f32_16x16x32_bf16 v[212:215], a[180:183], v[28:31], v[212:215]
    v_mfma_f32_16x16x32_bf16 v[216:219], a[184:187], v[28:31], v[216:219]
    ds_read_b64_tr_b16 v[26:27], v2 offset:24832
    v_mfma_f32_16x16x32_bf16 v[220:223], a[188:191], v[28:31], v[220:223]
    s_waitcnt lgkmcnt(4)
    v_mfma_f32_16x16x32_bf16 v[224:227], a[176:179], v[36:39], v[224:227]
    ds_read_b64_tr_b16 v[32:33], v3 offset:24576
    v_mfma_f32_16x16x32_bf16 v[228:231], a[180:183], v[36:39], v[228:231]
    buffer_load_dword v114, v115, s[68:71], s99 offen
    v_mfma_f32_16x16x32_bf16 v[232:235], a[184:187], v[36:39], v[232:235]
    ds_read_b64_tr_b16 v[34:35], v3 offset:24832
    v_mfma_f32_16x16x32_bf16 v[236:239], a[188:191], v[36:39], v[236:239]
    v_mfma_f32_16x16x32_bf16 v[240:243], a[176:179], v[44:47], v[240:243]
    ds_read_b64_tr_b16 v[40:41], v4 offset:24576
    v_mfma_f32_16x16x32_bf16 v[244:247], a[180:183], v[44:47], v[244:247]
    v_mfma_f32_16x16x32_bf16 v[248:251], a[184:187], v[44:47], v[248:251]
    ds_read_b64_tr_b16 v[42:43], v4 offset:24832
    v_mfma_f32_16x16x32_bf16 v[252:255], a[188:191], v[44:47], v[252:255]
    s_waitcnt lgkmcnt(4)
    v_mfma_f32_16x16x32_bf16 v[192:195], a[192:195], v[16:19], v[192:195]
    ds_read_b64_tr_b16 v[20:21], v1 offset:26624
    v_mfma_f32_16x16x32_bf16 v[196:199], a[196:199], v[16:19], v[196:199]
    v_mfma_f32_16x16x32_bf16 v[200:203], a[200:203], v[16:19], v[200:203]
    ds_read_b64_tr_b16 v[22:23], v1 offset:26880
    v_mfma_f32_16x16x32_bf16 v[204:207], a[204:207], v[16:19], v[204:207]
    v_mfma_f32_16x16x32_bf16 v[208:211], a[192:195], v[24:27], v[208:211]
    ds_read_b64_tr_b16 v[28:29], v2 offset:26624
    v_mfma_f32_16x16x32_bf16 v[212:215], a[196:199], v[24:27], v[212:215]
    v_mfma_f32_16x16x32_bf16 v[216:219], a[200:203], v[24:27], v[216:219]
    ds_read_b64_tr_b16 v[30:31], v2 offset:26880
    v_mfma_f32_16x16x32_bf16 v[220:223], a[204:207], v[24:27], v[220:223]
    s_waitcnt lgkmcnt(4)
    v_mfma_f32_16x16x32_bf16 v[224:227], a[192:195], v[32:35], v[224:227]
    ds_read_b64_tr_b16 v[36:37], v3 offset:26624
    v_mfma_f32_16x16x32_bf16 v[228:231], a[196:199], v[32:35], v[228:231]
    v_mfma_f32_16x16x32_bf16 v[232:235], a[200:203], v[32:35], v[232:235]
    ds_read_b64_tr_b16 v[38:39], v3 offset:26880
    v_mfma_f32_16x16x32_bf16 v[236:239], a[204:207], v[32:35], v[236:239]
    v_mfma_f32_16x16x32_bf16 v[240:243], a[192:195], v[40:43], v[240:243]
    ds_read_b64_tr_b16 v[44:45], v4 offset:26624
    v_mfma_f32_16x16x32_bf16 v[244:247], a[196:199], v[40:43], v[244:247]
    v_mfma_f32_16x16x32_bf16 v[248:251], a[200:203], v[40:43], v[248:251]
    ds_read_b64_tr_b16 v[46:47], v4 offset:26880
    v_mfma_f32_16x16x32_bf16 v[252:255], a[204:207], v[40:43], v[252:255]
    s_waitcnt lgkmcnt(4)
    v_mfma_f32_16x16x32_bf16 v[192:195], a[208:211], v[20:23], v[192:195]
    ds_read_b64_tr_b16 v[16:17], v1 offset:28672
    v_mfma_f32_16x16x32_bf16 v[196:199], a[212:215], v[20:23], v[196:199]
    v_mfma_f32_16x16x32_bf16 v[200:203], a[216:219], v[20:23], v[200:203]
    ds_read_b64_tr_b16 v[18:19], v1 offset:28928
    v_mfma_f32_16x16x32_bf16 v[204:207], a[220:223], v[20:23], v[204:207]
    v_mfma_f32_16x16x32_bf16 v[208:211], a[208:211], v[28:31], v[208:211]
    ds_read_b64_tr_b16 v[24:25], v2 offset:28672
    v_mfma_f32_16x16x32_bf16 v[212:215], a[212:215], v[28:31], v[212:215]
    v_mfma_f32_16x16x32_bf16 v[216:219], a[216:219], v[28:31], v[216:219]
    ds_read_b64_tr_b16 v[26:27], v2 offset:28928
    v_mfma_f32_16x16x32_bf16 v[220:223], a[220:223], v[28:31], v[220:223]
    s_waitcnt lgkmcnt(4)
    v_mfma_f32_16x16x32_bf16 v[224:227], a[208:211], v[36:39], v[224:227]
    ds_read_b64_tr_b16 v[32:33], v3 offset:28672
    v_mfma_f32_16x16x32_bf16 v[228:231], a[212:215], v[36:39], v[228:231]
    v_mfma_f32_16x16x32_bf16 v[232:235], a[216:219], v[36:39], v[232:235]
    ds_read_b64_tr_b16 v[34:35], v3 offset:28928
    v_mfma_f32_16x16x32_bf16 v[236:239], a[220:223], v[36:39], v[236:239]
    v_mfma_f32_16x16x32_bf16 v[240:243], a[208:211], v[44:47], v[240:243]
    ds_read_b64_tr_b16 v[40:41], v4 offset:28672
    v_mfma_f32_16x16x32_bf16 v[244:247], a[212:215], v[44:47], v[244:247]
    v_mfma_f32_16x16x32_bf16 v[248:251], a[216:219], v[44:47], v[248:251]
    ds_read_b64_tr_b16 v[42:43], v4 offset:28928
    v_mfma_f32_16x16x32_bf16 v[252:255], a[220:223], v[44:47], v[252:255]
    s_waitcnt lgkmcnt(4)
    v_mfma_f32_16x16x32_bf16 v[192:195], a[224:227], v[16:19], v[192:195]
    ds_read_b64_tr_b16 v[20:21], v1 offset:30720
    v_mfma_f32_16x16x32_bf16 v[196:199], a[228:231], v[16:19], v[196:199]
    v_mfma_f32_16x16x32_bf16 v[200:203], a[232:235], v[16:19], v[200:203]
    ds_read_b64_tr_b16 v[22:23], v1 offset:30976
    v_mfma_f32_16x16x32_bf16 v[204:207], a[236:239], v[16:19], v[204:207]
    v_mfma_f32_16x16x32_bf16 v[208:211], a[224:227], v[24:27], v[208:211]
    ds_read_b64_tr_b16 v[28:29], v2 offset:30720
    v_mfma_f32_16x16x32_bf16 v[212:215], a[228:231], v[24:27], v[212:215]
    v_mfma_f32_16x16x32_bf16 v[216:219], a[232:235], v[24:27], v[216:219]
    ds_read_b64_tr_b16 v[30:31], v2 offset:30976
    v_mfma_f32_16x16x32_bf16 v[220:223], a[236:239], v[24:27], v[220:223]
    s_waitcnt lgkmcnt(4)
    v_mfma_f32_16x16x32_bf16 v[224:227], a[224:227], v[32:35], v[224:227]
    ds_read_b64_tr_b16 v[36:37], v3 offset:30720
    v_mfma_f32_16x16x32_bf16 v[228:231], a[228:231], v[32:35], v[228:231]
    v_mfma_f32_16x16x32_bf16 v[232:235], a[232:235], v[32:35], v[232:235]
    ds_read_b64_tr_b16 v[38:39], v3 offset:30976
    v_mfma_f32_16x16x32_bf16 v[236:239], a[236:239], v[32:35], v[236:239]
    v_mfma_f32_16x16x32_bf16 v[240:243], a[224:227], v[40:43], v[240:243]
    ds_read_b64_tr_b16 v[44:45], v4 offset:30720
    v_mfma_f32_16x16x32_bf16 v[244:247], a[228:231], v[40:43], v[244:247]
    v_mfma_f32_16x16x32_bf16 v[248:251], a[232:235], v[40:43], v[248:251]
    ds_read_b64_tr_b16 v[46:47], v4 offset:30976
    v_mfma_f32_16x16x32_bf16 v[252:255], a[236:239], v[40:43], v[252:255]
    s_waitcnt lgkmcnt(4)
    v_mfma_f32_16x16x32_bf16 v[192:195], a[240:243], v[20:23], v[192:195]
    ds_read_b64_tr_b16 v[16:17], v1 offset:32768
    v_mfma_f32_16x16x32_bf16 v[196:199], a[244:247], v[20:23], v[196:199]
    v_mfma_f32_16x16x32_bf16 v[200:203], a[248:251], v[20:23], v[200:203]
    ds_read_b64_tr_b16 v[18:19], v1 offset:33024
    v_mfma_f32_16x16x32_bf16 v[204:207], a[252:255], v[20:23], v[204:207]
    v_mfma_f32_16x16x32_bf16 v[208:211], a[240:243], v[28:31], v[208:211]
    ds_read_b64_tr_b16 v[24:25], v2 offset:32768
    v_mfma_f32_16x16x32_bf16 v[212:215], a[244:247], v[28:31], v[212:215]
    v_mfma_f32_16x16x32_bf16 v[216:219], a[248:251], v[28:31], v[216:219]
    ds_read_b64_tr_b16 v[26:27], v2 offset:33024
    v_mfma_f32_16x16x32_bf16 v[220:223], a[252:255], v[28:31], v[220:223]
    s_waitcnt lgkmcnt(4)
    v_mfma_f32_16x16x32_bf16 v[224:227], a[240:243], v[36:39], v[224:227]
    ds_read_b64_tr_b16 v[32:33], v3 offset:32768
    v_mfma_f32_16x16x32_bf16 v[228:231], a[244:247], v[36:39], v[228:231]
    v_mfma_f32_16x16x32_bf16 v[232:235], a[248:251], v[36:39], v[232:235]
    ds_read_b64_tr_b16 v[34:35], v3 offset:33024
    v_mfma_f32_16x16x32_bf16 v[236:239], a[252:255], v[36:39], v[236:239]
    v_mfma_f32_16x16x32_bf16 v[240:243], a[240:243], v[44:47], v[240:243]
    ds_read_b64_tr_b16 v[40:41], v4 offset:32768
    v_mfma_f32_16x16x32_bf16 v[244:247], a[244:247], v[44:47], v[244:247]
    v_mfma_f32_16x16x32_bf16 v[248:251], a[248:251], v[44:47], v[248:251]
    ds_read_b64_tr_b16 v[42:43], v4 offset:33024
    v_mfma_f32_16x16x32_bf16 v[252:255], a[252:255], v[44:47], v[252:255]
    s_waitcnt lgkmcnt(4)
    v_mfma_f32_16x16x32_bf16 v[192:195], v[80:83], v[16:19], v[192:195]
    ds_read_b64_tr_b16 v[20:21], v1 offset:34816
    v_mfma_f32_16x16x32_bf16 v[196:199], v[84:87], v[16:19], v[196:199]
    v_mfma_f32_16x16x32_bf16 v[200:203], v[88:91], v[16:19], v[200:203]
    ds_read_b64_tr_b16 v[22:23], v1 offset:35072
    v_mfma_f32_16x16x32_bf16 v[204:207], v[92:95], v[16:19], v[204:207]
    v_mfma_f32_16x16x32_bf16 v[208:211], v[80:83], v[24:27], v[208:211]
    ds_read_b64_tr_b16 v[28:29], v2 offset:34816
    v_mfma_f32_16x16x32_bf16 v[212:215], v[84:87], v[24:27], v[212:215]
    v_mfma_f32_16x16x32_bf16 v[216:219], v[88:91], v[24:27], v[216:219]
    ds_read_b64_tr_b16 v[30:31], v2 offset:35072
    v_mfma_f32_16x16x32_bf16 v[220:223], v[92:95], v[24:27], v[220:223]
    s_waitcnt lgkmcnt(4)
    v_mfma_f32_16x16x32_bf16 v[224:227], v[80:83], v[32:35], v[224:227]
    ds_read_b64_tr_b16 v[36:37], v3 offset:34816
    v_mfma_f32_16x16x32_bf16 v[228:231], v[84:87], v[32:35], v[228:231]
    v_mfma_f32_16x16x32_bf16 v[232:235], v[88:91], v[32:35], v[232:235]
    ds_read_b64_tr_b16 v[38:39], v3 offset:35072
    v_mfma_f32_16x16x32_bf16 v[236:239], v[92:95], v[32:35], v[236:239]
    v_mfma_f32_16x16x32_bf16 v[240:243], v[80:83], v[40:43], v[240:243]
    ds_read_b64_tr_b16 v[44:45], v4 offset:34816
    v_mfma_f32_16x16x32_bf16 v[244:247], v[84:87], v[40:43], v[244:247]
    v_mfma_f32_16x16x32_bf16 v[248:251], v[88:91], v[40:43], v[248:251]
    ds_read_b64_tr_b16 v[46:47], v4 offset:35072
    v_mfma_f32_16x16x32_bf16 v[252:255], v[92:95], v[40:43], v[252:255]
    s_waitcnt lgkmcnt(4)
    v_mfma_f32_16x16x32_bf16 v[192:195], v[96:99], v[20:23], v[192:195]
    v_mfma_f32_16x16x32_bf16 v[196:199], v[100:103], v[20:23], v[196:199]
    v_mfma_f32_16x16x32_bf16 v[200:203], v[104:107], v[20:23], v[200:203]
    v_mfma_f32_16x16x32_bf16 v[204:207], v[108:111], v[20:23], v[204:207]
    s_waitcnt vmcnt(1) lgkmcnt(0)
    s_barrier
    v_mfma_f32_16x16x32_bf16 v[208:211], v[96:99], v[28:31], v[208:211]
    ds_read_b64_tr_b16 v[16:17], v5 offset:0
    v_mfma_f32_16x16x32_bf16 v[212:215], v[100:103], v[28:31], v[212:215]
    ds_read_b64_tr_b16 v[18:19], v5 offset:256
    v_mfma_f32_16x16x32_bf16 v[216:219], v[104:107], v[28:31], v[216:219]
    ds_read_b64_tr_b16 v[24:25], v6 offset:0
    v_mfma_f32_16x16x32_bf16 v[220:223], v[108:111], v[28:31], v[220:223]
    ds_read_b64_tr_b16 v[26:27], v6 offset:256
    v_mfma_f32_16x16x32_bf16 v[224:227], v[96:99], v[36:39], v[224:227]
    ds_read_b64_tr_b16 v[32:33], v7 offset:0
    v_mfma_f32_16x16x32_bf16 v[228:231], v[100:103], v[36:39], v[228:231]
    ds_read_b64_tr_b16 v[34:35], v7 offset:256
    v_mfma_f32_16x16x32_bf16 v[232:235], v[104:107], v[36:39], v[232:235]
    ds_read_b64_tr_b16 v[40:41], v8 offset:0
    v_mfma_f32_16x16x32_bf16 v[236:239], v[108:111], v[36:39], v[236:239]
    ds_read_b64_tr_b16 v[42:43], v8 offset:256
    v_mfma_f32_16x16x32_bf16 v[240:243], v[96:99], v[44:47], v[240:243]
    v_mfma_f32_16x16x32_bf16 v[244:247], v[100:103], v[44:47], v[244:247]
    v_mfma_f32_16x16x32_bf16 v[248:251], v[104:107], v[44:47], v[248:251]
    v_mfma_f32_16x16x32_bf16 v[252:255], v[108:111], v[44:47], v[252:255]
    v_swap_b32 v1, v5
    v_swap_b32 v2, v6
    v_swap_b32 v3, v7
    v_swap_b32 v4, v8
    s_xor_b32 s48, s48, s54
    s_mov_b32 s49, s73
    s_mov_b32 s73, s74
    s_mul_i32 s62, s41, 19456
    s_mul_i32 s53, s40, 2432
    s_add_u32 s62, s62, s53
    s_add_u32 s62, s62, 2368512
    s_sub_u32 s52, s50, 36
    s_lshl_b32 s52, s52, 5
    v_and_b32 v122, 1, v13
    v_mul_u32_u24 v122, 304, v122
    v_lshrrev_b32 v124, 1, v13
    v_lshl_add_u32 v122, v124, 3, v122
    v_and_b32 v124, 15, v0
    v_add3_u32 v124, s52, v124, 0
    v_mul_u32_u24 v123, 3641, v124
    v_lshrrev_b32 v123, 16, v123
    v_mul_u32_u24 v120, 18, v123
    v_sub_u32 v124, v124, v120
    v_mul_u32_u24 v123, 155648, v123
    v_lshl_add_u32 v123, v124, 4, v123
    v_add_u32 v123, v123, v122
    v_cvt_pk_bf16_f32 v48, v192, v193
    v_cvt_pk_bf16_f32 v49, v194, v195
    buffer_store_dwordx2 v[48:49], v123, s[28:31], s62 offen offset:0
    v_cvt_pk_bf16_f32 v50, v196, v197
    v_cvt_pk_bf16_f32 v51, v198, v199
    buffer_store_dwordx2 v[50:51], v123, s[28:31], s62 offen offset:608
    v_cvt_pk_bf16_f32 v52, v200, v201
    v_cvt_pk_bf16_f32 v53, v202, v203
    buffer_store_dwordx2 v[52:53], v123, s[28:31], s62 offen offset:1216
    v_cvt_pk_bf16_f32 v54, v204, v205
    v_cvt_pk_bf16_f32 v55, v206, v207
    buffer_store_dwordx2 v[54:55], v123, s[28:31], s62 offen offset:1824
    v_and_b32 v124, 15, v0
    v_add3_u32 v124, s52, v124, 16
    v_mul_u32_u24 v123, 3641, v124
    v_lshrrev_b32 v123, 16, v123
    v_mul_u32_u24 v120, 18, v123
    v_sub_u32 v124, v124, v120
    v_mul_u32_u24 v123, 155648, v123
    v_lshl_add_u32 v123, v124, 4, v123
    v_add_u32 v123, v123, v122
    v_cvt_pk_bf16_f32 v56, v208, v209
    v_cvt_pk_bf16_f32 v57, v210, v211
    buffer_store_dwordx2 v[56:57], v123, s[28:31], s62 offen offset:0
    v_cvt_pk_bf16_f32 v58, v212, v213
    v_cvt_pk_bf16_f32 v59, v214, v215
    buffer_store_dwordx2 v[58:59], v123, s[28:31], s62 offen offset:608
    v_cvt_pk_bf16_f32 v60, v216, v217
    v_cvt_pk_bf16_f32 v61, v218, v219
    buffer_store_dwordx2 v[60:61], v123, s[28:31], s62 offen offset:1216
    v_cvt_pk_bf16_f32 v62, v220, v221
    v_cvt_pk_bf16_f32 v63, v222, v223
    buffer_store_dwordx2 v[62:63], v123, s[28:31], s62 offen offset:1824
    v_and_b32 v124, 15, v0
    v_add3_u32 v124, s52, v124, 32
    v_mul_u32_u24 v123, 3641, v124
    v_lshrrev_b32 v123, 16, v123
    v_mul_u32_u24 v120, 18, v123
    v_sub_u32 v124, v124, v120
    v_mul_u32_u24 v123, 155648, v123
    v_lshl_add_u32 v123, v124, 4, v123
    v_add_u32 v123, v123, v122
    v_cvt_pk_bf16_f32 v48, v224, v225
    v_cvt_pk_bf16_f32 v49, v226, v227
    buffer_store_dwordx2 v[48:49], v123, s[28:31], s62 offen offset:0
    v_cvt_pk_bf16_f32 v50, v228, v229
    v_cvt_pk_bf16_f32 v51, v230, v231
    buffer_store_dwordx2 v[50:51], v123, s[28:31], s62 offen offset:608
    v_cvt_pk_bf16_f32 v52, v232, v233
    v_cvt_pk_bf16_f32 v53, v234, v235
    buffer_store_dwordx2 v[52:53], v123, s[28:31], s62 offen offset:1216
    v_cvt_pk_bf16_f32 v54, v236, v237
    v_cvt_pk_bf16_f32 v55, v238, v239
    buffer_store_dwordx2 v[54:55], v123, s[28:31], s62 offen offset:1824
    v_and_b32 v124, 15, v0
    v_add3_u32 v124, s52, v124, 48
    v_mul_u32_u24 v123, 3641, v124
    v_lshrrev_b32 v123, 16, v123
    v_mul_u32_u24 v120, 18, v123
    v_sub_u32 v124, v124, v120
    v_mul_u32_u24 v123, 155648, v123
    v_lshl_add_u32 v123, v124, 4, v123
    v_add_u32 v123, v123, v122
    v_cvt_pk_bf16_f32 v56, v240, v241
    v_cvt_pk_bf16_f32 v57, v242, v243
    buffer_store_dwordx2 v[56:57], v123, s[28:31], s62 offen offset:0
    v_cvt_pk_bf16_f32 v58, v244, v245
    v_cvt_pk_bf16_f32 v59, v246, v247
    buffer_store_dwordx2 v[58:59], v123, s[28:31], s62 offen offset:608
    v_cvt_pk_bf16_f32 v60, v248, v249
    v_cvt_pk_bf16_f32 v61, v250, v251
    buffer_store_dwordx2 v[60:61], v123, s[28:31], s62 offen offset:1216
    v_cvt_pk_bf16_f32 v62, v252, v253
    v_cvt_pk_bf16_f32 v63, v254, v255
    buffer_store_dwordx2 v[62:63], v123, s[28:31], s62 offen offset:1824
    s_cmp_lt_u32 s58, s59
    s_cbranch_scc1 L_k1_vloop
    s_cmp_eq_u32 s42, 28
    s_cbranch_scc1 L_k1_wodone
    s_xor_b32 s59, s48, s54
    s_sub_u32 s59, s59, s98
L_k1_wojob:
    s_mov_b32 s52, s59
    v_bfe_u32 v124, v0, 2, 2
    v_and_b32 v115, 3, v0
    v_lshlrev_b32 v115, 3, v115
    s_waitcnt lgkmcnt(0)
    s_lshr_b32 s53, s40, 1
    s_mul_i32 s53, s53, 18432
    s_add_u32 s52, s52, s53
    s_and_b32 s53, s40, 1
    s_mul_i32 s53, s53, 576
    s_add_u32 s52, s52, s53
    v_and_b32 v123, 1, v13
    v_lshl_add_u32 v123, v123, 2, v124
    v_mul_u32_u24 v123, 1152, v123
    v_lshrrev_b32 v124, 1, v13
    v_lshl_add_u32 v115, v124, 5, v115
    v_add3_u32 v123, v123, v115, s52
    ds_read_b64_tr_b16 v[128:129], v123 offset:0
    ds_read_b64_tr_b16 v[130:131], v123 offset:9216
    ds_read_b64_tr_b16 v[132:133], v123 offset:64
    ds_read_b64_tr_b16 v[134:135], v123 offset:9280
    ds_read_b64_tr_b16 v[136:137], v123 offset:128
    ds_read_b64_tr_b16 v[138:139], v123 offset:9344
    ds_read_b64_tr_b16 v[140:141], v123 offset:192
    ds_read_b64_tr_b16 v[142:143], v123 offset:9408
    ds_read_b64_tr_b16 v[144:145], v123 offset:256
    ds_read_b64_tr_b16 v[146:147], v123 offset:9472
    ds_read_b64_tr_b16 v[148:149], v123 offset:320
    ds_read_b64_tr_b16 v[150:151], v123 offset:9536
    ds_read_b64_tr_b16 v[152:153], v123 offset:384
    ds_read_b64_tr_b16 v[154:155], v123 offset:9600
    s_waitcnt lgkmcnt(8)
    ds_read_b64_tr_b16 v[156:157], v123 offset:448
    ds_read_b64_tr_b16 v[158:159], v123 offset:9664
    ds_read_b64_tr_b16 v[160:161], v123 offset:512
    ds_read_b64_tr_b16 v[162:163], v123 offset:9728
    s_waitcnt lgkmcnt(0)
    s_mov_b32 s55, s3
    s_lshr_b32 s52, s55, 3
    s_add_u32 s52, s52, 32
    s_cmp_ge_u32 s40, 2
    s_cselect_b32 s53, s52, s55
    s_lshr_b32 s52, s53, 1
    s_mul_i32 s52, s52, 36864
    s_and_b32 s53, s53, 1
    s_lshl_b32 s53, s53, 9
    s_add_u32 s53, s53, s52
    s_and_b32 s52, s40, 1
    s_mul_i32 s52, s52, 18432
    s_add_u32 s53, s53, s52
    s_add_u32 s53, s53, 5308416
    v_lshl_add_u32 v124, v124, 10, v14
    v_and_b32 v123, 1, v13
    s_cmp_ge_u32 s40, 2
    s_cbranch_scc1 L_k1_woleft
    v_lshl_add_u32 v124, v123, 8, v124
    buffer_store_dwordx4 v[128:131], v124, s[80:83], s53 offen offset:0
    buffer_store_dwordx4 v[132:135], v124, s[80:83], s53 offen offset:2048
    s_add_u32 s53, s53, 4096
    buffer_store_dwordx4 v[136:139], v124, s[80:83], s53 offen offset:0
    buffer_store_dwordx4 v[140:143], v124, s[80:83], s53 offen offset:2048
    s_add_u32 s53, s53, 4096
    buffer_store_dwordx4 v[144:147], v124, s[80:83], s53 offen offset:0
    buffer_store_dwordx4 v[148:151], v124, s[80:83], s53 offen offset:2048
    s_add_u32 s53, s53, 4096
    buffer_store_dwordx4 v[152:155], v124, s[80:83], s53 offen offset:0
    buffer_store_dwordx4 v[156:159], v124, s[80:83], s53 offen offset:2048
    s_add_u32 s53, s53, 4096
    buffer_store_dwordx4 v[160:163], v124, s[80:83], s53 offen offset:0
    s_branch L_k1_fin
L_k1_woleft:
    s_bfe_u32 s52, s55, 0x10002
    s_lshl_b32 s52, s52, 8
    s_add_u32 s53, s53, s52
    s_and_b32 s52, s55, 3
    s_lshl_b32 s52, s52, 2
    s_add_u32 s53, s53, s52
    v_lshl_add_u32 v124, v123, 30, v124
    buffer_store_dword v128, v124, s[80:83], s53 offen offset:0
    buffer_store_dword v132, v124, s[80:83], s53 offen offset:2048
    s_add_u32 s53, s53, 4096
    buffer_store_dword v136, v124, s[80:83], s53 offen offset:0
    buffer_store_dword v140, v124, s[80:83], s53 offen offset:2048
    s_add_u32 s53, s53, 4096
    buffer_store_dword v144, v124, s[80:83], s53 offen offset:0
    buffer_store_dword v148, v124, s[80:83], s53 offen offset:2048
    s_add_u32 s53, s53, 4096
    buffer_store_dword v152, v124, s[80:83], s53 offen offset:0
    buffer_store_dword v156, v124, s[80:83], s53 offen offset:2048
    s_add_u32 s53, s53, 4096
    buffer_store_dword v160, v124, s[80:83], s53 offen offset:0
L_k1_fin:
    s_and_b32 s52, s3, 3
    s_add_u32 s3, s3, 1
    s_add_u32 s59, s59, 36864
    s_cmp_lg_u32 s52, 0
    s_cbranch_scc1 L_k1_wodone
    s_waitcnt vmcnt(0)
    s_branch L_k1_wojob
L_k1_wodone:
L_k1_end:
    s_endpgm
.globl mid_kernel
.p2align 8
.type mid_kernel,@function
mid_kernel:
    s_cmp_ge_u32 s2, 512
    s_cbranch_scc1 L_k2_end
    s_load_dwordx2 s[6:7], s[0:1], 72
    v_lshrrev_b32 v1, 6, v0
    v_and_b32 v0, 63, v0
    v_readfirstlane_b32 s20, v1
    s_cmp_ge_u32 s2, 256
    s_cbranch_scc1 L_k2_down
    s_setprio 2
    s_and_b32 s21, s2, 7
    s_lshl_b32 s21, s21, 2
    s_bfe_u32 s23, s2, 0x20003
    s_add_u32 s21, s21, s23
    s_lshr_b32 s22, s2, 5
    v_lshlrev_b32 v5, 4, v0
    v_and_b32 v11, 0x1f0, v5
    s_mul_i32 s29, s21, 155648
    s_lshl_b32 s33, s20, 10
    s_add_u32 s32, s29, s33
    s_cmp_eq_u32 s20, 3
    s_mov_b32 s35, 4096
    s_cmov_b32 s35, 3072
    s_mul_i32 s23, s21, 73728
    s_mul_i32 s24, s22, 9216
    s_add_u32 s23, s23, s24
    s_lshr_b32 s24, s20, 1
    s_lshl_b32 s24, s24, 9
    s_add_u32 s24, s24, s23
    s_and_b32 s36, s20, 1
    s_lshl_b32 s36, s36, 3
    s_add_u32 s24, s24, s36
    s_add_u32 s24, s24, 8192
    s_lshl_b32 s36, s20, 11
    s_add_u32 s23, s23, s36
    s_waitcnt lgkmcnt(0)
    s_add_u32 s8, s6, 2359296
    s_addc_u32 s9, s7, 0
    s_mov_b32 s10, 2359296
    s_mov_b32 s11, 0x00020000
    s_add_u32 s12, s6, 4718592
    s_addc_u32 s13, s7, 0
    s_mov_b32 s14, 4980736
    s_mov_b32 s15, 0x00020000
    buffer_load_dwordx4 v[12:15], v5, s[8:11], s23 offen offset:0
    buffer_load_dwordx4 v[16:19], v5, s[8:11], s23 offen offset:1024
    buffer_load_dwordx2 v[6:7], v11, s[8:11], s24 offen
    s_add_u32 m0, s33, 0
    s_nop 0
    buffer_load_dwordx4 v5, s[12:15], s32 offen lds
    s_add_u32 s32, s32, 4096
    s_add_u32 m0, s33, 4096
    s_nop 0
    buffer_load_dwordx4 v5, s[12:15], s32 offen lds
    s_add_u32 s32, s32, 4096
    s_add_u32 m0, s33, 8192
    s_nop 0
    buffer_load_dwordx4 v5, s[12:15], s32 offen lds
    s_add_u32 s32, s32, 4096
    s_add_u32 m0, s33, 12288
    s_nop 0
    buffer_load_dwordx4 v5, s[12:15], s32 offen lds
    s_add_u32 s32, s32, s35
    s_add_u32 m0, m0, s35
    s_nop 0
    buffer_load_dwordx4 v5, s[12:15], s32 offen lds
    s_sub_u32 s32, s32, s35
    s_add_u32 s32, s32, 7168
    s_add_u32 s33, s33, 19456
    s_add_u32 m0, s33, 0
    s_nop 0
    buffer_load_dwordx4 v5, s[12:15], s32 offen lds
    s_add_u32 s32, s32, 4096
    s_add_u32 m0, s33, 4096
    s_nop 0
    buffer_load_dwordx4 v5, s[12:15], s32 offen lds
    s_add_u32 s32, s32, 4096
    s_add_u32 m0, s33, 8192
    s_nop 0
    buffer_load_dwordx4 v5, s[12:15], s32 offen lds
    s_add_u32 s32, s32, 4096
    s_add_u32 m0, s33, 12288
    s_nop 0
    buffer_load_dwordx4 v5, s[12:15], s32 offen lds
    s_add_u32 s32, s32, s35
    s_add_u32 m0, m0, s35
    s_nop 0
    buffer_load_dwordx4 v5, s[12:15], s32 offen lds
    s_sub_u32 s32, s32, s35
    s_add_u32 s32, s32, 7168
    s_add_u32 s33, s33, 19456
    s_add_u32 m0, s33, 0
    s_nop 0
    buffer_load_dwordx4 v5, s[12:15], s32 offen lds
    s_add_u32 s32, s32, 4096
    s_add_u32 m0, s33, 4096
    s_nop 0
    buffer_load_dwordx4 v5, s[12:15], s32 offen lds
    s_add_u32 s32, s32, 4096
    s_add_u32 m0, s33, 8192
    s_nop 0
    buffer_load_dwordx4 v5, s[12:15], s32 offen lds
    s_add_u32 s32, s32, 4096
    s_add_u32 m0, s33, 12288
    s_nop 0
    buffer_load_dwordx4 v5, s[12:15], s32 offen lds
    s_add_u32 s32, s32, s35
    s_add_u32 m0, m0, s35
    s_nop 0
    buffer_load_dwordx4 v5, s[12:15], s32 offen lds
    s_sub_u32 s32, s32, s35
    s_add_u32 s32, s32, 7168
    s_add_u32 s33, s33, 19456
    s_mov_b32 s16, s6
    s_mov_b32 s17, s7
    s_mov_b32 s18, 2359296
    s_mov_b32 s19, 0x00020000
    s_mov_b32 s37, s14
    s_lshl_b32 s28, s22, 3
    s_lshl_b32 s23, s20, 1
    s_add_u32 s28, s28, s23
    v_lshrrev_b32 v8, 5, v0
    v_mul_u32_u24 v10, 304, v8
    v_add_u32 v10, v10, v11
    v_cmp_lt_u32 vcc, 288, v11
    v_mov_b32 v9, 0x100000
    s_nop 0
    v_cndmask_b32 v10, v10, v9, vcc
    v_mov_b32 v1, v5
    v_add_u32 v2, 19456, v5
    v_add_u32 v3, 9216, v10
    v_add_u32 v4, 28672, v10
    s_mov_b32 s34, 19456
    v_cmp_gt_u32 s[30:31], 32, v0
    v_mov_b32 v65, 0
    v_mov_b32 v66, 0
    v_mov_b32 v69, 0
    v_mov_b32 v70, 0
    v_mov_b32 v144, 0
    v_mov_b32 v145, 0
    v_mov_b32 v146, 0
    v_mov_b32 v147, 0
    v_mov_b32 v148, 0
    v_mov_b32 v149, 0
    v_mov_b32 v150, 0
    v_mov_b32 v151, 0
    v_mov_b32 v152, 0
    v_mov_b32 v153, 0
    v_mov_b32 v154, 0
    v_mov_b32 v155, 0
    v_mov_b32 v156, 0
    v_mov_b32 v157, 0
    v_mov_b32 v158, 0
    v_mov_b32 v159, 0
    v_mov_b32 v73, 0
    v_mov_b32 v74, 0
    v_mov_b32 v77, 0
    v_mov_b32 v78, 0
    v_mov_b32 v160, 0
    v_mov_b32 v161, 0
    v_mov_b32 v162, 0
    v_mov_b32 v163, 0
    v_mov_b32 v164, 0
    v_mov_b32 v165, 0
    v_mov_b32 v166, 0
    v_mov_b32 v167, 0
    v_mov_b32 v168, 0
    v_mov_b32 v169, 0
    v_mov_b32 v170, 0
    v_mov_b32 v171, 0
    v_mov_b32 v172, 0
    v_mov_b32 v173, 0
    v_mov_b32 v174, 0
    v_mov_b32 v175, 0
    v_mov_b32 v56, 0
    v_mov_b32 v40, 0
    v_mov_b32 v57, 0
    v_mov_b32 v41, 0
    v_mov_b32 v58, 0
    v_mov_b32 v42, 0
    v_mov_b32 v59, 0
    v_mov_b32 v43, 0
    v_mov_b32 v60, 0
    v_mov_b32 v44, 0
    v_mov_b32 v61, 0
    v_mov_b32 v45, 0
    v_mov_b32 v62, 0
    v_mov_b32 v46, 0
    v_mov_b32 v63, 0
    v_mov_b32 v47, 0
    s_waitcnt vmcnt(10)
    s_barrier
    ds_read_b128 v[20:23], v1
    ds_read_b128 v[28:31], v1 offset:8192
    ds_read_b128 v[24:27], v1 offset:1024
    ds_read_b128 v[32:35], v3
    ds_read_b128 v[36:39], v3 offset:608
    v_cndmask_b32 v64, 0, v6, s[30:31]
    v_cndmask_b32 v67, 0, v6, s[30:31]
    v_cndmask_b32 v68, v6, 0, s[30:31]
    v_cndmask_b32 v71, v6, 0, s[30:31]
    v_cndmask_b32 v72, 0, v7, s[30:31]
    v_cndmask_b32 v75, 0, v7, s[30:31]
    v_cndmask_b32 v76, v7, 0, s[30:31]
    v_cndmask_b32 v79, v7, 0, s[30:31]
    s_waitcnt lgkmcnt(3)
    v_mfma_f32_32x32x16_bf16 v[80:95], v[20:23], v[12:15], 0
    v_mfma_f32_32x32x8_bf16 v[80:95], v[28:29], v[64:65], v[80:95]
    v_mfma_f32_32x32x16_bf16 v[96:111], v[20:23], v[16:19], 0
    v_mfma_f32_32x32x8_bf16 v[96:111], v[28:29], v[72:73], v[96:111]
    s_nop 9
    v_max3_f32 v6, v80, v81, v82
    v_max3_f32 v6, v83, v84, v6
    v_max3_f32 v6, v85, v86, v6
    v_max3_f32 v6, v87, v88, v6
    v_max3_f32 v6, v89, v90, v6
    v_max3_f32 v6, v91, v92, v6
    v_max3_f32 v6, v93, v94, v6
    v_max_f32 v6, v95, v6
    v_max3_f32 v7, v96, v97, v98
    v_max3_f32 v7, v99, v100, v7
    v_max3_f32 v7, v101, v102, v7
    v_max3_f32 v7, v103, v104, v7
    v_max3_f32 v7, v105, v106, v7
    v_max3_f32 v7, v107, v108, v7
    v_max3_f32 v7, v109, v110, v7
    v_max_f32 v7, v111, v7
    v_mov_b32 v8, v6
    v_mov_b32 v9, v7
    s_nop 1
    v_permlane32_swap_b32 v6, v8
    v_permlane32_swap_b32 v7, v9
    s_nop 0
    v_max_f32 v6, v6, v8
    v_max_f32 v7, v7, v9
    v_sub_f32 v112, 0, v6
    v_sub_f32 v113, 0, v6
    v_sub_f32 v114, 0, v6
    v_sub_f32 v115, 0, v6
    v_sub_f32 v116, 0, v6
    v_sub_f32 v117, 0, v6
    v_sub_f32 v118, 0, v6
    v_sub_f32 v119, 0, v6
    v_sub_f32 v120, 0, v6
    v_sub_f32 v121, 0, v6
    v_sub_f32 v122, 0, v6
    v_sub_f32 v123, 0, v6
    v_sub_f32 v124, 0, v6
    v_sub_f32 v125, 0, v6
    v_sub_f32 v126, 0, v6
    v_sub_f32 v127, 0, v6
    v_sub_f32 v128, 0, v7
    v_sub_f32 v129, 0, v7
    v_sub_f32 v130, 0, v7
    v_sub_f32 v131, 0, v7
    v_sub_f32 v132, 0, v7
    v_sub_f32 v133, 0, v7
    v_sub_f32 v134, 0, v7
    v_sub_f32 v135, 0, v7
    v_sub_f32 v136, 0, v7
    v_sub_f32 v137, 0, v7
    v_sub_f32 v138, 0, v7
    v_sub_f32 v139, 0, v7
    v_sub_f32 v140, 0, v7
    v_sub_f32 v141, 0, v7
    v_sub_f32 v142, 0, v7
    v_sub_f32 v143, 0, v7
    v_add_f32 v80, v80, v112
    v_add_f32 v81, v81, v112
    v_add_f32 v82, v82, v112
    v_add_f32 v83, v83, v112
    v_add_f32 v84, v84, v112
    v_add_f32 v85, v85, v112
    v_add_f32 v86, v86, v112
    v_add_f32 v87, v87, v112
    v_add_f32 v88, v88, v112
    v_add_f32 v89, v89, v112
    v_add_f32 v90, v90, v112
    v_add_f32 v91, v91, v112
    v_add_f32 v92, v92, v112
    v_add_f32 v93, v93, v112
    v_add_f32 v94, v94, v112
    v_add_f32 v95, v95, v112
    s_mov_b32 s25, 0
    s_waitcnt lgkmcnt(0)
    s_setprio 0
L_at_loop:
    v_mfma_f32_32x32x16_bf16 v[96:111], v[20:23], v[16:19], v[128:143]
    v_exp_f32 v80, v80
    v_exp_f32 v81, v81
    v_exp_f32 v82, v82
    v_exp_f32 v83, v83
    v_cvt_pk_bf16_f32 v48, v80, v81
    v_cvt_pk_bf16_f32 v49, v82, v83
    v_mfma_f32_32x32x8_bf16 v[96:111], v[28:29], v[72:73], v[96:111]
    v_exp_f32 v84, v84
    v_exp_f32 v85, v85
    v_exp_f32 v86, v86
    v_exp_f32 v87, v87
    v_cvt_pk_bf16_f32 v50, v84, v85
    v_cvt_pk_bf16_f32 v51, v86, v87
    v_mfma_f32_32x32x16_bf16 v[160:175], v[40:43], v[56:59], v[160:175]
    v_exp_f32 v88, v88
    v_exp_f32 v89, v89
    v_exp_f32 v90, v90
    v_exp_f32 v91, v91
    v_cvt_pk_bf16_f32 v52, v88, v89
    v_cvt_pk_bf16_f32 v53, v90, v91
    v_mfma_f32_32x32x16_bf16 v[160:175], v[44:47], v[60:63], v[160:175]
    s_waitcnt lgkmcnt(0)
    v_exp_f32 v92, v92
    v_exp_f32 v93, v93
    v_exp_f32 v94, v94
    v_exp_f32 v95, v95
    v_cvt_pk_bf16_f32 v54, v92, v93
    v_cvt_pk_bf16_f32 v55, v94, v95
    v_mfma_f32_32x32x16_bf16 v[80:95], v[24:27], v[12:15], v[112:127]
    ds_read_b128 v[40:43], v3 offset:1216
    v_exp_f32 v96, v96
    v_exp_f32 v97, v97
    v_exp_f32 v98, v98
    v_exp_f32 v99, v99
    v_cvt_pk_bf16_f32 v56, v96, v97
    v_cvt_pk_bf16_f32 v57, v98, v99
    v_mfma_f32_32x32x8_bf16 v[80:95], v[28:29], v[66:67], v[80:95]
    v_exp_f32 v100, v100
    v_exp_f32 v101, v101
    v_exp_f32 v102, v102
    v_exp_f32 v103, v103
    v_cvt_pk_bf16_f32 v58, v100, v101
    v_cvt_pk_bf16_f32 v59, v102, v103
    v_mfma_f32_32x32x16_bf16 v[144:159], v[32:35], v[48:51], v[144:159]
    ds_read_b128 v[44:47], v3 offset:1824
    v_exp_f32 v104, v104
    v_exp_f32 v105, v105
    v_exp_f32 v106, v106
    v_exp_f32 v107, v107
    v_cvt_pk_bf16_f32 v60, v104, v105
    v_cvt_pk_bf16_f32 v61, v106, v107
    v_mfma_f32_32x32x16_bf16 v[144:159], v[36:39], v[52:55], v[144:159]
    ds_read_b128 v[20:23], v1 offset:2048
    v_exp_f32 v108, v108
    v_exp_f32 v109, v109
    v_exp_f32 v110, v110
    v_exp_f32 v111, v111
    v_cvt_pk_bf16_f32 v62, v108, v109
    v_cvt_pk_bf16_f32 v63, v110, v111
    v_mfma_f32_32x32x16_bf16 v[96:111], v[24:27], v[16:19], v[128:143]
    s_cmp_lt_u32 s25, 5
    v_exp_f32 v80, v80
    v_exp_f32 v81, v81
    v_exp_f32 v82, v82
    v_exp_f32 v83, v83
    v_cvt_pk_bf16_f32 v48, v80, v81
    v_cvt_pk_bf16_f32 v49, v82, v83
    v_mfma_f32_32x32x8_bf16 v[96:111], v[28:29], v[74:75], v[96:111]
    v_exp_f32 v84, v84
    v_exp_f32 v85, v85
    v_exp_f32 v86, v86
    v_exp_f32 v87, v87
    v_cvt_pk_bf16_f32 v50, v84, v85
    v_cvt_pk_bf16_f32 v51, v86, v87
    v_mfma_f32_32x32x16_bf16 v[160:175], v[32:35], v[56:59], v[160:175]
    s_cselect_b32 s14, s37, 0
    v_exp_f32 v88, v88
    v_exp_f32 v89, v89
    v_exp_f32 v90, v90
    v_exp_f32 v91, v91
    v_cvt_pk_bf16_f32 v52, v88, v89
    v_cvt_pk_bf16_f32 v53, v90, v91
    v_mfma_f32_32x32x16_bf16 v[160:175], v[36:39], v[60:63], v[160:175]
    s_waitcnt lgkmcnt(0)
    v_exp_f32 v92, v92
    v_exp_f32 v93, v93
    v_exp_f32 v94, v94
    v_exp_f32 v95, v95
    v_cvt_pk_bf16_f32 v54, v92, v93
    v_cvt_pk_bf16_f32 v55, v94, v95
    v_mfma_f32_32x32x16_bf16 v[80:95], v[20:23], v[12:15], v[112:127]
    ds_read_b128 v[32:35], v3 offset:2432
    v_exp_f32 v96, v96
    v_exp_f32 v97, v97
    v_exp_f32 v98, v98
    v_exp_f32 v99, v99
    v_cvt_pk_bf16_f32 v56, v96, v97
    v_cvt_pk_bf16_f32 v57, v98, v99
    v_mfma_f32_32x32x8_bf16 v[80:95], v[30:31], v[64:65], v[80:95]
    v_exp_f32 v100, v100
    v_exp_f32 v101, v101
    v_exp_f32 v102, v102
    v_exp_f32 v103, v103
    v_cvt_pk_bf16_f32 v58, v100, v101
    v_cvt_pk_bf16_f32 v59, v102, v103
    v_mfma_f32_32x32x16_bf16 v[144:159], v[40:43], v[48:51], v[144:159]
    ds_read_b128 v[36:39], v3 offset:3040
    v_exp_f32 v104, v104
    v_exp_f32 v105, v105
    v_exp_f32 v106, v106
    v_exp_f32 v107, v107
    v_cvt_pk_bf16_f32 v60, v104, v105
    v_cvt_pk_bf16_f32 v61, v106, v107
    v_mfma_f32_32x32x16_bf16 v[144:159], v[44:47], v[52:55], v[144:159]
    ds_read_b128 v[24:27], v1 offset:3072
    v_exp_f32 v108, v108
    v_exp_f32 v109, v109
    v_exp_f32 v110, v110
    v_exp_f32 v111, v111
    v_cvt_pk_bf16_f32 v62, v108, v109
    v_cvt_pk_bf16_f32 v63, v110, v111
    v_mfma_f32_32x32x16_bf16 v[96:111], v[20:23], v[16:19], v[128:143]
    s_waitcnt vmcnt(5)
    s_barrier
    v_exp_f32 v80, v80
    v_exp_f32 v81, v81
    v_exp_f32 v82, v82
    v_exp_f32 v83, v83
    v_cvt_pk_bf16_f32 v48, v80, v81
    v_cvt_pk_bf16_f32 v49, v82, v83
    v_mfma_f32_32x32x8_bf16 v[96:111], v[30:31], v[72:73], v[96:111]
    v_exp_f32 v84, v84
    v_exp_f32 v85, v85
    v_exp_f32 v86, v86
    v_exp_f32 v87, v87
    v_cvt_pk_bf16_f32 v50, v84, v85
    v_cvt_pk_bf16_f32 v51, v86, v87
    v_mfma_f32_32x32x16_bf16 v[160:175], v[40:43], v[56:59], v[160:175]
    s_add_u32 m0, s33, 0
    v_exp_f32 v88, v88
    v_exp_f32 v89, v89
    v_exp_f32 v90, v90
    v_exp_f32 v91, v91
    v_cvt_pk_bf16_f32 v52, v88, v89
    v_cvt_pk_bf16_f32 v53, v90, v91
    v_mfma_f32_32x32x16_bf16 v[160:175], v[44:47], v[60:63], v[160:175]
    s_waitcnt lgkmcnt(0)
    v_exp_f32 v92, v92
    v_exp_f32 v93, v93
    v_exp_f32 v94, v94
    v_exp_f32 v95, v95
    v_cvt_pk_bf16_f32 v54, v92, v93
    v_cvt_pk_bf16_f32 v55, v94, v95
    v_mfma_f32_32x32x16_bf16 v[80:95], v[24:27], v[12:15], v[112:127]
    ds_read_b128 v[40:43], v3 offset:3648
    v_exp_f32 v96, v96
    v_exp_f32 v97, v97
    v_exp_f32 v98, v98
    v_exp_f32 v99, v99
    v_cvt_pk_bf16_f32 v56, v96, v97
    v_cvt_pk_bf16_f32 v57, v98, v99
    v_mfma_f32_32x32x8_bf16 v[80:95], v[30:31], v[66:67], v[80:95]
    v_exp_f32 v100, v100
    v_exp_f32 v101, v101
    v_exp_f32 v102, v102
    v_exp_f32 v103, v103
    v_cvt_pk_bf16_f32 v58, v100, v101
    v_cvt_pk_bf16_f32 v59, v102, v103
    v_mfma_f32_32x32x16_bf16 v[144:159], v[32:35], v[48:51], v[144:159]
    ds_read_b128 v[44:47], v3 offset:4256
    v_exp_f32 v104, v104
    v_exp_f32 v105, v105
    v_exp_f32 v106, v106
    v_exp_f32 v107, v107
    v_cvt_pk_bf16_f32 v60, v104, v105
    v_cvt_pk_bf16_f32 v61, v106, v107
    v_mfma_f32_32x32x16_bf16 v[144:159], v[36:39], v[52:55], v[144:159]
    ds_read_b128 v[20:23], v1 offset:4096
    v_exp_f32 v108, v108
    v_exp_f32 v109, v109
    v_exp_f32 v110, v110
    v_exp_f32 v111, v111
    v_cvt_pk_bf16_f32 v62, v108, v109
    v_cvt_pk_bf16_f32 v63, v110, v111
    v_mfma_f32_32x32x16_bf16 v[96:111], v[24:27], v[16:19], v[128:143]
    buffer_load_dwordx4 v5, s[12:15], s32 offen lds
    v_exp_f32 v80, v80
    v_exp_f32 v81, v81
    v_exp_f32 v82, v82
    v_exp_f32 v83, v83
    v_cvt_pk_bf16_f32 v48, v80, v81
    v_cvt_pk_bf16_f32 v49, v82, v83
    v_mfma_f32_32x32x8_bf16 v[96:111], v[30:31], v[74:75], v[96:111]
    v_exp_f32 v84, v84
    v_exp_f32 v85, v85
    v_exp_f32 v86, v86
    v_exp_f32 v87, v87
    v_cvt_pk_bf16_f32 v50, v84, v85
    v_cvt_pk_bf16_f32 v51, v86, v87
    v_mfma_f32_32x32x16_bf16 v[160:175], v[32:35], v[56:59], v[160:175]
    s_add_u32 s32, s32, 4096
    v_exp_f32 v88, v88
    v_exp_f32 v89, v89
    v_exp_f32 v90, v90
    v_exp_f32 v91, v91
    v_cvt_pk_bf16_f32 v52, v88, v89
    v_cvt_pk_bf16_f32 v53, v90, v91
    v_mfma_f32_32x32x16_bf16 v[160:175], v[36:39], v[60:63], v[160:175]
    s_waitcnt lgkmcnt(0)
    s_add_u32 m0, s33, 4096
    v_exp_f32 v92, v92
    v_exp_f32 v93, v93
    v_exp_f32 v94, v94
    v_exp_f32 v95, v95
    v_cvt_pk_bf16_f32 v54, v92, v93
    v_cvt_pk_bf16_f32 v55, v94, v95
    v_mfma_f32_32x32x16_bf16 v[80:95], v[20:23], v[12:15], v[112:127]
    ds_read_b128 v[32:35], v3 offset:4864
    v_exp_f32 v96, v96
    v_exp_f32 v97, v97
    v_exp_f32 v98, v98
    v_exp_f32 v99, v99
    v_cvt_pk_bf16_f32 v56, v96, v97
    v_cvt_pk_bf16_f32 v57, v98, v99
    v_mfma_f32_32x32x8_bf16 v[80:95], v[28:29], v[68:69], v[80:95]
    v_exp_f32 v100, v100
    v_exp_f32 v101, v101
    v_exp_f32 v102, v102
    v_exp_f32 v103, v103
    v_cvt_pk_bf16_f32 v58, v100, v101
    v_cvt_pk_bf16_f32 v59, v102, v103
    v_mfma_f32_32x32x16_bf16 v[144:159], v[40:43], v[48:51], v[144:159]
    ds_read_b128 v[36:39], v3 offset:5472
    v_exp_f32 v104, v104
    v_exp_f32 v105, v105
    v_exp_f32 v106, v106
    v_exp_f32 v107, v107
    v_cvt_pk_bf16_f32 v60, v104, v105
    v_cvt_pk_bf16_f32 v61, v106, v107
    v_mfma_f32_32x32x16_bf16 v[144:159], v[44:47], v[52:55], v[144:159]
    ds_read_b128 v[24:27], v1 offset:5120
    v_exp_f32 v108, v108
    v_exp_f32 v109, v109
    v_exp_f32 v110, v110
    v_exp_f32 v111, v111
    v_cvt_pk_bf16_f32 v62, v108, v109
    v_cvt_pk_bf16_f32 v63, v110, v111
    v_mfma_f32_32x32x16_bf16 v[96:111], v[20:23], v[16:19], v[128:143]
    buffer_load_dwordx4 v5, s[12:15], s32 offen lds
    v_exp_f32 v80, v80
    v_exp_f32 v81, v81
    v_exp_f32 v82, v82
    v_exp_f32 v83, v83
    v_cvt_pk_bf16_f32 v48, v80, v81
    v_cvt_pk_bf16_f32 v49, v82, v83
    v_mfma_f32_32x32x8_bf16 v[96:111], v[28:29], v[76:77], v[96:111]
    v_exp_f32 v84, v84
    v_exp_f32 v85, v85
    v_exp_f32 v86, v86
    v_exp_f32 v87, v87
    v_cvt_pk_bf16_f32 v50, v84, v85
    v_cvt_pk_bf16_f32 v51, v86, v87
    v_mfma_f32_32x32x16_bf16 v[160:175], v[40:43], v[56:59], v[160:175]
    s_add_u32 s32, s32, 4096
    v_exp_f32 v88, v88
    v_exp_f32 v89, v89
    v_exp_f32 v90, v90
    v_exp_f32 v91, v91
    v_cvt_pk_bf16_f32 v52, v88, v89
    v_cvt_pk_bf16_f32 v53, v90, v91
    v_mfma_f32_32x32x16_bf16 v[160:175], v[44:47], v[60:63], v[160:175]
    s_waitcnt lgkmcnt(0)
    s_add_u32 m0, s33, 8192
    v_exp_f32 v92, v92
    v_exp_f32 v93, v93
    v_exp_f32 v94, v94
    v_exp_f32 v95, v95
    v_cvt_pk_bf16_f32 v54, v92, v93
    v_cvt_pk_bf16_f32 v55, v94, v95
    v_mfma_f32_32x32x16_bf16 v[80:95], v[24:27], v[12:15], v[112:127]
    ds_read_b128 v[40:43], v3 offset:6080
    v_exp_f32 v96, v96
    v_exp_f32 v97, v97
    v_exp_f32 v98, v98
    v_exp_f32 v99, v99
    v_cvt_pk_bf16_f32 v56, v96, v97
    v_cvt_pk_bf16_f32 v57, v98, v99
    v_mfma_f32_32x32x8_bf16 v[80:95], v[28:29], v[70:71], v[80:95]
    v_exp_f32 v100, v100
    v_exp_f32 v101, v101
    v_exp_f32 v102, v102
    v_exp_f32 v103, v103
    v_cvt_pk_bf16_f32 v58, v100, v101
    v_cvt_pk_bf16_f32 v59, v102, v103
    v_mfma_f32_32x32x16_bf16 v[144:159], v[32:35], v[48:51], v[144:159]
    ds_read_b128 v[44:47], v3 offset:6688
    v_exp_f32 v104, v104
    v_exp_f32 v105, v105
    v_exp_f32 v106, v106
    v_exp_f32 v107, v107
    v_cvt_pk_bf16_f32 v60, v104, v105
    v_cvt_pk_bf16_f32 v61, v106, v107
    v_mfma_f32_32x32x16_bf16 v[144:159], v[36:39], v[52:55], v[144:159]
    ds_read_b128 v[20:23], v1 offset:6144
    v_exp_f32 v108, v108
    v_exp_f32 v109, v109
    v_exp_f32 v110, v110
    v_exp_f32 v111, v111
    v_cvt_pk_bf16_f32 v62, v108, v109
    v_cvt_pk_bf16_f32 v63, v110, v111
    v_mfma_f32_32x32x16_bf16 v[96:111], v[24:27], v[16:19], v[128:143]
    buffer_load_dwordx4 v5, s[12:15], s32 offen lds
    v_exp_f32 v80, v80
    v_exp_f32 v81, v81
    v_exp_f32 v82, v82
    v_exp_f32 v83, v83
    v_cvt_pk_bf16_f32 v48, v80, v81
    v_cvt_pk_bf16_f32 v49, v82, v83
    v_mfma_f32_32x32x8_bf16 v[96:111], v[28:29], v[78:79], v[96:111]
    v_exp_f32 v84, v84
    v_exp_f32 v85, v85
    v_exp_f32 v86, v86
    v_exp_f32 v87, v87
    v_cvt_pk_bf16_f32 v50, v84, v85
    v_cvt_pk_bf16_f32 v51, v86, v87
    v_mfma_f32_32x32x16_bf16 v[160:175], v[32:35], v[56:59], v[160:175]
    s_add_u32 s32, s32, 4096
    v_exp_f32 v88, v88
    v_exp_f32 v89, v89
    v_exp_f32 v90, v90
    v_exp_f32 v91, v91
    v_cvt_pk_bf16_f32 v52, v88, v89
    v_cvt_pk_bf16_f32 v53, v90, v91
    v_mfma_f32_32x32x16_bf16 v[160:175], v[36:39], v[60:63], v[160:175]
    s_waitcnt lgkmcnt(0)
    s_add_u32 m0, s33, 12288
    v_exp_f32 v92, v92
    v_exp_f32 v93, v93
    v_exp_f32 v94, v94
    v_exp_f32 v95, v95
    v_cvt_pk_bf16_f32 v54, v92, v93
    v_cvt_pk_bf16_f32 v55, v94, v95
    v_mfma_f32_32x32x16_bf16 v[80:95], v[20:23], v[12:15], v[112:127]
    ds_read_b128 v[32:35], v3 offset:7296
    v_exp_f32 v96, v96
    v_exp_f32 v97, v97
    v_exp_f32 v98, v98
    v_exp_f32 v99, v99
    v_cvt_pk_bf16_f32 v56, v96, v97
    v_cvt_pk_bf16_f32 v57, v98, v99
    v_mfma_f32_32x32x8_bf16 v[80:95], v[30:31], v[68:69], v[80:95]
    v_exp_f32 v100, v100
    v_exp_f32 v101, v101
    v_exp_f32 v102, v102
    v_exp_f32 v103, v103
    v_cvt_pk_bf16_f32 v58, v100, v101
    v_cvt_pk_bf16_f32 v59, v102, v103
    v_mfma_f32_32x32x16_bf16 v[144:159], v[40:43], v[48:51], v[144:159]
    ds_read_b128 v[36:39], v3 offset:7904
    v_exp_f32 v104, v104
    v_exp_f32 v105, v105
    v_exp_f32 v106, v106
    v_exp_f32 v107, v107
    v_cvt_pk_bf16_f32 v60, v104, v105
    v_cvt_pk_bf16_f32 v61, v106, v107
    v_mfma_f32_32x32x16_bf16 v[144:159], v[44:47], v[52:55], v[144:159]
    ds_read_b128 v[24:27], v1 offset:7168
    v_exp_f32 v108, v108
    v_exp_f32 v109, v109
    v_exp_f32 v110, v110
    v_exp_f32 v111, v111
    v_cvt_pk_bf16_f32 v62, v108, v109
    v_cvt_pk_bf16_f32 v63, v110, v111
    v_mfma_f32_32x32x16_bf16 v[96:111], v[20:23], v[16:19], v[128:143]
    buffer_load_dwordx4 v5, s[12:15], s32 offen lds
    v_exp_f32 v80, v80
    v_exp_f32 v81, v81
    v_exp_f32 v82, v82
    v_exp_f32 v83, v83
    v_cvt_pk_bf16_f32 v48, v80, v81
    v_cvt_pk_bf16_f32 v49, v82, v83
    v_mfma_f32_32x32x8_bf16 v[96:111], v[30:31], v[76:77], v[96:111]
    v_exp_f32 v84, v84
    v_exp_f32 v85, v85
    v_exp_f32 v86, v86
    v_exp_f32 v87, v87
    v_cvt_pk_bf16_f32 v50, v84, v85
    v_cvt_pk_bf16_f32 v51, v86, v87
    v_mfma_f32_32x32x16_bf16 v[160:175], v[40:43], v[56:59], v[160:175]
    s_add_u32 s32, s32, s35
    v_exp_f32 v88, v88
    v_exp_f32 v89, v89
    v_exp_f32 v90, v90
    v_exp_f32 v91, v91
    v_cvt_pk_bf16_f32 v52, v88, v89
    v_cvt_pk_bf16_f32 v53, v90, v91
    v_mfma_f32_32x32x16_bf16 v[160:175], v[44:47], v[60:63], v[160:175]
    s_waitcnt lgkmcnt(0)
    s_add_u32 m0, m0, s35
    v_exp_f32 v92, v92
    v_exp_f32 v93, v93
    v_exp_f32 v94, v94
    v_exp_f32 v95, v95
    v_cvt_pk_bf16_f32 v54, v92, v93
    v_cvt_pk_bf16_f32 v55, v94, v95
    v_mfma_f32_32x32x16_bf16 v[80:95], v[24:27], v[12:15], v[112:127]
    ds_read_b128 v[40:43], v3 offset:8512
    v_exp_f32 v96, v96
    v_exp_f32 v97, v97
    v_exp_f32 v98, v98
    v_exp_f32 v99, v99
    v_cvt_pk_bf16_f32 v56, v96, v97
    v_cvt_pk_bf16_f32 v57, v98, v99
    v_mfma_f32_32x32x8_bf16 v[80:95], v[30:31], v[70:71], v[80:95]
    v_exp_f32 v100, v100
    v_exp_f32 v101, v101
    v_exp_f32 v102, v102
    v_exp_f32 v103, v103
    v_cvt_pk_bf16_f32 v58, v100, v101
    v_cvt_pk_bf16_f32 v59, v102, v103
    v_mfma_f32_32x32x16_bf16 v[144:159], v[32:35], v[48:51], v[144:159]
    ds_read_b128 v[44:47], v3 offset:9120
    v_exp_f32 v104, v104
    v_exp_f32 v105, v105
    v_exp_f32 v106, v106
    v_exp_f32 v107, v107
    v_cvt_pk_bf16_f32 v60, v104, v105
    v_cvt_pk_bf16_f32 v61, v106, v107
    v_mfma_f32_32x32x16_bf16 v[144:159], v[36:39], v[52:55], v[144:159]
    ds_read_b128 v[20:23], v2 offset:0
    v_exp_f32 v108, v108
    v_exp_f32 v109, v109
    v_exp_f32 v110, v110
    v_exp_f32 v111, v111
    v_cvt_pk_bf16_f32 v62, v108, v109
    v_cvt_pk_bf16_f32 v63, v110, v111
    v_mfma_f32_32x32x16_bf16 v[96:111], v[24:27], v[16:19], v[128:143]
    buffer_load_dwordx4 v5, s[12:15], s32 offen lds
    v_exp_f32 v80, v80
    v_exp_f32 v81, v81
    v_exp_f32 v82, v82
    v_exp_f32 v83, v83
    v_cvt_pk_bf16_f32 v48, v80, v81
    v_cvt_pk_bf16_f32 v49, v82, v83
    v_mfma_f32_32x32x8_bf16 v[96:111], v[30:31], v[78:79], v[96:111]
    v_exp_f32 v84, v84
    v_exp_f32 v85, v85
    v_exp_f32 v86, v86
    v_exp_f32 v87, v87
    v_cvt_pk_bf16_f32 v50, v84, v85
    v_cvt_pk_bf16_f32 v51, v86, v87
    v_mfma_f32_32x32x16_bf16 v[160:175], v[32:35], v[56:59], v[160:175]
    s_sub_u32 s32, s32, s35
    ds_read_b128 v[28:31], v2 offset:8192
    v_exp_f32 v88, v88
    v_exp_f32 v89, v89
    v_exp_f32 v90, v90
    v_exp_f32 v91, v91
    v_cvt_pk_bf16_f32 v52, v88, v89
    v_cvt_pk_bf16_f32 v53, v90, v91
    v_mfma_f32_32x32x16_bf16 v[160:175], v[36:39], v[60:63], v[160:175]
    s_waitcnt lgkmcnt(1)
    v_exp_f32 v92, v92
    v_exp_f32 v93, v93
    v_exp_f32 v94, v94
    v_exp_f32 v95, v95
    v_cvt_pk_bf16_f32 v54, v92, v93
    v_cvt_pk_bf16_f32 v55, v94, v95
    v_mfma_f32_32x32x16_bf16 v[80:95], v[20:23], v[12:15], v[112:127]
    s_waitcnt lgkmcnt(0)
    ds_read_b128 v[32:35], v4 offset:0
    v_exp_f32 v96, v96
    v_exp_f32 v97, v97
    v_exp_f32 v98, v98
    v_exp_f32 v99, v99
    v_cvt_pk_bf16_f32 v56, v96, v97
    v_cvt_pk_bf16_f32 v57, v98, v99
    v_mfma_f32_32x32x8_bf16 v[80:95], v[28:29], v[64:65], v[80:95]
    s_add_u32 s32, s32, 7168
    s_add_u32 s33, s33, 19456
    v_exp_f32 v100, v100
    v_exp_f32 v101, v101
    v_exp_f32 v102, v102
    v_exp_f32 v103, v103
    v_cvt_pk_bf16_f32 v58, v100, v101
    v_cvt_pk_bf16_f32 v59, v102, v103
    v_mfma_f32_32x32x16_bf16 v[144:159], v[40:43], v[48:51], v[144:159]
    ds_read_b128 v[36:39], v4 offset:608
    s_cmp_ge_u32 s33, 77824
    s_cselect_b32 s36, 77824, 0
    s_sub_u32 s33, s33, s36
    v_exp_f32 v104, v104
    v_exp_f32 v105, v105
    v_exp_f32 v106, v106
    v_exp_f32 v107, v107
    v_cvt_pk_bf16_f32 v60, v104, v105
    v_cvt_pk_bf16_f32 v61, v106, v107
    v_mfma_f32_32x32x16_bf16 v[144:159], v[44:47], v[52:55], v[144:159]
    ds_read_b128 v[24:27], v2 offset:1024
    v_exp_f32 v108, v108
    v_exp_f32 v109, v109
    v_exp_f32 v110, v110
    v_exp_f32 v111, v111
    v_cvt_pk_bf16_f32 v62, v108, v109
    v_cvt_pk_bf16_f32 v63, v110, v111
    s_add_u32 s34, s34, 19456
    v_mov_b32 v1, v2
    s_cmp_ge_u32 s34, 77824
    v_mov_b32 v3, v4
    s_cselect_b32 s34, 0, s34
    s_add_u32 s25, s25, 1
    v_add_u32 v2, s34, v5
    s_add_u32 s36, s34, 9216
    s_cmp_lt_u32 s25, 8
    v_add_u32 v4, s36, v10
    s_cbranch_scc1 L_at_loop
    s_setprio 3
    v_mfma_f32_32x32x16_bf16 v[160:175], v[40:43], v[56:59], v[160:175]
    v_mfma_f32_32x32x16_bf16 v[160:175], v[44:47], v[60:63], v[160:175]
    s_mov_b32 s14, s37
    s_mov_b32 s27, 0
    s_waitcnt lgkmcnt(0)
L_at_fin:
    s_mul_i32 s23, s28, 36864
    s_lshl_b32 s24, s21, 10
    s_add_u32 s34, s23, s24
    s_lshl_b32 s24, s21, 7
    s_add_u32 s23, s23, s24
    s_add_u32 s23, s23, 32768
    v_lshrrev_b32 v9, 5, v0
    v_lshlrev_b32 v9, 30, v9
    v_lshl_add_u32 v9, v0, 2, v9
    v_mov_b32 v6, v154
    v_mov_b32 v7, v154
    s_nop 1
    v_permlane32_swap_b32 v6, v7
    s_nop 0
    v_rcp_f32 v6, v6
    s_nop 0
    v_mul_f32 v80, v144, v6
    v_mul_f32 v81, v145, v6
    v_mul_f32 v82, v146, v6
    v_mul_f32 v83, v147, v6
    v_mul_f32 v84, v148, v6
    v_mul_f32 v85, v149, v6
    v_mul_f32 v86, v150, v6
    v_mul_f32 v87, v151, v6
    v_mul_f32 v88, v152, v6
    v_mul_f32 v89, v153, v6
    v_cvt_pk_bf16_f32 v48, v80, v81
    v_cvt_pk_bf16_f32 v49, v82, v83
    v_cvt_pk_bf16_f32 v50, v84, v85
    v_cvt_pk_bf16_f32 v51, v86, v87
    v_cvt_pk_bf16_f32 v52, v88, v89
    buffer_store_dwordx4 v[48:51], v5, s[16:19], s34 offen sc1
    buffer_store_dword v52, v9, s[16:19], s23 offen sc1
    s_add_u32 s34, s34, 36864
    s_add_u32 s23, s23, 36864
    v_mov_b32 v6, v170
    v_mov_b32 v7, v170
    s_nop 1
    v_permlane32_swap_b32 v6, v7
    s_nop 0
    v_rcp_f32 v6, v6
    s_nop 0
    v_mul_f32 v96, v160, v6
    v_mul_f32 v97, v161, v6
    v_mul_f32 v98, v162, v6
    v_mul_f32 v99, v163, v6
    v_mul_f32 v100, v164, v6
    v_mul_f32 v101, v165, v6
    v_mul_f32 v102, v166, v6
    v_mul_f32 v103, v167, v6
    v_mul_f32 v104, v168, v6
    v_mul_f32 v105, v169, v6
    v_cvt_pk_bf16_f32 v56, v96, v97
    v_cvt_pk_bf16_f32 v57, v98, v99
    v_cvt_pk_bf16_f32 v58, v100, v101
    v_cvt_pk_bf16_f32 v59, v102, v103
    v_cvt_pk_bf16_f32 v60, v104, v105
    buffer_store_dwordx4 v[56:59], v5, s[16:19], s34 offen sc1
    buffer_store_dword v60, v9, s[16:19], s23 offen sc1
    s_cmp_lg_u32 s27, 0
    s_cbranch_scc1 L_at_pub
    v_mul_f32 v6, 0, v144
    v_fma_f32 v6, v145, 0, v6
    v_fma_f32 v6, v146, 0, v6
    v_fma_f32 v6, v147, 0, v6
    v_fma_f32 v6, v148, 0, v6
    v_fma_f32 v6, v149, 0, v6
    v_fma_f32 v6, v150, 0, v6
    v_fma_f32 v6, v151, 0, v6
    v_mul_f32 v8, 0, v152
    v_fma_f32 v8, v153, 0, v8
    v_mul_f32 v9, 0x21800000, v154
    v_floor_f32 v9, v9
    v_add_f32 v8, v8, v9
    v_cndmask_b32 v8, 0, v8, s[30:31]
    v_add_f32 v6, v6, v8
    v_mul_f32 v7, 0, v160
    v_fma_f32 v7, v161, 0, v7
    v_fma_f32 v7, v162, 0, v7
    v_fma_f32 v7, v163, 0, v7
    v_fma_f32 v7, v164, 0, v7
    v_fma_f32 v7, v165, 0, v7
    v_fma_f32 v7, v166, 0, v7
    v_fma_f32 v7, v167, 0, v7
    v_mul_f32 v8, 0, v168
    v_fma_f32 v8, v169, 0, v8
    v_mul_f32 v9, 0x21800000, v170
    v_floor_f32 v9, v9
    v_add_f32 v8, v8, v9
    v_cndmask_b32 v8, 0, v8, s[30:31]
    v_add_f32 v7, v7, v8
    v_add_f32 v6, v6, v7
    v_cmp_neq_f32 vcc, 0, v6
    s_nop 1
    s_cmp_eq_u64 vcc, 0
    s_cbranch_scc0 L_at_slow
L_at_pub:
    s_add_u32 s8, s6, 34545664
    s_addc_u32 s9, s7, 0
    s_mov_b32 s10, 131072
    s_mov_b32 s11, 0x00020000
    s_lshl_b32 s23, s28, 10
    s_lshl_b32 s24, s21, 6
    s_add_u32 s23, s23, s24
    v_mov_b32 v6, 1
    v_lshlrev_b32 v7, 24, v0
    s_waitcnt vmcnt(0)
    buffer_store_dword v6, v7, s[8:11], s23 offen sc1
    s_endpgm
L_at_slow:
    v_mov_b32 v6, 0xff7fffff
    v_mov_b32 v7, 0xff7fffff
    v_mov_b32 v29, 0
    v_mov_b32 v112, 0
    v_mov_b32 v144, 0
    v_mov_b32 v113, 0
    v_mov_b32 v145, 0
    v_mov_b32 v114, 0
    v_mov_b32 v146, 0
    v_mov_b32 v115, 0
    v_mov_b32 v147, 0
    v_mov_b32 v116, 0
    v_mov_b32 v148, 0
    v_mov_b32 v117, 0
    v_mov_b32 v149, 0
    v_mov_b32 v118, 0
    v_mov_b32 v150, 0
    v_mov_b32 v119, 0
    v_mov_b32 v151, 0
    v_mov_b32 v120, 0
    v_mov_b32 v152, 0
    v_mov_b32 v121, 0
    v_mov_b32 v153, 0
    v_mov_b32 v122, 0
    v_mov_b32 v154, 0
    v_mov_b32 v123, 0
    v_mov_b32 v155, 0
    v_mov_b32 v124, 0
    v_mov_b32 v156, 0
    v_mov_b32 v125, 0
    v_mov_b32 v157, 0
    v_mov_b32 v126, 0
    v_mov_b32 v158, 0
    v_mov_b32 v127, 0
    v_mov_b32 v159, 0
    v_mov_b32 v128, 0
    v_mov_b32 v160, 0
    v_mov_b32 v129, 0
    v_mov_b32 v161, 0
    v_mov_b32 v130, 0
    v_mov_b32 v162, 0
    v_mov_b32 v131, 0
    v_mov_b32 v163, 0
    v_mov_b32 v132, 0
    v_mov_b32 v164, 0
    v_mov_b32 v133, 0
    v_mov_b32 v165, 0
    v_mov_b32 v134, 0
    v_mov_b32 v166, 0
    v_mov_b32 v135, 0
    v_mov_b32 v167, 0
    v_mov_b32 v136, 0
    v_mov_b32 v168, 0
    v_mov_b32 v137, 0
    v_mov_b32 v169, 0
    v_mov_b32 v138, 0
    v_mov_b32 v170, 0
    v_mov_b32 v139, 0
    v_mov_b32 v171, 0
    v_mov_b32 v140, 0
    v_mov_b32 v172, 0
    v_mov_b32 v141, 0
    v_mov_b32 v173, 0
    v_mov_b32 v142, 0
    v_mov_b32 v174, 0
    v_mov_b32 v143, 0
    v_mov_b32 v175, 0
    s_mov_b32 s27, 0
L_at_spass:
    s_mov_b32 s25, 0
L_at_sloop:
    s_lshr_b32 s23, s25, 3
    s_mul_i32 s23, s23, 19456
    s_add_u32 s23, s23, s29
    s_and_b32 s24, s25, 7
    s_lshl_b32 s36, s24, 10
    s_add_u32 s36, s36, s23
    buffer_load_dwordx4 v[20:23], v5, s[12:15], s36 offen
    s_mul_i32 s36, s24, 1216
    s_add_u32 s36, s36, s23
    s_add_u32 s36, s36, 9216
    buffer_load_dwordx4 v[32:35], v10, s[12:15], s36 offen
    buffer_load_dwordx4 v[36:39], v10, s[12:15], s36 offen offset:608
    s_lshr_b32 s36, s24, 2
    s_lshl_b32 s36, s36, 9
    s_add_u32 s23, s23, s36
    s_and_b32 s36, s24, 3
    s_lshl_b32 s36, s36, 2
    s_add_u32 s23, s23, s36
    s_add_u32 s23, s23, 8192
    buffer_load_dword v28, v11, s[12:15], s23 offen
    s_waitcnt vmcnt(0)
    v_mfma_f32_32x32x16_bf16 v[80:95], v[20:23], v[12:15], v[112:127]
    v_mfma_f32_32x32x8_bf16 v[80:95], v[28:29], v[64:65], v[80:95]
    v_mfma_f32_32x32x16_bf16 v[96:111], v[20:23], v[16:19], v[128:143]
    v_mfma_f32_32x32x8_bf16 v[96:111], v[28:29], v[72:73], v[96:111]
    s_nop 11
    s_cmp_lg_u32 s27, 0
    s_cbranch_scc1 L_at_sacc
    v_max3_f32 v6, v80, v81, v6
    v_max3_f32 v6, v82, v83, v6
    v_max3_f32 v6, v84, v85, v6
    v_max3_f32 v6, v86, v87, v6
    v_max3_f32 v6, v88, v89, v6
    v_max3_f32 v6, v90, v91, v6
    v_max3_f32 v6, v92, v93, v6
    v_max3_f32 v6, v94, v95, v6
    v_max3_f32 v7, v96, v97, v7
    v_max3_f32 v7, v98, v99, v7
    v_max3_f32 v7, v100, v101, v7
    v_max3_f32 v7, v102, v103, v7
    v_max3_f32 v7, v104, v105, v7
    v_max3_f32 v7, v106, v107, v7
    v_max3_f32 v7, v108, v109, v7
    v_max3_f32 v7, v110, v111, v7
    s_branch L_at_snext
L_at_sacc:
    v_exp_f32 v80, v80
    v_exp_f32 v81, v81
    v_exp_f32 v82, v82
    v_exp_f32 v83, v83
    v_exp_f32 v84, v84
    v_exp_f32 v85, v85
    v_exp_f32 v86, v86
    v_exp_f32 v87, v87
    v_exp_f32 v88, v88
    v_exp_f32 v89, v89
    v_exp_f32 v90, v90
    v_exp_f32 v91, v91
    v_exp_f32 v92, v92
    v_exp_f32 v93, v93
    v_exp_f32 v94, v94
    v_exp_f32 v95, v95
    s_nop 0
    v_cvt_pk_bf16_f32 v48, v80, v81
    v_cvt_pk_bf16_f32 v49, v82, v83
    v_cvt_pk_bf16_f32 v50, v84, v85
    v_cvt_pk_bf16_f32 v51, v86, v87
    v_cvt_pk_bf16_f32 v52, v88, v89
    v_cvt_pk_bf16_f32 v53, v90, v91
    v_cvt_pk_bf16_f32 v54, v92, v93
    v_cvt_pk_bf16_f32 v55, v94, v95
    v_exp_f32 v96, v96
    v_exp_f32 v97, v97
    v_exp_f32 v98, v98
    v_exp_f32 v99, v99
    v_exp_f32 v100, v100
    v_exp_f32 v101, v101
    v_exp_f32 v102, v102
    v_exp_f32 v103, v103
    v_exp_f32 v104, v104
    v_exp_f32 v105, v105
    v_exp_f32 v106, v106
    v_exp_f32 v107, v107
    v_exp_f32 v108, v108
    v_exp_f32 v109, v109
    v_exp_f32 v110, v110
    v_exp_f32 v111, v111
    s_nop 0
    v_cvt_pk_bf16_f32 v56, v96, v97
    v_cvt_pk_bf16_f32 v57, v98, v99
    v_cvt_pk_bf16_f32 v58, v100, v101
    v_cvt_pk_bf16_f32 v59, v102, v103
    v_cvt_pk_bf16_f32 v60, v104, v105
    v_cvt_pk_bf16_f32 v61, v106, v107
    v_cvt_pk_bf16_f32 v62, v108, v109
    v_cvt_pk_bf16_f32 v63, v110, v111
    s_nop 1
    v_mfma_f32_32x32x16_bf16 v[144:159], v[32:35], v[48:51], v[144:159]
    v_mfma_f32_32x32x16_bf16 v[144:159], v[36:39], v[52:55], v[144:159]
    v_mfma_f32_32x32x16_bf16 v[160:175], v[32:35], v[56:59], v[160:175]
    v_mfma_f32_32x32x16_bf16 v[160:175], v[36:39], v[60:63], v[160:175]
    s_nop 11
L_at_snext:
    s_add_u32 s25, s25, 1
    s_cmp_lt_u32 s25, 64
    s_cbranch_scc1 L_at_sloop
    s_cmp_lg_u32 s27, 0
    s_cbranch_scc1 L_at_fin
    v_mov_b32 v8, v6
    v_mov_b32 v9, v7
    s_nop 1
    v_permlane32_swap_b32 v6, v8
    v_permlane32_swap_b32 v7, v9
    s_nop 0
    v_max_f32 v6, v6, v8
    v_max_f32 v7, v7, v9
    v_sub_f32 v112, 0, v6
    v_sub_f32 v113, 0, v6
    v_sub_f32 v114, 0, v6
    v_sub_f32 v115, 0, v6
    v_sub_f32 v116, 0, v6
    v_sub_f32 v117, 0, v6
    v_sub_f32 v118, 0, v6
    v_sub_f32 v119, 0, v6
    v_sub_f32 v120, 0, v6
    v_sub_f32 v121, 0, v6
    v_sub_f32 v122, 0, v6
    v_sub_f32 v123, 0, v6
    v_sub_f32 v124, 0, v6
    v_sub_f32 v125, 0, v6
    v_sub_f32 v126, 0, v6
    v_sub_f32 v127, 0, v6
    v_sub_f32 v128, 0, v7
    v_sub_f32 v129, 0, v7
    v_sub_f32 v130, 0, v7
    v_sub_f32 v131, 0, v7
    v_sub_f32 v132, 0, v7
    v_sub_f32 v133, 0, v7
    v_sub_f32 v134, 0, v7
    v_sub_f32 v135, 0, v7
    v_sub_f32 v136, 0, v7
    v_sub_f32 v137, 0, v7
    v_sub_f32 v138, 0, v7
    v_sub_f32 v139, 0, v7
    v_sub_f32 v140, 0, v7
    v_sub_f32 v141, 0, v7
    v_sub_f32 v142, 0, v7
    v_sub_f32 v143, 0, v7
    s_mov_b32 s27, 1
    s_branch L_at_spass
L_k2_down:
    s_setprio 1
    s_load_dwordx2 s[36:37], s[0:1], 0
    s_load_dwordx2 s[40:41], s[0:1], 56
    s_sub_u32 s3, s2, 256
    s_bfe_u32 s21, s3, 0x20001
    s_lshl_b32 s21, s21, 2
    s_bfe_u32 s22, s3, 0x20003
    s_add_u32 s21, s21, s22
    s_lshl_b32 s21, s21, 2
    s_add_u32 s21, s21, s20
    s_lshr_b32 s28, s21, 1
    s_lshl_b32 s28, s28, 11
    s_and_b32 s22, s3, 1
    s_lshl_b32 s26, s21, 1
    s_add_u32 s26, s26, s22
    s_mul_i32 s48, s21, 36864
    s_lshl_b32 s21, s22, 8
    s_add_u32 s48, s48, s21
    s_mul_i32 s21, s22, 73728
    s_mul_i32 s24, s26, 147456
    s_add_u32 s24, s24, s21
    s_xor_b32 s49, s26, 1
    s_mul_i32 s49, s49, 147456
    s_add_u32 s49, s49, s21
    s_lshr_b32 s27, s3, 5
    s_mul_i32 s27, s27, 9
    s_lshr_b32 s27, s27, 1
    s_mul_i32 s25, s22, 2654208
    s_sub_u32 s50, 2654208, s25
    s_mul_i32 s21, s20, 36864
    s_add_u32 s25, s25, s21
    s_lshl_b32 s21, s27, 10
    s_add_u32 s25, s25, s21
    v_lshlrev_b32 v1, 4, v0
    s_waitcnt lgkmcnt(0)
    s_add_u32 s8, s6, 9699328
    s_addc_u32 s9, s7, 0
    s_mov_b32 s10, 18874368
    s_mov_b32 s11, 0x00020000
    s_add_u32 s12, s6, 28573696
    s_addc_u32 s13, s7, 0
    s_mov_b32 s14, 5971968
    s_mov_b32 s15, 0x00020000
    s_bitcmp1_b32 s3, 5
    s_cbranch_scc1 L_dn5
    s_mul_i32 s29, s20, 4096
    s_mov_b32 m0, s29
    s_nop 0
    buffer_load_dwordx4 v1, s[12:15], s25 offen offset:0 lds
    buffer_load_dwordx4 v1, s[12:15], s25 offen offset:1024 lds
    buffer_load_dwordx4 v[24:27], v1, s[8:11], s24 offen
    s_add_u32 s24, s24, 1024
    buffer_load_dwordx4 v[28:31], v1, s[8:11], s49 offen
    s_add_u32 s49, s49, 1024
    buffer_load_dwordx4 v1, s[12:15], s25 offen offset:2048 lds
    buffer_load_dwordx4 v1, s[12:15], s25 offen offset:3072 lds
    s_add_u32 s25, s25, 147456
    buffer_load_dwordx4 v[32:35], v1, s[8:11], s24 offen
    s_add_u32 s24, s24, 1024
    buffer_load_dwordx4 v[36:39], v1, s[8:11], s49 offen
    s_add_u32 s49, s49, 1024
    buffer_load_dwordx4 v[40:43], v1, s[8:11], s24 offen
    s_add_u32 s24, s24, 1024
    buffer_load_dwordx4 v[44:47], v1, s[8:11], s49 offen
    s_add_u32 s49, s49, 1024
    s_add_u32 s29, s29, 16384
    buffer_load_dwordx4 v[48:51], v1, s[8:11], s24 offen
    s_add_u32 s24, s24, 1024
    buffer_load_dwordx4 v[52:55], v1, s[8:11], s49 offen
    s_add_u32 s49, s49, 1024
    s_mov_b32 m0, s29
    s_nop 0
    buffer_load_dwordx4 v1, s[12:15], s25 offen offset:0 lds
    buffer_load_dwordx4 v1, s[12:15], s25 offen offset:1024 lds
    buffer_load_dwordx4 v[56:59], v1, s[8:11], s24 offen
    s_add_u32 s24, s24, 1024
    buffer_load_dwordx4 v[60:63], v1, s[8:11], s49 offen
    s_add_u32 s49, s49, 1024
    buffer_load_dwordx4 v1, s[12:15], s25 offen offset:2048 lds
    buffer_load_dwordx4 v1, s[12:15], s25 offen offset:3072 lds
    s_add_u32 s25, s25, 147456
    buffer_load_dwordx4 v[64:67], v1, s[8:11], s24 offen
    s_add_u32 s24, s24, 1024
    buffer_load_dwordx4 v[68:71], v1, s[8:11], s49 offen
    s_add_u32 s49, s49, 1024
    buffer_load_dwordx4 v[72:75], v1, s[8:11], s24 offen
    s_add_u32 s24, s24, 1024
    buffer_load_dwordx4 v[76:79], v1, s[8:11], s49 offen
    s_add_u32 s49, s49, 1024
    s_add_u32 s29, s29, 16384
    v_mov_b32 v9, v1
    v_add_u32 v10, 16384, v1
    s_mov_b32 s31, 16384
    s_mov_b32 s30, 32768
    v_mov_b32 v96, 0
    v_mov_b32 v97, 0
    v_mov_b32 v98, 0
    v_mov_b32 v99, 0
    v_mov_b32 v100, 0
    v_mov_b32 v101, 0
    v_mov_b32 v102, 0
    v_mov_b32 v103, 0
    v_mov_b32 v104, 0
    v_mov_b32 v105, 0
    v_mov_b32 v106, 0
    v_mov_b32 v107, 0
    v_mov_b32 v108, 0
    v_mov_b32 v109, 0
    v_mov_b32 v110, 0
    v_mov_b32 v111, 0
    v_mov_b32 v116, 0
    v_mov_b32 v117, 0
    v_mov_b32 v118, 0
    v_mov_b32 v119, 0
    v_mov_b32 v120, 0
    v_mov_b32 v121, 0
    v_mov_b32 v122, 0
    v_mov_b32 v123, 0
    v_mov_b32 v124, 0
    v_mov_b32 v125, 0
    v_mov_b32 v126, 0
    v_mov_b32 v127, 0
    v_mov_b32 v128, 0
    v_mov_b32 v129, 0
    v_mov_b32 v130, 0
    v_mov_b32 v131, 0
    s_mov_b32 s38, 2359296
    s_mov_b32 s39, 0x00020000
    s_mov_b32 s42, 2359296
    s_mov_b32 s43, 0x00020000
    v_lshrrev_b32 v3, 4, v0
    v_and_b32 v6, 0xf0, v1
    v_lshl_add_u32 v2, v3, 9, v6
    v_and_b32 v7, 15, v0
    v_lshlrev_b32 v11, 2, v7
    v_mul_u32_u24 v7, 1152, v7
    v_lshl_add_u32 v7, v3, 3, v7
    v_lshl_add_u32 v11, v3, 9, v11
    s_and_b32 s22, s26, 1
    s_xor_b32 s22, s22, 1
    s_mul_i32 s22, s22, 192
    v_add_u32 v11, s22, v11
    s_mul_i32 s26, s26, 18432
    s_lshl_b32 s22, s27, 5
    s_add_u32 s26, s26, s22
    s_waitcnt vmcnt(16)
    s_barrier
    ds_read_b128 v[136:139], v9 offset:0
    ds_read_b128 v[152:155], v9 offset:1024
    ds_read_b128 v[168:171], v9 offset:2048
    ds_read_b128 v[184:187], v9 offset:3072
    ds_read_b128 v[140:143], v9 offset:4096
    ds_read_b128 v[156:159], v9 offset:5120
    ds_read_b128 v[172:175], v9 offset:6144
    ds_read_b128 v[188:191], v9 offset:7168
    s_mov_b32 s23, 0
    s_setprio 0
L_dn_loop_4:
    s_cmp_lg_u32 s23, 3
    s_cbranch_scc1 L_dn_nx_4
    buffer_load_dwordx2 v[12:13], v7, s[36:39], s26 offen offset:0
    buffer_load_dwordx2 v[14:15], v7, s[36:39], s26 offen offset:32
    buffer_load_dwordx2 v[16:17], v7, s[36:39], s26 offen offset:64
    buffer_load_dwordx2 v[18:19], v7, s[36:39], s26 offen offset:96
    s_lshl_b32 s21, s27, 10
    s_add_u32 s21, s21, 5898240
    s_add_u32 s22, s21, 1024
    buffer_load_dwordx4 v[216:219], v1, s[12:15], s21 offen offset:0
    buffer_load_dwordx4 v[220:223], v1, s[12:15], s21 offen offset:1024
    buffer_load_dwordx4 v[224:227], v1, s[12:15], s21 offen offset:2048
    buffer_load_dwordx4 v[228:231], v1, s[12:15], s21 offen offset:3072
    s_add_u32 s21, s21, 36864
    s_add_u32 s22, s21, 1024
    buffer_load_dwordx4 v[236:239], v1, s[12:15], s21 offen offset:0
    buffer_load_dwordx4 v[240:243], v1, s[12:15], s21 offen offset:1024
    buffer_load_dwordx4 v[244:247], v1, s[12:15], s21 offen offset:2048
    buffer_load_dwordx4 v[248:251], v1, s[12:15], s21 offen offset:3072
    s_add_u32 s21, s21, 36864
L_dn_nx_4:
    s_cmp_lg_u32 s23, 5
    s_cbranch_scc1 L_dn_nc_4
    s_getpc_b64 s[16:17]
L_dn_pc_4:
    s_sub_u32 s16, s16, L_dn_pc_4 - L_at_fin
    s_subb_u32 s17, s17, 0
    s_mov_b32 s18, L_code_end - L_at_fin
    s_mov_b32 s19, 0x00020000
    v_lshlrev_b32 v3, 3, v1
    s_lshl_b32 s21, s20, 13
    buffer_load_dword v8, v3, s[16:19], s21 offen
L_dn_nc_4:
    s_cmp_eq_u32 s23, 8
    s_cselect_b32 s21, s50, 0
    s_add_u32 s25, s25, s21
    s_waitcnt lgkmcnt(4)
    v_mfma_f32_16x16x32_bf16 v[96:99], v[136:139], v[24:27], v[96:99]
    ds_read_b128 v[144:147], v9 offset:8192
    v_mfma_f32_16x16x32_bf16 v[116:119], v[136:139], v[28:31], v[116:119]
    buffer_load_dwordx4 v[80:83], v1, s[8:11], s24 offen
    s_add_u32 s24, s24, 1024
    v_mfma_f32_16x16x32_bf16 v[100:103], v[152:155], v[24:27], v[100:103]
    ds_read_b128 v[160:163], v9 offset:9216
    v_mfma_f32_16x16x32_bf16 v[120:123], v[152:155], v[28:31], v[120:123]
    buffer_load_dwordx4 v[84:87], v1, s[8:11], s49 offen
    s_add_u32 s49, s49, 1024
    v_mfma_f32_16x16x32_bf16 v[104:107], v[168:171], v[24:27], v[104:107]
    ds_read_b128 v[176:179], v9 offset:10240
    v_mfma_f32_16x16x32_bf16 v[124:127], v[168:171], v[28:31], v[124:127]
    s_mov_b32 m0, s29
    s_nop 0
    buffer_load_dwordx4 v1, s[12:15], s25 offen offset:0 lds
    v_mfma_f32_16x16x32_bf16 v[108:111], v[184:187], v[24:27], v[108:111]
    ds_read_b128 v[192:195], v9 offset:11264
    v_mfma_f32_16x16x32_bf16 v[128:131], v[184:187], v[28:31], v[128:131]
    buffer_load_dwordx4 v1, s[12:15], s25 offen offset:1024 lds
    s_waitcnt vmcnt(18) lgkmcnt(4)
    v_mfma_f32_16x16x32_bf16 v[96:99], v[140:143], v[32:35], v[96:99]
    ds_read_b128 v[148:151], v9 offset:12288
    v_mfma_f32_16x16x32_bf16 v[116:119], v[140:143], v[36:39], v[116:119]
    s_cmp_lt_u32 s23, 8
    s_cselect_b32 s10, s10, 0
    buffer_load_dwordx4 v[24:27], v1, s[8:11], s24 offen
    s_add_u32 s24, s24, 1024
    v_mfma_f32_16x16x32_bf16 v[100:103], v[156:159], v[32:35], v[100:103]
    ds_read_b128 v[164:167], v9 offset:13312
    v_mfma_f32_16x16x32_bf16 v[120:123], v[156:159], v[36:39], v[120:123]
    buffer_load_dwordx4 v[28:31], v1, s[8:11], s49 offen
    s_add_u32 s49, s49, 1024
    v_mfma_f32_16x16x32_bf16 v[104:107], v[172:175], v[32:35], v[104:107]
    ds_read_b128 v[180:183], v9 offset:14336
    v_mfma_f32_16x16x32_bf16 v[124:127], v[172:175], v[36:39], v[124:127]
    buffer_load_dwordx4 v1, s[12:15], s25 offen offset:2048 lds
    v_mfma_f32_16x16x32_bf16 v[108:111], v[188:191], v[32:35], v[108:111]
    ds_read_b128 v[196:199], v9 offset:15360
    v_mfma_f32_16x16x32_bf16 v[128:131], v[188:191], v[36:39], v[128:131]
    buffer_load_dwordx4 v1, s[12:15], s25 offen offset:3072 lds
    s_add_u32 s25, s25, 147456
    s_waitcnt vmcnt(20) lgkmcnt(4)
    v_mfma_f32_16x16x32_bf16 v[96:99], v[144:147], v[40:43], v[96:99]
    s_waitcnt vmcnt(12) lgkmcnt(0)
    s_barrier
    ds_read_b128 v[136:139], v10 offset:0
    v_mfma_f32_16x16x32_bf16 v[116:119], v[144:147], v[44:47], v[116:119]
    buffer_load_dwordx4 v[32:35], v1, s[8:11], s24 offen
    s_add_u32 s24, s24, 1024
    v_mfma_f32_16x16x32_bf16 v[100:103], v[160:163], v[40:43], v[100:103]
    ds_read_b128 v[152:155], v10 offset:1024
    v_mfma_f32_16x16x32_bf16 v[120:123], v[160:163], v[44:47], v[120:123]
    buffer_load_dwordx4 v[36:39], v1, s[8:11], s49 offen
    s_add_u32 s49, s49, 1024
    v_mfma_f32_16x16x32_bf16 v[104:107], v[176:179], v[40:43], v[104:107]
    ds_read_b128 v[168:171], v10 offset:2048
    v_mfma_f32_16x16x32_bf16 v[124:127], v[176:179], v[44:47], v[124:127]
    v_mfma_f32_16x16x32_bf16 v[108:111], v[192:195], v[40:43], v[108:111]
    ds_read_b128 v[184:187], v10 offset:3072
    v_mfma_f32_16x16x32_bf16 v[128:131], v[192:195], v[44:47], v[128:131]
    v_mfma_f32_16x16x32_bf16 v[96:99], v[148:151], v[48:51], v[96:99]
    ds_read_b128 v[140:143], v10 offset:4096
    v_mfma_f32_16x16x32_bf16 v[116:119], v[148:151], v[52:55], v[116:119]
    buffer_load_dwordx4 v[40:43], v1, s[8:11], s24 offen
    s_add_u32 s24, s24, 1024
    v_mfma_f32_16x16x32_bf16 v[100:103], v[164:167], v[48:51], v[100:103]
    ds_read_b128 v[156:159], v10 offset:5120
    v_mfma_f32_16x16x32_bf16 v[120:123], v[164:167], v[52:55], v[120:123]
    buffer_load_dwordx4 v[44:47], v1, s[8:11], s49 offen
    s_add_u32 s49, s49, 1024
    v_mfma_f32_16x16x32_bf16 v[104:107], v[180:183], v[48:51], v[104:107]
    ds_read_b128 v[172:175], v10 offset:6144
    v_mfma_f32_16x16x32_bf16 v[124:127], v[180:183], v[52:55], v[124:127]
    v_mfma_f32_16x16x32_bf16 v[108:111], v[196:199], v[48:51], v[108:111]
    ds_read_b128 v[188:191], v10 offset:7168
    v_mfma_f32_16x16x32_bf16 v[128:131], v[196:199], v[52:55], v[128:131]
    s_add_u32 s31, s31, 16384
    s_cmp_eq_u32 s31, 49152
    s_cselect_b32 s31, 0, s31
    v_mov_b32 v9, v10
    v_add_u32 v10, s31, v1
    s_add_u32 s29, s29, 16384
    s_add_u32 s30, s30, 16384
    s_cmp_eq_u32 s30, 49152
    s_cselect_b32 s21, 49152, 0
    s_sub_u32 s30, s30, s21
    s_sub_u32 s29, s29, s21
    s_waitcnt lgkmcnt(4)
    v_mfma_f32_16x16x32_bf16 v[96:99], v[136:139], v[56:59], v[96:99]
    ds_read_b128 v[144:147], v9 offset:8192
    v_mfma_f32_16x16x32_bf16 v[116:119], v[136:139], v[60:63], v[116:119]
    buffer_load_dwordx4 v[48:51], v1, s[8:11], s24 offen
    s_add_u32 s24, s24, 1024
    v_mfma_f32_16x16x32_bf16 v[100:103], v[152:155], v[56:59], v[100:103]
    ds_read_b128 v[160:163], v9 offset:9216
    v_mfma_f32_16x16x32_bf16 v[120:123], v[152:155], v[60:63], v[120:123]
    buffer_load_dwordx4 v[52:55], v1, s[8:11], s49 offen
    s_add_u32 s49, s49, 1024
    v_mfma_f32_16x16x32_bf16 v[104:107], v[168:171], v[56:59], v[104:107]
    ds_read_b128 v[176:179], v9 offset:10240
    v_mfma_f32_16x16x32_bf16 v[124:127], v[168:171], v[60:63], v[124:127]
    s_mov_b32 m0, s29
    s_nop 0
    buffer_load_dwordx4 v1, s[12:15], s25 offen offset:0 lds
    v_mfma_f32_16x16x32_bf16 v[108:111], v[184:187], v[56:59], v[108:111]
    ds_read_b128 v[192:195], v9 offset:11264
    v_mfma_f32_16x16x32_bf16 v[128:131], v[184:187], v[60:63], v[128:131]
    buffer_load_dwordx4 v1, s[12:15], s25 offen offset:1024 lds
    s_waitcnt vmcnt(18) lgkmcnt(4)
    v_mfma_f32_16x16x32_bf16 v[96:99], v[140:143], v[64:67], v[96:99]
    ds_read_b128 v[148:151], v9 offset:12288
    v_mfma_f32_16x16x32_bf16 v[116:119], v[140:143], v[68:71], v[116:119]
    buffer_load_dwordx4 v[56:59], v1, s[8:11], s24 offen
    s_add_u32 s24, s24, 1024
    v_mfma_f32_16x16x32_bf16 v[100:103], v[156:159], v[64:67], v[100:103]
    ds_read_b128 v[164:167], v9 offset:13312
    v_mfma_f32_16x16x32_bf16 v[120:123], v[156:159], v[68:71], v[120:123]
    buffer_load_dwordx4 v[60:63], v1, s[8:11], s49 offen
    s_add_u32 s49, s49, 1024
    v_mfma_f32_16x16x32_bf16 v[104:107], v[172:175], v[64:67], v[104:107]
    ds_read_b128 v[180:183], v9 offset:14336
    v_mfma_f32_16x16x32_bf16 v[124:127], v[172:175], v[68:71], v[124:127]
    buffer_load_dwordx4 v1, s[12:15], s25 offen offset:2048 lds
    v_mfma_f32_16x16x32_bf16 v[108:111], v[188:191], v[64:67], v[108:111]
    ds_read_b128 v[196:199], v9 offset:15360
    v_mfma_f32_16x16x32_bf16 v[128:131], v[188:191], v[68:71], v[128:131]
    buffer_load_dwordx4 v1, s[12:15], s25 offen offset:3072 lds
    s_add_u32 s25, s25, 147456
    s_waitcnt vmcnt(20) lgkmcnt(4)
    v_mfma_f32_16x16x32_bf16 v[96:99], v[144:147], v[72:75], v[96:99]
    s_waitcnt vmcnt(12) lgkmcnt(0)
    s_barrier
    ds_read_b128 v[136:139], v10 offset:0
    v_mfma_f32_16x16x32_bf16 v[116:119], v[144:147], v[76:79], v[116:119]
    buffer_load_dwordx4 v[64:67], v1, s[8:11], s24 offen
    s_add_u32 s24, s24, 1024
    v_mfma_f32_16x16x32_bf16 v[100:103], v[160:163], v[72:75], v[100:103]
    ds_read_b128 v[152:155], v10 offset:1024
    v_mfma_f32_16x16x32_bf16 v[120:123], v[160:163], v[76:79], v[120:123]
    buffer_load_dwordx4 v[68:71], v1, s[8:11], s49 offen
    s_add_u32 s49, s49, 1024
    v_mfma_f32_16x16x32_bf16 v[104:107], v[176:179], v[72:75], v[104:107]
    ds_read_b128 v[168:171], v10 offset:2048
    v_mfma_f32_16x16x32_bf16 v[124:127], v[176:179], v[76:79], v[124:127]
    v_mfma_f32_16x16x32_bf16 v[108:111], v[192:195], v[72:75], v[108:111]
    ds_read_b128 v[184:187], v10 offset:3072
    v_mfma_f32_16x16x32_bf16 v[128:131], v[192:195], v[76:79], v[128:131]
    v_mfma_f32_16x16x32_bf16 v[96:99], v[148:151], v[80:83], v[96:99]
    ds_read_b128 v[140:143], v10 offset:4096
    v_mfma_f32_16x16x32_bf16 v[116:119], v[148:151], v[84:87], v[116:119]
    buffer_load_dwordx4 v[72:75], v1, s[8:11], s24 offen
    s_add_u32 s24, s24, 1024
    v_mfma_f32_16x16x32_bf16 v[100:103], v[164:167], v[80:83], v[100:103]
    ds_read_b128 v[156:159], v10 offset:5120
    v_mfma_f32_16x16x32_bf16 v[120:123], v[164:167], v[84:87], v[120:123]
    buffer_load_dwordx4 v[76:79], v1, s[8:11], s49 offen
    s_add_u32 s49, s49, 1024
    v_mfma_f32_16x16x32_bf16 v[104:107], v[180:183], v[80:83], v[104:107]
    ds_read_b128 v[172:175], v10 offset:6144
    v_mfma_f32_16x16x32_bf16 v[124:127], v[180:183], v[84:87], v[124:127]
    v_mfma_f32_16x16x32_bf16 v[108:111], v[196:199], v[80:83], v[108:111]
    ds_read_b128 v[188:191], v10 offset:7168
    v_mfma_f32_16x16x32_bf16 v[128:131], v[196:199], v[84:87], v[128:131]
    s_add_u32 s31, s31, 16384
    s_cmp_eq_u32 s31, 49152
    s_cselect_b32 s31, 0, s31
    v_mov_b32 v9, v10
    v_add_u32 v10, s31, v1
    s_add_u32 s29, s29, 16384
    s_add_u32 s30, s30, 16384
    s_cmp_eq_u32 s30, 49152
    s_cselect_b32 s21, 49152, 0
    s_sub_u32 s30, s30, s21
    s_sub_u32 s29, s29, s21
    s_add_u32 s23, s23, 1
    s_cmp_lt_u32 s23, 9
    s_cbranch_scc1 L_dn_loop_4
    s_setprio 0
    s_add_u32 s16, s6, 34709504
    s_addc_u32 s17, s7, 0
    s_mov_b32 s18, 5242880
    s_mov_b32 s19, 0x00020000
    s_lshl_b32 s23, s3, 2
    s_add_u32 s23, s23, s20
    s_mul_i32 s22, s23, 5120
    s_add_u32 s24, s22, 1024
    buffer_store_dwordx4 v[116:119], v1, s[16:19], s22 offen offset:0 sc1
    buffer_store_dwordx4 v[120:123], v1, s[16:19], s22 offen offset:1024 sc1
    buffer_store_dwordx4 v[124:127], v1, s[16:19], s22 offen offset:2048 sc1
    buffer_store_dwordx4 v[128:131], v1, s[16:19], s22 offen offset:3072 sc1
    s_mov_b32 m0, s29
    s_nop 0
    buffer_load_dwordx4 v1, s[12:15], s25 offen offset:0 lds
    buffer_load_dwordx4 v1, s[12:15], s25 offen offset:1024 lds
    buffer_load_dwordx4 v1, s[12:15], s25 offen offset:2048 lds
    buffer_load_dwordx4 v1, s[12:15], s25 offen offset:3072 lds
    s_add_u32 s25, s25, 147456
    s_add_u32 s29, s29, 16384
    s_add_u32 s30, s30, 16384
    s_cmp_eq_u32 s30, 49152
    s_cselect_b32 s21, 49152, 0
    s_sub_u32 s30, s30, s21
    s_sub_u32 s29, s29, s21
    s_waitcnt lgkmcnt(5)
    ds_read_b128 v[144:147], v1 offset:8192
    ds_read_b128 v[160:163], v1 offset:9216
    ds_read_b128 v[176:179], v1 offset:10240
    ds_read_b128 v[192:195], v1 offset:11264
    s_waitcnt lgkmcnt(5)
    ds_read_b128 v[148:151], v1 offset:12288
    ds_read_b128 v[164:167], v1 offset:13312
    ds_read_b128 v[180:183], v1 offset:14336
    ds_read_b128 v[196:199], v1 offset:15360
    s_add_u32 s32, s6, 34545664
    s_addc_u32 s33, s7, 0
    s_mov_b32 s34, 131072
    s_mov_b32 s35, 0x00020000
    s_mov_b32 s44, s6
    s_mov_b32 s45, s7
    s_mov_b32 s46, 2359296
    s_mov_b32 s47, 0x00020000
    s_lshl_b32 s31, s23, 6
    s_add_u32 s31, s31, 65536
    v_mov_b32 v3, 1
    v_lshlrev_b32 v6, 24, v0
    s_waitcnt vmcnt(4) lgkmcnt(0)
    buffer_store_dword v3, v6, s[32:35], s31 offen sc1
    s_barrier
    s_mov_b32 m0, s29
    s_nop 0
    buffer_load_dwordx4 v1, s[12:15], s25 offen offset:0 lds
    buffer_load_dwordx4 v1, s[12:15], s25 offen offset:1024 lds
    buffer_load_dwordx4 v1, s[12:15], s25 offen offset:2048 lds
    buffer_load_dwordx4 v1, s[12:15], s25 offen offset:3072 lds
    s_add_u32 s25, s25, 147456
    s_xor_b32 s31, s31, 256
    v_mov_b32 v6, 0
    s_mov_b32 s22, 1048576
L_dn_poll1_4:
    buffer_load_dword v8, v6, s[32:35], s31 offen sc1
    s_sub_u32 s22, s22, 1
    s_waitcnt vmcnt(0)
    s_cbranch_scc1 L_dn_got1_4
    v_cmp_ne_u32 vcc, 1, v8
    s_cbranch_vccnz L_dn_poll1_4
L_dn_got1_4:
    s_xor_b32 s23, s23, 4
    s_mul_i32 s22, s23, 5120
    s_add_u32 s24, s22, 1024
    buffer_load_dwordx4 v[116:119], v1, s[16:19], s22 offen offset:0 sc1
    buffer_load_dwordx4 v[120:123], v1, s[16:19], s22 offen offset:1024 sc1
    buffer_load_dwordx4 v[124:127], v1, s[16:19], s22 offen offset:2048 sc1
    buffer_load_dwordx4 v[128:131], v1, s[16:19], s22 offen offset:3072 sc1
    v_and_b32 v6, 31, v0
    v_lshlrev_b32 v6, 6, v6
    buffer_load_dword v8, v6, s[32:35], s28 offen sc1
    s_barrier
    s_waitcnt vmcnt(1)
    v_add_f32 v96, v96, v116
    v_add_f32 v97, v97, v117
    v_add_f32 v98, v98, v118
    v_add_f32 v99, v99, v119
    v_add_f32 v100, v100, v120
    v_add_f32 v101, v101, v121
    v_add_f32 v102, v102, v122
    v_add_f32 v103, v103, v123
    v_add_f32 v104, v104, v124
    v_add_f32 v105, v105, v125
    v_add_f32 v106, v106, v126
    v_add_f32 v107, v107, v127
    v_add_f32 v108, v108, v128
    v_add_f32 v109, v109, v129
    v_add_f32 v110, v110, v130
    v_add_f32 v111, v111, v131
    v_mul_f32 v116, 0xbfb8aa3b, v96
    v_mul_f32 v117, 0xbfb8aa3b, v97
    v_mul_f32 v118, 0xbfb8aa3b, v98
    v_mul_f32 v119, 0xbfb8aa3b, v99
    v_mul_f32 v120, 0xbfb8aa3b, v100
    v_mul_f32 v121, 0xbfb8aa3b, v101
    v_mul_f32 v122, 0xbfb8aa3b, v102
    v_mul_f32 v123, 0xbfb8aa3b, v103
    v_mul_f32 v124, 0xbfb8aa3b, v104
    v_mul_f32 v125, 0xbfb8aa3b, v105
    v_mul_f32 v126, 0xbfb8aa3b, v106
    v_mul_f32 v127, 0xbfb8aa3b, v107
    v_mul_f32 v128, 0xbfb8aa3b, v108
    v_mul_f32 v129, 0xbfb8aa3b, v109
    v_mul_f32 v130, 0xbfb8aa3b, v110
    v_mul_f32 v131, 0xbfb8aa3b, v111
    v_exp_f32 v116, v116
    v_exp_f32 v117, v117
    v_exp_f32 v118, v118
    v_exp_f32 v119, v119
    v_exp_f32 v120, v120
    v_exp_f32 v121, v121
    v_exp_f32 v122, v122
    v_exp_f32 v123, v123
    v_exp_f32 v124, v124
    v_exp_f32 v125, v125
    v_exp_f32 v126, v126
    v_exp_f32 v127, v127
    v_exp_f32 v128, v128
    v_exp_f32 v129, v129
    v_exp_f32 v130, v130
    v_exp_f32 v131, v131
    v_add_f32 v116, 1.0, v116
    v_add_f32 v117, 1.0, v117
    v_add_f32 v118, 1.0, v118
    v_add_f32 v119, 1.0, v119
    v_add_f32 v120, 1.0, v120
    v_add_f32 v121, 1.0, v121
    v_add_f32 v122, 1.0, v122
    v_add_f32 v123, 1.0, v123
    v_add_f32 v124, 1.0, v124
    v_add_f32 v125, 1.0, v125
    v_add_f32 v126, 1.0, v126
    v_add_f32 v127, 1.0, v127
    v_add_f32 v128, 1.0, v128
    v_add_f32 v129, 1.0, v129
    v_add_f32 v130, 1.0, v130
    v_add_f32 v131, 1.0, v131
    v_rcp_f32 v116, v116
    v_rcp_f32 v117, v117
    v_rcp_f32 v118, v118
    v_rcp_f32 v119, v119
    v_rcp_f32 v120, v120
    v_rcp_f32 v121, v121
    v_rcp_f32 v122, v122
    v_rcp_f32 v123, v123
    v_rcp_f32 v124, v124
    v_rcp_f32 v125, v125
    v_rcp_f32 v126, v126
    v_rcp_f32 v127, v127
    v_rcp_f32 v128, v128
    v_rcp_f32 v129, v129
    v_rcp_f32 v130, v130
    v_rcp_f32 v131, v131
    v_mul_f32 v96, v96, v116
    v_mul_f32 v97, v97, v117
    v_mul_f32 v98, v98, v118
    v_mul_f32 v99, v99, v119
    v_mul_f32 v100, v100, v120
    v_mul_f32 v101, v101, v121
    v_mul_f32 v102, v102, v122
    v_mul_f32 v103, v103, v123
    v_mul_f32 v104, v104, v124
    v_mul_f32 v105, v105, v125
    v_mul_f32 v106, v106, v126
    v_mul_f32 v107, v107, v127
    v_mul_f32 v108, v108, v128
    v_mul_f32 v109, v109, v129
    v_mul_f32 v110, v110, v130
    v_mul_f32 v111, v111, v131
    s_mov_b32 s22, 1048576
    s_waitcnt vmcnt(0)
    v_mov_b32 v3, 0
L_dn_poll_4:
    v_cmp_ne_u32 vcc, 1, v8
    s_cbranch_vccz L_dn_got_4
    s_ff1_i32_b32 s21, vcc_lo
    s_lshl_b32 s21, s21, 6
    s_add_u32 s21, s21, s28
L_dn_poll2_4:
    buffer_load_dword v8, v3, s[32:35], s21 offen sc1
    s_sub_u32 s22, s22, 1
    s_waitcnt vmcnt(0)
    s_cbranch_scc1 L_dn_got_4
    v_cmp_ne_u32 vcc, 1, v8
    s_cbranch_vccnz L_dn_poll2_4
    buffer_load_dword v8, v6, s[32:35], s28 offen sc1
    s_sub_u32 s22, s22, 1
    s_waitcnt vmcnt(0)
    s_cbranch_scc0 L_dn_poll_4
L_dn_got_4:
    buffer_load_dwordx4 v[24:27], v2, s[44:47], s48 offen offset:0 sc1
    buffer_load_dwordx4 v[28:31], v2, s[44:47], s48 offen offset:2048 sc1
    s_add_u32 s48, s48, 4096
    buffer_load_dwordx4 v[32:35], v2, s[44:47], s48 offen offset:0 sc1
    buffer_load_dwordx4 v[36:39], v2, s[44:47], s48 offen offset:2048 sc1
    s_add_u32 s48, s48, 4096
    buffer_load_dwordx4 v[40:43], v2, s[44:47], s48 offen offset:0 sc1
    buffer_load_dwordx4 v[44:47], v2, s[44:47], s48 offen offset:2048 sc1
    s_add_u32 s48, s48, 4096
    buffer_load_dwordx4 v[48:51], v2, s[44:47], s48 offen offset:0 sc1
    buffer_load_dwordx4 v[52:55], v2, s[44:47], s48 offen offset:2048 sc1
    s_add_u32 s48, s48, 4096
    buffer_load_dwordx4 v[56:59], v2, s[44:47], s48 offen offset:0 sc1
    buffer_load_dwordx4 v[60:63], v2, s[44:47], s48 offen offset:2048 sc1
    s_add_u32 s48, s48, 4096
    buffer_load_dwordx4 v[64:67], v2, s[44:47], s48 offen offset:0 sc1
    buffer_load_dwordx4 v[68:71], v2, s[44:47], s48 offen offset:2048 sc1
    s_add_u32 s48, s48, 4096
    buffer_load_dwordx4 v[72:75], v2, s[44:47], s48 offen offset:0 sc1
    buffer_load_dwordx4 v[76:79], v2, s[44:47], s48 offen offset:2048 sc1
    s_add_u32 s48, s48, 4096
    buffer_load_dwordx4 v[80:83], v2, s[44:47], s48 offen offset:0 sc1
    buffer_load_dwordx4 v[84:87], v2, s[44:47], s48 offen offset:2048 sc1
    s_add_u32 s48, s48, 4096
    s_sub_u32 s48, s48, 192
    buffer_load_dword v88, v11, s[44:47], s48 offen offset:0 sc1
    buffer_load_dword v89, v11, s[44:47], s48 offen offset:128 sc1
    buffer_load_dword v90, v11, s[44:47], s48 offen offset:256 sc1
    buffer_load_dword v91, v11, s[44:47], s48 offen offset:384 sc1
    buffer_load_dword v92, v11, s[44:47], s48 offen offset:2048 sc1
    buffer_load_dword v93, v11, s[44:47], s48 offen offset:2176 sc1
    buffer_load_dword v94, v11, s[44:47], s48 offen offset:2304 sc1
    buffer_load_dword v95, v11, s[44:47], s48 offen offset:2432 sc1
    s_waitcnt vmcnt(23)
    v_mfma_f32_16x16x32_bf16 v[116:119], v[136:139], v[24:27], 0
    v_mfma_f32_16x16x32_bf16 v[120:123], v[152:155], v[24:27], 0
    v_mfma_f32_16x16x32_bf16 v[124:127], v[168:171], v[24:27], 0
    v_mfma_f32_16x16x32_bf16 v[128:131], v[184:187], v[24:27], 0
    s_waitcnt vmcnt(22)
    v_mfma_f32_16x16x32_bf16 v[116:119], v[140:143], v[28:31], v[116:119]
    ds_read_b128 v[136:139], v1 offset:16384
    v_mfma_f32_16x16x32_bf16 v[120:123], v[156:159], v[28:31], v[120:123]
    ds_read_b128 v[152:155], v1 offset:17408
    v_mfma_f32_16x16x32_bf16 v[124:127], v[172:175], v[28:31], v[124:127]
    ds_read_b128 v[168:171], v1 offset:18432
    v_mfma_f32_16x16x32_bf16 v[128:131], v[188:191], v[28:31], v[128:131]
    ds_read_b128 v[184:187], v1 offset:19456
    s_waitcnt vmcnt(21)
    v_mfma_f32_16x16x32_bf16 v[116:119], v[144:147], v[32:35], v[116:119]
    ds_read_b128 v[140:143], v1 offset:20480
    v_mfma_f32_16x16x32_bf16 v[120:123], v[160:163], v[32:35], v[120:123]
    ds_read_b128 v[156:159], v1 offset:21504
    v_mfma_f32_16x16x32_bf16 v[124:127], v[176:179], v[32:35], v[124:127]
    ds_read_b128 v[172:175], v1 offset:22528
    v_mfma_f32_16x16x32_bf16 v[128:131], v[192:195], v[32:35], v[128:131]
    ds_read_b128 v[188:191], v1 offset:23552
    s_waitcnt vmcnt(20)
    v_mfma_f32_16x16x32_bf16 v[116:119], v[148:151], v[36:39], v[116:119]
    ds_read_b128 v[144:147], v1 offset:24576
    v_mfma_f32_16x16x32_bf16 v[120:123], v[164:167], v[36:39], v[120:123]
    ds_read_b128 v[160:163], v1 offset:25600
    v_mfma_f32_16x16x32_bf16 v[124:127], v[180:183], v[36:39], v[124:127]
    ds_read_b128 v[176:179], v1 offset:26624
    v_mfma_f32_16x16x32_bf16 v[128:131], v[196:199], v[36:39], v[128:131]
    ds_read_b128 v[192:195], v1 offset:27648
    s_waitcnt vmcnt(19) lgkmcnt(8)
    v_mfma_f32_16x16x32_bf16 v[116:119], v[136:139], v[40:43], v[116:119]
    ds_read_b128 v[148:151], v1 offset:28672
    v_mfma_f32_16x16x32_bf16 v[120:123], v[152:155], v[40:43], v[120:123]
    ds_read_b128 v[164:167], v1 offset:29696
    v_mfma_f32_16x16x32_bf16 v[124:127], v[168:171], v[40:43], v[124:127]
    ds_read_b128 v[180:183], v1 offset:30720
    v_mfma_f32_16x16x32_bf16 v[128:131], v[184:187], v[40:43], v[128:131]
    ds_read_b128 v[196:199], v1 offset:31744
    s_waitcnt vmcnt(18) lgkmcnt(8)
    v_mfma_f32_16x16x32_bf16 v[116:119], v[140:143], v[44:47], v[116:119]
    ds_read_b128 v[136:139], v1 offset:32768
    v_mfma_f32_16x16x32_bf16 v[120:123], v[156:159], v[44:47], v[120:123]
    ds_read_b128 v[152:155], v1 offset:33792
    v_mfma_f32_16x16x32_bf16 v[124:127], v[172:175], v[44:47], v[124:127]
    ds_read_b128 v[168:171], v1 offset:34816
    v_mfma_f32_16x16x32_bf16 v[128:131], v[188:191], v[44:47], v[128:131]
    ds_read_b128 v[184:187], v1 offset:35840
    s_waitcnt vmcnt(17) lgkmcnt(8)
    v_mfma_f32_16x16x32_bf16 v[116:119], v[144:147], v[48:51], v[116:119]
    ds_read_b128 v[140:143], v1 offset:36864
    v_mfma_f32_16x16x32_bf16 v[120:123], v[160:163], v[48:51], v[120:123]
    ds_read_b128 v[156:159], v1 offset:37888
    v_mfma_f32_16x16x32_bf16 v[124:127], v[176:179], v[48:51], v[124:127]
    ds_read_b128 v[172:175], v1 offset:38912
    v_mfma_f32_16x16x32_bf16 v[128:131], v[192:195], v[48:51], v[128:131]
    ds_read_b128 v[188:191], v1 offset:39936
    s_waitcnt vmcnt(16) lgkmcnt(8)
    v_mfma_f32_16x16x32_bf16 v[116:119], v[148:151], v[52:55], v[116:119]
    ds_read_b128 v[144:147], v1 offset:40960
    v_mfma_f32_16x16x32_bf16 v[120:123], v[164:167], v[52:55], v[120:123]
    ds_read_b128 v[160:163], v1 offset:41984
    v_mfma_f32_16x16x32_bf16 v[124:127], v[180:183], v[52:55], v[124:127]
    ds_read_b128 v[176:179], v1 offset:43008
    v_mfma_f32_16x16x32_bf16 v[128:131], v[196:199], v[52:55], v[128:131]
    ds_read_b128 v[192:195], v1 offset:44032
    s_waitcnt vmcnt(15) lgkmcnt(8)
    v_mfma_f32_16x16x32_bf16 v[116:119], v[136:139], v[56:59], v[116:119]
    ds_read_b128 v[148:151], v1 offset:45056
    v_mfma_f32_16x16x32_bf16 v[120:123], v[152:155], v[56:59], v[120:123]
    ds_read_b128 v[164:167], v1 offset:46080
    v_mfma_f32_16x16x32_bf16 v[124:127], v[168:171], v[56:59], v[124:127]
    ds_read_b128 v[180:183], v1 offset:47104
    v_mfma_f32_16x16x32_bf16 v[128:131], v[184:187], v[56:59], v[128:131]
    ds_read_b128 v[196:199], v1 offset:48128
    s_waitcnt vmcnt(14) lgkmcnt(8)
    v_mfma_f32_16x16x32_bf16 v[116:119], v[140:143], v[60:63], v[116:119]
    ds_read_b128 v[136:139], v1 offset:0
    v_mfma_f32_16x16x32_bf16 v[120:123], v[156:159], v[60:63], v[120:123]
    ds_read_b128 v[152:155], v1 offset:1024
    v_mfma_f32_16x16x32_bf16 v[124:127], v[172:175], v[60:63], v[124:127]
    ds_read_b128 v[168:171], v1 offset:2048
    v_mfma_f32_16x16x32_bf16 v[128:131], v[188:191], v[60:63], v[128:131]
    ds_read_b128 v[184:187], v1 offset:3072
    s_waitcnt vmcnt(13) lgkmcnt(8)
    v_mfma_f32_16x16x32_bf16 v[116:119], v[144:147], v[64:67], v[116:119]
    ds_read_b128 v[140:143], v1 offset:4096
    v_mfma_f32_16x16x32_bf16 v[120:123], v[160:163], v[64:67], v[120:123]
    ds_read_b128 v[156:159], v1 offset:5120
    v_mfma_f32_16x16x32_bf16 v[124:127], v[176:179], v[64:67], v[124:127]
    ds_read_b128 v[172:175], v1 offset:6144
    v_mfma_f32_16x16x32_bf16 v[128:131], v[192:195], v[64:67], v[128:131]
    ds_read_b128 v[188:191], v1 offset:7168
    s_waitcnt vmcnt(12) lgkmcnt(8)
    v_mfma_f32_16x16x32_bf16 v[116:119], v[148:151], v[68:71], v[116:119]
    ds_read_b128 v[144:147], v1 offset:8192
    v_mfma_f32_16x16x32_bf16 v[120:123], v[164:167], v[68:71], v[120:123]
    ds_read_b128 v[160:163], v1 offset:9216
    v_mfma_f32_16x16x32_bf16 v[124:127], v[180:183], v[68:71], v[124:127]
    ds_read_b128 v[176:179], v1 offset:10240
    v_mfma_f32_16x16x32_bf16 v[128:131], v[196:199], v[68:71], v[128:131]
    ds_read_b128 v[192:195], v1 offset:11264
    s_waitcnt vmcnt(11) lgkmcnt(8)
    v_mfma_f32_16x16x32_bf16 v[116:119], v[136:139], v[72:75], v[116:119]
    ds_read_b128 v[148:151], v1 offset:12288
    v_mfma_f32_16x16x32_bf16 v[120:123], v[152:155], v[72:75], v[120:123]
    ds_read_b128 v[164:167], v1 offset:13312
    v_mfma_f32_16x16x32_bf16 v[124:127], v[168:171], v[72:75], v[124:127]
    ds_read_b128 v[180:183], v1 offset:14336
    v_mfma_f32_16x16x32_bf16 v[128:131], v[184:187], v[72:75], v[128:131]
    ds_read_b128 v[196:199], v1 offset:15360
    s_waitcnt vmcnt(10) lgkmcnt(8)
    v_mfma_f32_16x16x32_bf16 v[116:119], v[140:143], v[76:79], v[116:119]
    v_mfma_f32_16x16x32_bf16 v[120:123], v[156:159], v[76:79], v[120:123]
    v_mfma_f32_16x16x32_bf16 v[124:127], v[172:175], v[76:79], v[124:127]
    v_mfma_f32_16x16x32_bf16 v[128:131], v[188:191], v[76:79], v[128:131]
    s_waitcnt vmcnt(9) lgkmcnt(4)
    v_mfma_f32_16x16x32_bf16 v[116:119], v[144:147], v[80:83], v[116:119]
    v_mfma_f32_16x16x32_bf16 v[120:123], v[160:163], v[80:83], v[120:123]
    v_mfma_f32_16x16x32_bf16 v[124:127], v[176:179], v[80:83], v[124:127]
    v_mfma_f32_16x16x32_bf16 v[128:131], v[192:195], v[80:83], v[128:131]
    s_waitcnt vmcnt(8) lgkmcnt(0)
    v_mfma_f32_16x16x32_bf16 v[116:119], v[148:151], v[84:87], v[116:119]
    v_mfma_f32_16x16x32_bf16 v[120:123], v[164:167], v[84:87], v[120:123]
    v_mfma_f32_16x16x32_bf16 v[124:127], v[180:183], v[84:87], v[124:127]
    v_mfma_f32_16x16x32_bf16 v[128:131], v[196:199], v[84:87], v[128:131]
    s_waitcnt vmcnt(4)
    v_mfma_f32_16x16x32_bf16 v[116:119], v[216:219], v[88:91], v[116:119]
    v_mfma_f32_16x16x32_bf16 v[120:123], v[220:223], v[88:91], v[120:123]
    v_mfma_f32_16x16x32_bf16 v[124:127], v[224:227], v[88:91], v[124:127]
    v_mfma_f32_16x16x32_bf16 v[128:131], v[228:231], v[88:91], v[128:131]
    s_waitcnt vmcnt(0)
    v_mfma_f32_16x16x32_bf16 v[116:119], v[236:239], v[92:95], v[116:119]
    v_mfma_f32_16x16x32_bf16 v[120:123], v[240:243], v[92:95], v[120:123]
    v_mfma_f32_16x16x32_bf16 v[124:127], v[244:247], v[92:95], v[124:127]
    v_mfma_f32_16x16x32_bf16 v[128:131], v[248:251], v[92:95], v[128:131]
    v_lshlrev_b32 v136, 16, v12
    v_and_b32 v137, 0xffff0000, v12
    v_lshlrev_b32 v138, 16, v13
    v_and_b32 v139, 0xffff0000, v13
    v_lshlrev_b32 v140, 16, v14
    v_and_b32 v141, 0xffff0000, v14
    v_lshlrev_b32 v142, 16, v15
    v_and_b32 v143, 0xffff0000, v15
    v_lshlrev_b32 v144, 16, v16
    v_and_b32 v145, 0xffff0000, v16
    v_lshlrev_b32 v146, 16, v17
    v_and_b32 v147, 0xffff0000, v17
    v_lshlrev_b32 v148, 16, v18
    v_and_b32 v149, 0xffff0000, v18
    v_lshlrev_b32 v150, 16, v19
    v_and_b32 v151, 0xffff0000, v19
    v_fmac_f32 v136, v96, v116
    v_fmac_f32 v137, v97, v117
    v_fmac_f32 v138, v98, v118
    v_fmac_f32 v139, v99, v119
    v_fmac_f32 v140, v100, v120
    v_fmac_f32 v141, v101, v121
    v_fmac_f32 v142, v102, v122
    v_fmac_f32 v143, v103, v123
    v_fmac_f32 v144, v104, v124
    v_fmac_f32 v145, v105, v125
    v_fmac_f32 v146, v106, v126
    v_fmac_f32 v147, v107, v127
    v_fmac_f32 v148, v108, v128
    v_fmac_f32 v149, v109, v129
    v_fmac_f32 v150, v110, v130
    v_fmac_f32 v151, v111, v131
    v_cvt_pk_bf16_f32 v12, v136, v137
    v_cvt_pk_bf16_f32 v13, v138, v139
    v_cvt_pk_bf16_f32 v14, v140, v141
    v_cvt_pk_bf16_f32 v15, v142, v143
    v_cvt_pk_bf16_f32 v16, v144, v145
    v_cvt_pk_bf16_f32 v17, v146, v147
    v_cvt_pk_bf16_f32 v18, v148, v149
    v_cvt_pk_bf16_f32 v19, v150, v151
    buffer_store_dwordx2 v[12:13], v7, s[40:43], s26 offen offset:0
    buffer_store_dwordx2 v[14:15], v7, s[40:43], s26 offen offset:32
    buffer_store_dwordx2 v[16:17], v7, s[40:43], s26 offen offset:64
    buffer_store_dwordx2 v[18:19], v7, s[40:43], s26 offen offset:96
    s_endpgm
L_dn5:
    s_mul_i32 s29, s20, 5120
    s_mov_b32 m0, s29
    s_nop 0
    buffer_load_dwordx4 v1, s[12:15], s25 offen offset:0 lds
    buffer_load_dwordx4 v1, s[12:15], s25 offen offset:1024 lds
    buffer_load_dwordx4 v[24:27], v1, s[8:11], s24 offen
    s_add_u32 s24, s24, 1024
    buffer_load_dwordx4 v[28:31], v1, s[8:11], s49 offen
    s_add_u32 s49, s49, 1024
    buffer_load_dwordx4 v1, s[12:15], s25 offen offset:2048 lds
    buffer_load_dwordx4 v1, s[12:15], s25 offen offset:3072 lds
    buffer_load_dwordx4 v[32:35], v1, s[8:11], s24 offen
    s_add_u32 s24, s24, 1024
    buffer_load_dwordx4 v[36:39], v1, s[8:11], s49 offen
    s_add_u32 s49, s49, 1024
    s_add_u32 m0, s29, 1024
    s_add_u32 s25, s25, 1024
    buffer_load_dwordx4 v1, s[12:15], s25 offen offset:3072 lds
    s_add_u32 s25, s25, 146432
    buffer_load_dwordx4 v[40:43], v1, s[8:11], s24 offen
    s_add_u32 s24, s24, 1024
    buffer_load_dwordx4 v[44:47], v1, s[8:11], s49 offen
    s_add_u32 s49, s49, 1024
    s_add_u32 s29, s29, 20480
    buffer_load_dwordx4 v[48:51], v1, s[8:11], s24 offen
    s_add_u32 s24, s24, 1024
    buffer_load_dwordx4 v[52:55], v1, s[8:11], s49 offen
    s_add_u32 s49, s49, 1024
    s_mov_b32 m0, s29
    s_nop 0
    buffer_load_dwordx4 v1, s[12:15], s25 offen offset:0 lds
    buffer_load_dwordx4 v1, s[12:15], s25 offen offset:1024 lds
    buffer_load_dwordx4 v[56:59], v1, s[8:11], s24 offen
    s_add_u32 s24, s24, 1024
    buffer_load_dwordx4 v[60:63], v1, s[8:11], s49 offen
    s_add_u32 s49, s49, 1024
    buffer_load_dwordx4 v1, s[12:15], s25 offen offset:2048 lds
    buffer_load_dwordx4 v1, s[12:15], s25 offen offset:3072 lds
    buffer_load_dwordx4 v[64:67], v1, s[8:11], s24 offen
    s_add_u32 s24, s24, 1024
    buffer_load_dwordx4 v[68:71], v1, s[8:11], s49 offen
    s_add_u32 s49, s49, 1024
    s_add_u32 m0, s29, 1024
    s_add_u32 s25, s25, 1024
    buffer_load_dwordx4 v1, s[12:15], s25 offen offset:3072 lds
    s_add_u32 s25, s25, 146432
    buffer_load_dwordx4 v[72:75], v1, s[8:11], s24 offen
    s_add_u32 s24, s24, 1024
    buffer_load_dwordx4 v[76:79], v1, s[8:11], s49 offen
    s_add_u32 s49, s49, 1024
    s_add_u32 s29, s29, 20480
    v_mov_b32 v9, v1
    v_add_u32 v10, 20480, v1
    s_mov_b32 s31, 20480
    s_mov_b32 s30, 40960
    v_mov_b32 v96, 0
    v_mov_b32 v97, 0
    v_mov_b32 v98, 0
    v_mov_b32 v99, 0
    v_mov_b32 v100, 0
    v_mov_b32 v101, 0
    v_mov_b32 v102, 0
    v_mov_b32 v103, 0
    v_mov_b32 v104, 0
    v_mov_b32 v105, 0
    v_mov_b32 v106, 0
    v_mov_b32 v107, 0
    v_mov_b32 v108, 0
    v_mov_b32 v109, 0
    v_mov_b32 v110, 0
    v_mov_b32 v111, 0
    v_mov_b32 v112, 0
    v_mov_b32 v113, 0
    v_mov_b32 v114, 0
    v_mov_b32 v115, 0
    v_mov_b32 v116, 0
    v_mov_b32 v117, 0
    v_mov_b32 v118, 0
    v_mov_b32 v119, 0
    v_mov_b32 v120, 0
    v_mov_b32 v121, 0
    v_mov_b32 v122, 0
    v_mov_b32 v123, 0
    v_mov_b32 v124, 0
    v_mov_b32 v125, 0
    v_mov_b32 v126, 0
    v_mov_b32 v127, 0
    v_mov_b32 v128, 0
    v_mov_b32 v129, 0
    v_mov_b32 v130, 0
    v_mov_b32 v131, 0
    v_mov_b32 v132, 0
    v_mov_b32 v133, 0
    v_mov_b32 v134, 0
    v_mov_b32 v135, 0
    s_mov_b32 s38, 2359296
    s_mov_b32 s39, 0x00020000
    s_mov_b32 s42, 2359296
    s_mov_b32 s43, 0x00020000
    v_lshrrev_b32 v3, 4, v0
    v_and_b32 v6, 0xf0, v1
    v_lshl_add_u32 v2, v3, 9, v6
    v_and_b32 v7, 15, v0
    v_lshlrev_b32 v11, 2, v7
    v_mul_u32_u24 v7, 1152, v7
    v_lshl_add_u32 v7, v3, 3, v7
    v_lshl_add_u32 v11, v3, 9, v11
    s_and_b32 s22, s26, 1
    s_xor_b32 s22, s22, 1
    s_mul_i32 s22, s22, 192
    v_add_u32 v11, s22, v11
    s_mul_i32 s26, s26, 18432
    s_lshl_b32 s22, s27, 5
    s_add_u32 s26, s26, s22
    s_waitcnt vmcnt(15)
    s_barrier
    ds_read_b128 v[136:139], v9 offset:0
    ds_read_b128 v[152:155], v9 offset:1024
    ds_read_b128 v[168:171], v9 offset:2048
    ds_read_b128 v[184:187], v9 offset:3072
    ds_read_b128 v[200:203], v9 offset:4096
    ds_read_b128 v[140:143], v9 offset:5120
    ds_read_b128 v[156:159], v9 offset:6144
    ds_read_b128 v[172:175], v9 offset:7168
    ds_read_b128 v[188:191], v9 offset:8192
    ds_read_b128 v[204:207], v9 offset:9216
    s_mov_b32 s23, 0
    s_setprio 0
L_dn_loop_5:
    s_cmp_lg_u32 s23, 3
    s_cbranch_scc1 L_dn_nx_5
    buffer_load_dwordx2 v[12:13], v7, s[36:39], s26 offen offset:0
    buffer_load_dwordx2 v[14:15], v7, s[36:39], s26 offen offset:32
    buffer_load_dwordx2 v[16:17], v7, s[36:39], s26 offen offset:64
    buffer_load_dwordx2 v[18:19], v7, s[36:39], s26 offen offset:96
    buffer_load_dwordx2 v[20:21], v7, s[36:39], s26 offen offset:128
    s_lshl_b32 s21, s27, 10
    s_add_u32 s21, s21, 5898240
    s_add_u32 s22, s21, 1024
    buffer_load_dwordx4 v[216:219], v1, s[12:15], s21 offen offset:0
    buffer_load_dwordx4 v[220:223], v1, s[12:15], s21 offen offset:1024
    buffer_load_dwordx4 v[224:227], v1, s[12:15], s21 offen offset:2048
    buffer_load_dwordx4 v[228:231], v1, s[12:15], s21 offen offset:3072
    buffer_load_dwordx4 v[232:235], v1, s[12:15], s22 offen offset:3072
    s_add_u32 s21, s21, 36864
    s_add_u32 s22, s21, 1024
    buffer_load_dwordx4 v[236:239], v1, s[12:15], s21 offen offset:0
    buffer_load_dwordx4 v[240:243], v1, s[12:15], s21 offen offset:1024
    buffer_load_dwordx4 v[244:247], v1, s[12:15], s21 offen offset:2048
    buffer_load_dwordx4 v[248:251], v1, s[12:15], s21 offen offset:3072
    buffer_load_dwordx4 v[252:255], v1, s[12:15], s22 offen offset:3072
    s_add_u32 s21, s21, 36864
L_dn_nx_5:
    s_cmp_lg_u32 s23, 5
    s_cbranch_scc1 L_dn_nc_5
    s_getpc_b64 s[16:17]
L_dn_pc_5:
    s_sub_u32 s16, s16, L_dn_pc_5 - L_at_fin
    s_subb_u32 s17, s17, 0
    s_mov_b32 s18, L_code_end - L_at_fin
    s_mov_b32 s19, 0x00020000
    v_lshlrev_b32 v3, 3, v1
    s_lshl_b32 s21, s20, 13
    buffer_load_dword v8, v3, s[16:19], s21 offen
L_dn_nc_5:
    s_cmp_eq_u32 s23, 8
    s_cselect_b32 s21, s50, 0
    s_add_u32 s25, s25, s21
    s_waitcnt lgkmcnt(5)
    v_mfma_f32_16x16x32_bf16 v[96:99], v[136:139], v[24:27], v[96:99]
    ds_read_b128 v[144:147], v9 offset:10240
    v_mfma_f32_16x16x32_bf16 v[116:119], v[136:139], v[28:31], v[116:119]
    buffer_load_dwordx4 v[80:83], v1, s[8:11], s24 offen
    s_add_u32 s24, s24, 1024
    v_mfma_f32_16x16x32_bf16 v[100:103], v[152:155], v[24:27], v[100:103]
    ds_read_b128 v[160:163], v9 offset:11264
    v_mfma_f32_16x16x32_bf16 v[120:123], v[152:155], v[28:31], v[120:123]
    buffer_load_dwordx4 v[84:87], v1, s[8:11], s49 offen
    s_add_u32 s49, s49, 1024
    v_mfma_f32_16x16x32_bf16 v[104:107], v[168:171], v[24:27], v[104:107]
    ds_read_b128 v[176:179], v9 offset:12288
    v_mfma_f32_16x16x32_bf16 v[124:127], v[168:171], v[28:31], v[124:127]
    s_mov_b32 m0, s29
    s_nop 0
    buffer_load_dwordx4 v1, s[12:15], s25 offen offset:0 lds
    v_mfma_f32_16x16x32_bf16 v[108:111], v[184:187], v[24:27], v[108:111]
    ds_read_b128 v[192:195], v9 offset:13312
    v_mfma_f32_16x16x32_bf16 v[128:131], v[184:187], v[28:31], v[128:131]
    buffer_load_dwordx4 v1, s[12:15], s25 offen offset:1024 lds
    v_mfma_f32_16x16x32_bf16 v[112:115], v[200:203], v[24:27], v[112:115]
    ds_read_b128 v[208:211], v9 offset:14336
    v_mfma_f32_16x16x32_bf16 v[132:135], v[200:203], v[28:31], v[132:135]
    s_waitcnt lgkmcnt(5)
    v_mfma_f32_16x16x32_bf16 v[96:99], v[140:143], v[32:35], v[96:99]
    ds_read_b128 v[148:151], v9 offset:15360
    v_mfma_f32_16x16x32_bf16 v[116:119], v[140:143], v[36:39], v[116:119]
    s_cmp_lt_u32 s23, 8
    s_cselect_b32 s10, s10, 0
    buffer_load_dwordx4 v[24:27], v1, s[8:11], s24 offen
    s_add_u32 s24, s24, 1024
    v_mfma_f32_16x16x32_bf16 v[100:103], v[156:159], v[32:35], v[100:103]
    ds_read_b128 v[164:167], v9 offset:16384
    v_mfma_f32_16x16x32_bf16 v[120:123], v[156:159], v[36:39], v[120:123]
    buffer_load_dwordx4 v[28:31], v1, s[8:11], s49 offen
    s_add_u32 s49, s49, 1024
    v_mfma_f32_16x16x32_bf16 v[104:107], v[172:175], v[32:35], v[104:107]
    ds_read_b128 v[180:183], v9 offset:17408
    v_mfma_f32_16x16x32_bf16 v[124:127], v[172:175], v[36:39], v[124:127]
    buffer_load_dwordx4 v1, s[12:15], s25 offen offset:2048 lds
    v_mfma_f32_16x16x32_bf16 v[108:111], v[188:191], v[32:35], v[108:111]
    ds_read_b128 v[196:199], v9 offset:18432
    v_mfma_f32_16x16x32_bf16 v[128:131], v[188:191], v[36:39], v[128:131]
    buffer_load_dwordx4 v1, s[12:15], s25 offen offset:3072 lds
    v_mfma_f32_16x16x32_bf16 v[112:115], v[204:207], v[32:35], v[112:115]
    ds_read_b128 v[212:215], v9 offset:19456
    v_mfma_f32_16x16x32_bf16 v[132:135], v[204:207], v[36:39], v[132:135]
    s_waitcnt vmcnt(21) lgkmcnt(5)
    v_mfma_f32_16x16x32_bf16 v[96:99], v[144:147], v[40:43], v[96:99]
    s_waitcnt vmcnt(10) lgkmcnt(0)
    s_barrier
    ds_read_b128 v[136:139], v10 offset:0
    v_mfma_f32_16x16x32_bf16 v[116:119], v[144:147], v[44:47], v[116:119]
    buffer_load_dwordx4 v[32:35], v1, s[8:11], s24 offen
    s_add_u32 s24, s24, 1024
    v_mfma_f32_16x16x32_bf16 v[100:103], v[160:163], v[40:43], v[100:103]
    ds_read_b128 v[152:155], v10 offset:1024
    v_mfma_f32_16x16x32_bf16 v[120:123], v[160:163], v[44:47], v[120:123]
    buffer_load_dwordx4 v[36:39], v1, s[8:11], s49 offen
    s_add_u32 s49, s49, 1024
    v_mfma_f32_16x16x32_bf16 v[104:107], v[176:179], v[40:43], v[104:107]
    ds_read_b128 v[168:171], v10 offset:2048
    v_mfma_f32_16x16x32_bf16 v[124:127], v[176:179], v[44:47], v[124:127]
    s_add_u32 m0, s29, 1024
    s_add_u32 s25, s25, 1024
    buffer_load_dwordx4 v1, s[12:15], s25 offen offset:3072 lds
    s_add_u32 s25, s25, 146432
    v_mfma_f32_16x16x32_bf16 v[108:111], v[192:195], v[40:43], v[108:111]
    ds_read_b128 v[184:187], v10 offset:3072
    v_mfma_f32_16x16x32_bf16 v[128:131], v[192:195], v[44:47], v[128:131]
    v_mfma_f32_16x16x32_bf16 v[112:115], v[208:211], v[40:43], v[112:115]
    ds_read_b128 v[200:203], v10 offset:4096
    v_mfma_f32_16x16x32_bf16 v[132:135], v[208:211], v[44:47], v[132:135]
    v_mfma_f32_16x16x32_bf16 v[96:99], v[148:151], v[48:51], v[96:99]
    ds_read_b128 v[140:143], v10 offset:5120
    v_mfma_f32_16x16x32_bf16 v[116:119], v[148:151], v[52:55], v[116:119]
    buffer_load_dwordx4 v[40:43], v1, s[8:11], s24 offen
    s_add_u32 s24, s24, 1024
    v_mfma_f32_16x16x32_bf16 v[100:103], v[164:167], v[48:51], v[100:103]
    ds_read_b128 v[156:159], v10 offset:6144
    v_mfma_f32_16x16x32_bf16 v[120:123], v[164:167], v[52:55], v[120:123]
    buffer_load_dwordx4 v[44:47], v1, s[8:11], s49 offen
    s_add_u32 s49, s49, 1024
    v_mfma_f32_16x16x32_bf16 v[104:107], v[180:183], v[48:51], v[104:107]
    ds_read_b128 v[172:175], v10 offset:7168
    v_mfma_f32_16x16x32_bf16 v[124:127], v[180:183], v[52:55], v[124:127]
    v_mfma_f32_16x16x32_bf16 v[108:111], v[196:199], v[48:51], v[108:111]
    ds_read_b128 v[188:191], v10 offset:8192
    v_mfma_f32_16x16x32_bf16 v[128:131], v[196:199], v[52:55], v[128:131]
    v_mfma_f32_16x16x32_bf16 v[112:115], v[212:215], v[48:51], v[112:115]
    ds_read_b128 v[204:207], v10 offset:9216
    v_mfma_f32_16x16x32_bf16 v[132:135], v[212:215], v[52:55], v[132:135]
    s_add_u32 s31, s31, 20480
    s_cmp_eq_u32 s31, 61440
    s_cselect_b32 s31, 0, s31
    v_mov_b32 v9, v10
    v_add_u32 v10, s31, v1
    s_add_u32 s29, s29, 20480
    s_add_u32 s30, s30, 20480
    s_cmp_eq_u32 s30, 61440
    s_cselect_b32 s21, 61440, 0
    s_sub_u32 s30, s30, s21
    s_sub_u32 s29, s29, s21
    s_waitcnt lgkmcnt(5)
    v_mfma_f32_16x16x32_bf16 v[96:99], v[136:139], v[56:59], v[96:99]
    ds_read_b128 v[144:147], v9 offset:10240
    v_mfma_f32_16x16x32_bf16 v[116:119], v[136:139], v[60:63], v[116:119]
    buffer_load_dwordx4 v[48:51], v1, s[8:11], s24 offen
    s_add_u32 s24, s24, 1024
    v_mfma_f32_16x16x32_bf16 v[100:103], v[152:155], v[56:59], v[100:103]
    ds_read_b128 v[160:163], v9 offset:11264
    v_mfma_f32_16x16x32_bf16 v[120:123], v[152:155], v[60:63], v[120:123]
    buffer_load_dwordx4 v[52:55], v1, s[8:11], s49 offen
    s_add_u32 s49, s49, 1024
    v_mfma_f32_16x16x32_bf16 v[104:107], v[168:171], v[56:59], v[104:107]
    ds_read_b128 v[176:179], v9 offset:12288
    v_mfma_f32_16x16x32_bf16 v[124:127], v[168:171], v[60:63], v[124:127]
    s_mov_b32 m0, s29
    s_nop 0
    buffer_load_dwordx4 v1, s[12:15], s25 offen offset:0 lds
    v_mfma_f32_16x16x32_bf16 v[108:111], v[184:187], v[56:59], v[108:111]
    ds_read_b128 v[192:195], v9 offset:13312
    v_mfma_f32_16x16x32_bf16 v[128:131], v[184:187], v[60:63], v[128:131]
    buffer_load_dwordx4 v1, s[12:15], s25 offen offset:1024 lds
    v_mfma_f32_16x16x32_bf16 v[112:115], v[200:203], v[56:59], v[112:115]
    ds_read_b128 v[208:211], v9 offset:14336
    v_mfma_f32_16x16x32_bf16 v[132:135], v[200:203], v[60:63], v[132:135]
    s_waitcnt lgkmcnt(5)
    v_mfma_f32_16x16x32_bf16 v[96:99], v[140:143], v[64:67], v[96:99]
    ds_read_b128 v[148:151], v9 offset:15360
    v_mfma_f32_16x16x32_bf16 v[116:119], v[140:143], v[68:71], v[116:119]
    buffer_load_dwordx4 v[56:59], v1, s[8:11], s24 offen
    s_add_u32 s24, s24, 1024
    v_mfma_f32_16x16x32_bf16 v[100:103], v[156:159], v[64:67], v[100:103]
    ds_read_b128 v[164:167], v9 offset:16384
    v_mfma_f32_16x16x32_bf16 v[120:123], v[156:159], v[68:71], v[120:123]
    buffer_load_dwordx4 v[60:63], v1, s[8:11], s49 offen
    s_add_u32 s49, s49, 1024
    v_mfma_f32_16x16x32_bf16 v[104:107], v[172:175], v[64:67], v[104:107]
    ds_read_b128 v[180:183], v9 offset:17408
    v_mfma_f32_16x16x32_bf16 v[124:127], v[172:175], v[68:71], v[124:127]
    buffer_load_dwordx4 v1, s[12:15], s25 offen offset:2048 lds
    v_mfma_f32_16x16x32_bf16 v[108:111], v[188:191], v[64:67], v[108:111]
    ds_read_b128 v[196:199], v9 offset:18432
    v_mfma_f32_16x16x32_bf16 v[128:131], v[188:191], v[68:71], v[128:131]
    buffer_load_dwordx4 v1, s[12:15], s25 offen offset:3072 lds
    v_mfma_f32_16x16x32_bf16 v[112:115], v[204:207], v[64:67], v[112:115]
    ds_read_b128 v[212:215], v9 offset:19456
    v_mfma_f32_16x16x32_bf16 v[132:135], v[204:207], v[68:71], v[132:135]
    s_waitcnt vmcnt(21) lgkmcnt(5)
    v_mfma_f32_16x16x32_bf16 v[96:99], v[144:147], v[72:75], v[96:99]
    s_waitcnt vmcnt(10) lgkmcnt(0)
    s_barrier
    ds_read_b128 v[136:139], v10 offset:0
    v_mfma_f32_16x16x32_bf16 v[116:119], v[144:147], v[76:79], v[116:119]
    buffer_load_dwordx4 v[64:67], v1, s[8:11], s24 offen
    s_add_u32 s24, s24, 1024
    v_mfma_f32_16x16x32_bf16 v[100:103], v[160:163], v[72:75], v[100:103]
    ds_read_b128 v[152:155], v10 offset:1024
    v_mfma_f32_16x16x32_bf16 v[120:123], v[160:163], v[76:79], v[120:123]
    buffer_load_dwordx4 v[68:71], v1, s[8:11], s49 offen
    s_add_u32 s49, s49, 1024
    v_mfma_f32_16x16x32_bf16 v[104:107], v[176:179], v[72:75], v[104:107]
    ds_read_b128 v[168:171], v10 offset:2048
    v_mfma_f32_16x16x32_bf16 v[124:127], v[176:179], v[76:79], v[124:127]
    s_add_u32 m0, s29, 1024
    s_add_u32 s25, s25, 1024
    buffer_load_dwordx4 v1, s[12:15], s25 offen offset:3072 lds
    s_add_u32 s25, s25, 146432
    v_mfma_f32_16x16x32_bf16 v[108:111], v[192:195], v[72:75], v[108:111]
    ds_read_b128 v[184:187], v10 offset:3072
    v_mfma_f32_16x16x32_bf16 v[128:131], v[192:195], v[76:79], v[128:131]
    v_mfma_f32_16x16x32_bf16 v[112:115], v[208:211], v[72:75], v[112:115]
    ds_read_b128 v[200:203], v10 offset:4096
    v_mfma_f32_16x16x32_bf16 v[132:135], v[208:211], v[76:79], v[132:135]
    v_mfma_f32_16x16x32_bf16 v[96:99], v[148:151], v[80:83], v[96:99]
    ds_read_b128 v[140:143], v10 offset:5120
    v_mfma_f32_16x16x32_bf16 v[116:119], v[148:151], v[84:87], v[116:119]
    buffer_load_dwordx4 v[72:75], v1, s[8:11], s24 offen
    s_add_u32 s24, s24, 1024
    v_mfma_f32_16x16x32_bf16 v[100:103], v[164:167], v[80:83], v[100:103]
    ds_read_b128 v[156:159], v10 offset:6144
    v_mfma_f32_16x16x32_bf16 v[120:123], v[164:167], v[84:87], v[120:123]
    buffer_load_dwordx4 v[76:79], v1, s[8:11], s49 offen
    s_add_u32 s49, s49, 1024
    v_mfma_f32_16x16x32_bf16 v[104:107], v[180:183], v[80:83], v[104:107]
    ds_read_b128 v[172:175], v10 offset:7168
    v_mfma_f32_16x16x32_bf16 v[124:127], v[180:183], v[84:87], v[124:127]
    v_mfma_f32_16x16x32_bf16 v[108:111], v[196:199], v[80:83], v[108:111]
    ds_read_b128 v[188:191], v10 offset:8192
    v_mfma_f32_16x16x32_bf16 v[128:131], v[196:199], v[84:87], v[128:131]
    v_mfma_f32_16x16x32_bf16 v[112:115], v[212:215], v[80:83], v[112:115]
    ds_read_b128 v[204:207], v10 offset:9216
    v_mfma_f32_16x16x32_bf16 v[132:135], v[212:215], v[84:87], v[132:135]
    s_add_u32 s31, s31, 20480
    s_cmp_eq_u32 s31, 61440
    s_cselect_b32 s31, 0, s31
    v_mov_b32 v9, v10
    v_add_u32 v10, s31, v1
    s_add_u32 s29, s29, 20480
    s_add_u32 s30, s30, 20480
    s_cmp_eq_u32 s30, 61440
    s_cselect_b32 s21, 61440, 0
    s_sub_u32 s30, s30, s21
    s_sub_u32 s29, s29, s21
    s_add_u32 s23, s23, 1
    s_cmp_lt_u32 s23, 9
    s_cbranch_scc1 L_dn_loop_5
    s_setprio 0
    s_add_u32 s16, s6, 34709504
    s_addc_u32 s17, s7, 0
    s_mov_b32 s18, 5242880
    s_mov_b32 s19, 0x00020000
    s_lshl_b32 s23, s3, 2
    s_add_u32 s23, s23, s20
    s_mul_i32 s22, s23, 5120
    s_add_u32 s24, s22, 1024
    buffer_store_dwordx4 v[116:119], v1, s[16:19], s22 offen offset:0 sc1
    buffer_store_dwordx4 v[120:123], v1, s[16:19], s22 offen offset:1024 sc1
    buffer_store_dwordx4 v[124:127], v1, s[16:19], s22 offen offset:2048 sc1
    buffer_store_dwordx4 v[128:131], v1, s[16:19], s22 offen offset:3072 sc1
    buffer_store_dwordx4 v[132:135], v1, s[16:19], s24 offen offset:3072 sc1
    s_mov_b32 m0, s29
    s_nop 0
    buffer_load_dwordx4 v1, s[12:15], s25 offen offset:0 lds
    buffer_load_dwordx4 v1, s[12:15], s25 offen offset:1024 lds
    buffer_load_dwordx4 v1, s[12:15], s25 offen offset:2048 lds
    buffer_load_dwordx4 v1, s[12:15], s25 offen offset:3072 lds
    s_add_u32 m0, s29, 1024
    s_add_u32 s25, s25, 1024
    buffer_load_dwordx4 v1, s[12:15], s25 offen offset:3072 lds
    s_add_u32 s25, s25, 146432
    s_add_u32 s29, s29, 20480
    s_add_u32 s30, s30, 20480
    s_cmp_eq_u32 s30, 61440
    s_cselect_b32 s21, 61440, 0
    s_sub_u32 s30, s30, s21
    s_sub_u32 s29, s29, s21
    s_waitcnt lgkmcnt(5)
    ds_read_b128 v[144:147], v1 offset:10240
    ds_read_b128 v[160:163], v1 offset:11264
    ds_read_b128 v[176:179], v1 offset:12288
    ds_read_b128 v[192:195], v1 offset:13312
    ds_read_b128 v[208:211], v1 offset:14336
    s_waitcnt lgkmcnt(5)
    ds_read_b128 v[148:151], v1 offset:15360
    ds_read_b128 v[164:167], v1 offset:16384
    ds_read_b128 v[180:183], v1 offset:17408
    ds_read_b128 v[196:199], v1 offset:18432
    ds_read_b128 v[212:215], v1 offset:19456
    s_add_u32 s32, s6, 34545664
    s_addc_u32 s33, s7, 0
    s_mov_b32 s34, 131072
    s_mov_b32 s35, 0x00020000
    s_mov_b32 s44, s6
    s_mov_b32 s45, s7
    s_mov_b32 s46, 2359296
    s_mov_b32 s47, 0x00020000
    s_lshl_b32 s31, s23, 6
    s_add_u32 s31, s31, 65536
    v_mov_b32 v3, 1
    v_lshlrev_b32 v6, 24, v0
    s_waitcnt vmcnt(5) lgkmcnt(0)
    buffer_store_dword v3, v6, s[32:35], s31 offen sc1
    s_barrier
    s_mov_b32 m0, s29
    s_nop 0
    buffer_load_dwordx4 v1, s[12:15], s25 offen offset:0 lds
    buffer_load_dwordx4 v1, s[12:15], s25 offen offset:1024 lds
    buffer_load_dwordx4 v1, s[12:15], s25 offen offset:2048 lds
    buffer_load_dwordx4 v1, s[12:15], s25 offen offset:3072 lds
    s_add_u32 m0, s29, 1024
    s_add_u32 s25, s25, 1024
    buffer_load_dwordx4 v1, s[12:15], s25 offen offset:3072 lds
    s_add_u32 s25, s25, 146432
    s_xor_b32 s31, s31, 256
    v_mov_b32 v6, 0
    s_mov_b32 s22, 1048576
L_dn_poll1_5:
    buffer_load_dword v8, v6, s[32:35], s31 offen sc1
    s_sub_u32 s22, s22, 1
    s_waitcnt vmcnt(0)
    s_cbranch_scc1 L_dn_got1_5
    v_cmp_ne_u32 vcc, 1, v8
    s_cbranch_vccnz L_dn_poll1_5
L_dn_got1_5:
    s_xor_b32 s23, s23, 4
    s_mul_i32 s22, s23, 5120
    s_add_u32 s24, s22, 1024
    buffer_load_dwordx4 v[116:119], v1, s[16:19], s22 offen offset:0 sc1
    buffer_load_dwordx4 v[120:123], v1, s[16:19], s22 offen offset:1024 sc1
    buffer_load_dwordx4 v[124:127], v1, s[16:19], s22 offen offset:2048 sc1
    buffer_load_dwordx4 v[128:131], v1, s[16:19], s22 offen offset:3072 sc1
    buffer_load_dwordx4 v[132:135], v1, s[16:19], s24 offen offset:3072 sc1
    v_and_b32 v6, 31, v0
    v_lshlrev_b32 v6, 6, v6
    buffer_load_dword v8, v6, s[32:35], s28 offen sc1
    s_barrier
    s_waitcnt vmcnt(1)
    v_add_f32 v96, v96, v116
    v_add_f32 v97, v97, v117
    v_add_f32 v98, v98, v118
    v_add_f32 v99, v99, v119
    v_add_f32 v100, v100, v120
    v_add_f32 v101, v101, v121
    v_add_f32 v102, v102, v122
    v_add_f32 v103, v103, v123
    v_add_f32 v104, v104, v124
    v_add_f32 v105, v105, v125
    v_add_f32 v106, v106, v126
    v_add_f32 v107, v107, v127
    v_add_f32 v108, v108, v128
    v_add_f32 v109, v109, v129
    v_add_f32 v110, v110, v130
    v_add_f32 v111, v111, v131
    v_add_f32 v112, v112, v132
    v_add_f32 v113, v113, v133
    v_add_f32 v114, v114, v134
    v_add_f32 v115, v115, v135
    v_mul_f32 v116, 0xbfb8aa3b, v96
    v_mul_f32 v117, 0xbfb8aa3b, v97
    v_mul_f32 v118, 0xbfb8aa3b, v98
    v_mul_f32 v119, 0xbfb8aa3b, v99
    v_mul_f32 v120, 0xbfb8aa3b, v100
    v_mul_f32 v121, 0xbfb8aa3b, v101
    v_mul_f32 v122, 0xbfb8aa3b, v102
    v_mul_f32 v123, 0xbfb8aa3b, v103
    v_mul_f32 v124, 0xbfb8aa3b, v104
    v_mul_f32 v125, 0xbfb8aa3b, v105
    v_mul_f32 v126, 0xbfb8aa3b, v106
    v_mul_f32 v127, 0xbfb8aa3b, v107
    v_mul_f32 v128, 0xbfb8aa3b, v108
    v_mul_f32 v129, 0xbfb8aa3b, v109
    v_mul_f32 v130, 0xbfb8aa3b, v110
    v_mul_f32 v131, 0xbfb8aa3b, v111
    v_mul_f32 v132, 0xbfb8aa3b, v112
    v_mul_f32 v133, 0xbfb8aa3b, v113
    v_mul_f32 v134, 0xbfb8aa3b, v114
    v_mul_f32 v135, 0xbfb8aa3b, v115
    v_exp_f32 v116, v116
    v_exp_f32 v117, v117
    v_exp_f32 v118, v118
    v_exp_f32 v119, v119
    v_exp_f32 v120, v120
    v_exp_f32 v121, v121
    v_exp_f32 v122, v122
    v_exp_f32 v123, v123
    v_exp_f32 v124, v124
    v_exp_f32 v125, v125
    v_exp_f32 v126, v126
    v_exp_f32 v127, v127
    v_exp_f32 v128, v128
    v_exp_f32 v129, v129
    v_exp_f32 v130, v130
    v_exp_f32 v131, v131
    v_exp_f32 v132, v132
    v_exp_f32 v133, v133
    v_exp_f32 v134, v134
    v_exp_f32 v135, v135
    v_add_f32 v116, 1.0, v116
    v_add_f32 v117, 1.0, v117
    v_add_f32 v118, 1.0, v118
    v_add_f32 v119, 1.0, v119
    v_add_f32 v120, 1.0, v120
    v_add_f32 v121, 1.0, v121
    v_add_f32 v122, 1.0, v122
    v_add_f32 v123, 1.0, v123
    v_add_f32 v124, 1.0, v124
    v_add_f32 v125, 1.0, v125
    v_add_f32 v126, 1.0, v126
    v_add_f32 v127, 1.0, v127
    v_add_f32 v128, 1.0, v128
    v_add_f32 v129, 1.0, v129
    v_add_f32 v130, 1.0, v130
    v_add_f32 v131, 1.0, v131
    v_add_f32 v132, 1.0, v132
    v_add_f32 v133, 1.0, v133
    v_add_f32 v134, 1.0, v134
    v_add_f32 v135, 1.0, v135
    v_rcp_f32 v116, v116
    v_rcp_f32 v117, v117
    v_rcp_f32 v118, v118
    v_rcp_f32 v119, v119
    v_rcp_f32 v120, v120
    v_rcp_f32 v121, v121
    v_rcp_f32 v122, v122
    v_rcp_f32 v123, v123
    v_rcp_f32 v124, v124
    v_rcp_f32 v125, v125
    v_rcp_f32 v126, v126
    v_rcp_f32 v127, v127
    v_rcp_f32 v128, v128
    v_rcp_f32 v129, v129
    v_rcp_f32 v130, v130
    v_rcp_f32 v131, v131
    v_rcp_f32 v132, v132
    v_rcp_f32 v133, v133
    v_rcp_f32 v134, v134
    v_rcp_f32 v135, v135
    v_mul_f32 v96, v96, v116
    v_mul_f32 v97, v97, v117
    v_mul_f32 v98, v98, v118
    v_mul_f32 v99, v99, v119
    v_mul_f32 v100, v100, v120
    v_mul_f32 v101, v101, v121
    v_mul_f32 v102, v102, v122
    v_mul_f32 v103, v103, v123
    v_mul_f32 v104, v104, v124
    v_mul_f32 v105, v105, v125
    v_mul_f32 v106, v106, v126
    v_mul_f32 v107, v107, v127
    v_mul_f32 v108, v108, v128
    v_mul_f32 v109, v109, v129
    v_mul_f32 v110, v110, v130
    v_mul_f32 v111, v111, v131
    v_mul_f32 v112, v112, v132
    v_mul_f32 v113, v113, v133
    v_mul_f32 v114, v114, v134
    v_mul_f32 v115, v115, v135
    s_mov_b32 s22, 1048576
    s_waitcnt vmcnt(0)
    v_mov_b32 v3, 0
L_dn_poll_5:
    v_cmp_ne_u32 vcc, 1, v8
    s_cbranch_vccz L_dn_got_5
    s_ff1_i32_b32 s21, vcc_lo
    s_lshl_b32 s21, s21, 6
    s_add_u32 s21, s21, s28
L_dn_poll2_5:
    buffer_load_dword v8, v3, s[32:35], s21 offen sc1
    s_sub_u32 s22, s22, 1
    s_waitcnt vmcnt(0)
    s_cbranch_scc1 L_dn_got_5
    v_cmp_ne_u32 vcc, 1, v8
    s_cbranch_vccnz L_dn_poll2_5
    buffer_load_dword v8, v6, s[32:35], s28 offen sc1
    s_sub_u32 s22, s22, 1
    s_waitcnt vmcnt(0)
    s_cbranch_scc0 L_dn_poll_5
L_dn_got_5:
    buffer_load_dwordx4 v[24:27], v2, s[44:47], s48 offen offset:0 sc1
    buffer_load_dwordx4 v[28:31], v2, s[44:47], s48 offen offset:2048 sc1
    s_add_u32 s48, s48, 4096
    buffer_load_dwordx4 v[32:35], v2, s[44:47], s48 offen offset:0 sc1
    buffer_load_dwordx4 v[36:39], v2, s[44:47], s48 offen offset:2048 sc1
    s_add_u32 s48, s48, 4096
    buffer_load_dwordx4 v[40:43], v2, s[44:47], s48 offen offset:0 sc1
    buffer_load_dwordx4 v[44:47], v2, s[44:47], s48 offen offset:2048 sc1
    s_add_u32 s48, s48, 4096
    buffer_load_dwordx4 v[48:51], v2, s[44:47], s48 offen offset:0 sc1
    buffer_load_dwordx4 v[52:55], v2, s[44:47], s48 offen offset:2048 sc1
    s_add_u32 s48, s48, 4096
    buffer_load_dwordx4 v[56:59], v2, s[44:47], s48 offen offset:0 sc1
    buffer_load_dwordx4 v[60:63], v2, s[44:47], s48 offen offset:2048 sc1
    s_add_u32 s48, s48, 4096
    buffer_load_dwordx4 v[64:67], v2, s[44:47], s48 offen offset:0 sc1
    buffer_load_dwordx4 v[68:71], v2, s[44:47], s48 offen offset:2048 sc1
    s_add_u32 s48, s48, 4096
    buffer_load_dwordx4 v[72:75], v2, s[44:47], s48 offen offset:0 sc1
    buffer_load_dwordx4 v[76:79], v2, s[44:47], s48 offen offset:2048 sc1
    s_add_u32 s48, s48, 4096
    buffer_load_dwordx4 v[80:83], v2, s[44:47], s48 offen offset:0 sc1
    buffer_load_dwordx4 v[84:87], v2, s[44:47], s48 offen offset:2048 sc1
    s_add_u32 s48, s48, 4096
    s_sub_u32 s48, s48, 192
    buffer_load_dword v88, v11, s[44:47], s48 offen offset:0 sc1
    buffer_load_dword v89, v11, s[44:47], s48 offen offset:128 sc1
    buffer_load_dword v90, v11, s[44:47], s48 offen offset:256 sc1
    buffer_load_dword v91, v11, s[44:47], s48 offen offset:384 sc1
    buffer_load_dword v92, v11, s[44:47], s48 offen offset:2048 sc1
    buffer_load_dword v93, v11, s[44:47], s48 offen offset:2176 sc1
    buffer_load_dword v94, v11, s[44:47], s48 offen offset:2304 sc1
    buffer_load_dword v95, v11, s[44:47], s48 offen offset:2432 sc1
    s_waitcnt vmcnt(23)
    v_mfma_f32_16x16x32_bf16 v[116:119], v[136:139], v[24:27], 0
    v_mfma_f32_16x16x32_bf16 v[120:123], v[152:155], v[24:27], 0
    v_mfma_f32_16x16x32_bf16 v[124:127], v[168:171], v[24:27], 0
    v_mfma_f32_16x16x32_bf16 v[128:131], v[184:187], v[24:27], 0
    v_mfma_f32_16x16x32_bf16 v[132:135], v[200:203], v[24:27], 0
    s_waitcnt vmcnt(22)
    v_mfma_f32_16x16x32_bf16 v[116:119], v[140:143], v[28:31], v[116:119]
    ds_read_b128 v[136:139], v1 offset:20480
    v_mfma_f32_16x16x32_bf16 v[120:123], v[156:159], v[28:31], v[120:123]
    ds_read_b128 v[152:155], v1 offset:21504
    v_mfma_f32_16x16x32_bf16 v[124:127], v[172:175], v[28:31], v[124:127]
    ds_read_b128 v[168:171], v1 offset:22528
    v_mfma_f32_16x16x32_bf16 v[128:131], v[188:191], v[28:31], v[128:131]
    ds_read_b128 v[184:187], v1 offset:23552
    v_mfma_f32_16x16x32_bf16 v[132:135], v[204:207], v[28:31], v[132:135]
    ds_read_b128 v[200:203], v1 offset:24576
    s_waitcnt vmcnt(21)
    v_mfma_f32_16x16x32_bf16 v[116:119], v[144:147], v[32:35], v[116:119]
    ds_read_b128 v[140:143], v1 offset:25600
    v_mfma_f32_16x16x32_bf16 v[120:123], v[160:163], v[32:35], v[120:123]
    ds_read_b128 v[156:159], v1 offset:26624
    v_mfma_f32_16x16x32_bf16 v[124:127], v[176:179], v[32:35], v[124:127]
    ds_read_b128 v[172:175], v1 offset:27648
    v_mfma_f32_16x16x32_bf16 v[128:131], v[192:195], v[32:35], v[128:131]
    ds_read_b128 v[188:191], v1 offset:28672
    v_mfma_f32_16x16x32_bf16 v[132:135], v[208:211], v[32:35], v[132:135]
    ds_read_b128 v[204:207], v1 offset:29696
    s_waitcnt vmcnt(20)
    v_mfma_f32_16x16x32_bf16 v[116:119], v[148:151], v[36:39], v[116:119]
    ds_read_b128 v[144:147], v1 offset:30720
    v_mfma_f32_16x16x32_bf16 v[120:123], v[164:167], v[36:39], v[120:123]
    ds_read_b128 v[160:163], v1 offset:31744
    v_mfma_f32_16x16x32_bf16 v[124:127], v[180:183], v[36:39], v[124:127]
    ds_read_b128 v[176:179], v1 offset:32768
    v_mfma_f32_16x16x32_bf16 v[128:131], v[196:199], v[36:39], v[128:131]
    ds_read_b128 v[192:195], v1 offset:33792
    v_mfma_f32_16x16x32_bf16 v[132:135], v[212:215], v[36:39], v[132:135]
    ds_read_b128 v[208:211], v1 offset:34816
    s_waitcnt vmcnt(19) lgkmcnt(10)
    v_mfma_f32_16x16x32_bf16 v[116:119], v[136:139], v[40:43], v[116:119]
    ds_read_b128 v[148:151], v1 offset:35840
    v_mfma_f32_16x16x32_bf16 v[120:123], v[152:155], v[40:43], v[120:123]
    ds_read_b128 v[164:167], v1 offset:36864
    v_mfma_f32_16x16x32_bf16 v[124:127], v[168:171], v[40:43], v[124:127]
    ds_read_b128 v[180:183], v1 offset:37888
    v_mfma_f32_16x16x32_bf16 v[128:131], v[184:187], v[40:43], v[128:131]
    ds_read_b128 v[196:199], v1 offset:38912
    v_mfma_f32_16x16x32_bf16 v[132:135], v[200:203], v[40:43], v[132:135]
    ds_read_b128 v[212:215], v1 offset:39936
    s_waitcnt vmcnt(18) lgkmcnt(10)
    v_mfma_f32_16x16x32_bf16 v[116:119], v[140:143], v[44:47], v[116:119]
    ds_read_b128 v[136:139], v1 offset:40960
    v_mfma_f32_16x16x32_bf16 v[120:123], v[156:159], v[44:47], v[120:123]
    ds_read_b128 v[152:155], v1 offset:41984
    v_mfma_f32_16x16x32_bf16 v[124:127], v[172:175], v[44:47], v[124:127]
    ds_read_b128 v[168:171], v1 offset:43008
    v_mfma_f32_16x16x32_bf16 v[128:131], v[188:191], v[44:47], v[128:131]
    ds_read_b128 v[184:187], v1 offset:44032
    v_mfma_f32_16x16x32_bf16 v[132:135], v[204:207], v[44:47], v[132:135]
    ds_read_b128 v[200:203], v1 offset:45056
    s_waitcnt vmcnt(17) lgkmcnt(10)
    v_mfma_f32_16x16x32_bf16 v[116:119], v[144:147], v[48:51], v[116:119]
    ds_read_b128 v[140:143], v1 offset:46080
    v_mfma_f32_16x16x32_bf16 v[120:123], v[160:163], v[48:51], v[120:123]
    ds_read_b128 v[156:159], v1 offset:47104
    v_mfma_f32_16x16x32_bf16 v[124:127], v[176:179], v[48:51], v[124:127]
    ds_read_b128 v[172:175], v1 offset:48128
    v_mfma_f32_16x16x32_bf16 v[128:131], v[192:195], v[48:51], v[128:131]
    ds_read_b128 v[188:191], v1 offset:49152
    v_mfma_f32_16x16x32_bf16 v[132:135], v[208:211], v[48:51], v[132:135]
    ds_read_b128 v[204:207], v1 offset:50176
    s_waitcnt vmcnt(16) lgkmcnt(10)
    v_mfma_f32_16x16x32_bf16 v[116:119], v[148:151], v[52:55], v[116:119]
    ds_read_b128 v[144:147], v1 offset:51200
    v_mfma_f32_16x16x32_bf16 v[120:123], v[164:167], v[52:55], v[120:123]
    ds_read_b128 v[160:163], v1 offset:52224
    v_mfma_f32_16x16x32_bf16 v[124:127], v[180:183], v[52:55], v[124:127]
    ds_read_b128 v[176:179], v1 offset:53248
    v_mfma_f32_16x16x32_bf16 v[128:131], v[196:199], v[52:55], v[128:131]
    ds_read_b128 v[192:195], v1 offset:54272
    v_mfma_f32_16x16x32_bf16 v[132:135], v[212:215], v[52:55], v[132:135]
    ds_read_b128 v[208:211], v1 offset:55296
    s_waitcnt vmcnt(15) lgkmcnt(10)
    v_mfma_f32_16x16x32_bf16 v[116:119], v[136:139], v[56:59], v[116:119]
    ds_read_b128 v[148:151], v1 offset:56320
    v_mfma_f32_16x16x32_bf16 v[120:123], v[152:155], v[56:59], v[120:123]
    ds_read_b128 v[164:167], v1 offset:57344
    v_mfma_f32_16x16x32_bf16 v[124:127], v[168:171], v[56:59], v[124:127]
    ds_read_b128 v[180:183], v1 offset:58368
    v_mfma_f32_16x16x32_bf16 v[128:131], v[184:187], v[56:59], v[128:131]
    ds_read_b128 v[196:199], v1 offset:59392
    v_mfma_f32_16x16x32_bf16 v[132:135], v[200:203], v[56:59], v[132:135]
    ds_read_b128 v[212:215], v1 offset:60416
    s_waitcnt vmcnt(14) lgkmcnt(10)
    v_mfma_f32_16x16x32_bf16 v[116:119], v[140:143], v[60:63], v[116:119]
    ds_read_b128 v[136:139], v1 offset:0
    v_mfma_f32_16x16x32_bf16 v[120:123], v[156:159], v[60:63], v[120:123]
    ds_read_b128 v[152:155], v1 offset:1024
    v_mfma_f32_16x16x32_bf16 v[124:127], v[172:175], v[60:63], v[124:127]
    ds_read_b128 v[168:171], v1 offset:2048
    v_mfma_f32_16x16x32_bf16 v[128:131], v[188:191], v[60:63], v[128:131]
    ds_read_b128 v[184:187], v1 offset:3072
    v_mfma_f32_16x16x32_bf16 v[132:135], v[204:207], v[60:63], v[132:135]
    ds_read_b128 v[200:203], v1 offset:4096
    s_waitcnt vmcnt(13) lgkmcnt(10)
    v_mfma_f32_16x16x32_bf16 v[116:119], v[144:147], v[64:67], v[116:119]
    ds_read_b128 v[140:143], v1 offset:5120
    v_mfma_f32_16x16x32_bf16 v[120:123], v[160:163], v[64:67], v[120:123]
    ds_read_b128 v[156:159], v1 offset:6144
    v_mfma_f32_16x16x32_bf16 v[124:127], v[176:179], v[64:67], v[124:127]
    ds_read_b128 v[172:175], v1 offset:7168
    v_mfma_f32_16x16x32_bf16 v[128:131], v[192:195], v[64:67], v[128:131]
    ds_read_b128 v[188:191], v1 offset:8192
    v_mfma_f32_16x16x32_bf16 v[132:135], v[208:211], v[64:67], v[132:135]
    ds_read_b128 v[204:207], v1 offset:9216
    s_waitcnt vmcnt(12) lgkmcnt(10)
    v_mfma_f32_16x16x32_bf16 v[116:119], v[148:151], v[68:71], v[116:119]
    ds_read_b128 v[144:147], v1 offset:10240
    v_mfma_f32_16x16x32_bf16 v[120:123], v[164:167], v[68:71], v[120:123]
    ds_read_b128 v[160:163], v1 offset:11264
    v_mfma_f32_16x16x32_bf16 v[124:127], v[180:183], v[68:71], v[124:127]
    ds_read_b128 v[176:179], v1 offset:12288
    v_mfma_f32_16x16x32_bf16 v[128:131], v[196:199], v[68:71], v[128:131]
    ds_read_b128 v[192:195], v1 offset:13312
    v_mfma_f32_16x16x32_bf16 v[132:135], v[212:215], v[68:71], v[132:135]
    ds_read_b128 v[208:211], v1 offset:14336
    s_waitcnt vmcnt(11) lgkmcnt(10)
    v_mfma_f32_16x16x32_bf16 v[116:119], v[136:139], v[72:75], v[116:119]
    ds_read_b128 v[148:151], v1 offset:15360
    v_mfma_f32_16x16x32_bf16 v[120:123], v[152:155], v[72:75], v[120:123]
    ds_read_b128 v[164:167], v1 offset:16384
    v_mfma_f32_16x16x32_bf16 v[124:127], v[168:171], v[72:75], v[124:127]
    ds_read_b128 v[180:183], v1 offset:17408
    v_mfma_f32_16x16x32_bf16 v[128:131], v[184:187], v[72:75], v[128:131]
    ds_read_b128 v[196:199], v1 offset:18432
    v_mfma_f32_16x16x32_bf16 v[132:135], v[200:203], v[72:75], v[132:135]
    ds_read_b128 v[212:215], v1 offset:19456
    s_waitcnt vmcnt(10) lgkmcnt(10)
    v_mfma_f32_16x16x32_bf16 v[116:119], v[140:143], v[76:79], v[116:119]
    v_mfma_f32_16x16x32_bf16 v[120:123], v[156:159], v[76:79], v[120:123]
    v_mfma_f32_16x16x32_bf16 v[124:127], v[172:175], v[76:79], v[124:127]
    v_mfma_f32_16x16x32_bf16 v[128:131], v[188:191], v[76:79], v[128:131]
    v_mfma_f32_16x16x32_bf16 v[132:135], v[204:207], v[76:79], v[132:135]
    s_waitcnt vmcnt(9) lgkmcnt(5)
    v_mfma_f32_16x16x32_bf16 v[116:119], v[144:147], v[80:83], v[116:119]
    v_mfma_f32_16x16x32_bf16 v[120:123], v[160:163], v[80:83], v[120:123]
    v_mfma_f32_16x16x32_bf16 v[124:127], v[176:179], v[80:83], v[124:127]
    v_mfma_f32_16x16x32_bf16 v[128:131], v[192:195], v[80:83], v[128:131]
    v_mfma_f32_16x16x32_bf16 v[132:135], v[208:211], v[80:83], v[132:135]
    s_waitcnt vmcnt(8) lgkmcnt(0)
    v_mfma_f32_16x16x32_bf16 v[116:119], v[148:151], v[84:87], v[116:119]
    v_mfma_f32_16x16x32_bf16 v[120:123], v[164:167], v[84:87], v[120:123]
    v_mfma_f32_16x16x32_bf16 v[124:127], v[180:183], v[84:87], v[124:127]
    v_mfma_f32_16x16x32_bf16 v[128:131], v[196:199], v[84:87], v[128:131]
    v_mfma_f32_16x16x32_bf16 v[132:135], v[212:215], v[84:87], v[132:135]
    s_waitcnt vmcnt(4)
    v_mfma_f32_16x16x32_bf16 v[116:119], v[216:219], v[88:91], v[116:119]
    v_mfma_f32_16x16x32_bf16 v[120:123], v[220:223], v[88:91], v[120:123]
    v_mfma_f32_16x16x32_bf16 v[124:127], v[224:227], v[88:91], v[124:127]
    v_mfma_f32_16x16x32_bf16 v[128:131], v[228:231], v[88:91], v[128:131]
    v_mfma_f32_16x16x32_bf16 v[132:135], v[232:235], v[88:91], v[132:135]
    s_waitcnt vmcnt(0)
    v_mfma_f32_16x16x32_bf16 v[116:119], v[236:239], v[92:95], v[116:119]
    v_mfma_f32_16x16x32_bf16 v[120:123], v[240:243], v[92:95], v[120:123]
    v_mfma_f32_16x16x32_bf16 v[124:127], v[244:247], v[92:95], v[124:127]
    v_mfma_f32_16x16x32_bf16 v[128:131], v[248:251], v[92:95], v[128:131]
    v_mfma_f32_16x16x32_bf16 v[132:135], v[252:255], v[92:95], v[132:135]
    v_lshlrev_b32 v136, 16, v12
    v_and_b32 v137, 0xffff0000, v12
    v_lshlrev_b32 v138, 16, v13
    v_and_b32 v139, 0xffff0000, v13
    v_lshlrev_b32 v140, 16, v14
    v_and_b32 v141, 0xffff0000, v14
    v_lshlrev_b32 v142, 16, v15
    v_and_b32 v143, 0xffff0000, v15
    v_lshlrev_b32 v144, 16, v16
    v_and_b32 v145, 0xffff0000, v16
    v_lshlrev_b32 v146, 16, v17
    v_and_b32 v147, 0xffff0000, v17
    v_lshlrev_b32 v148, 16, v18
    v_and_b32 v149, 0xffff0000, v18
    v_lshlrev_b32 v150, 16, v19
    v_and_b32 v151, 0xffff0000, v19
    v_lshlrev_b32 v152, 16, v20
    v_and_b32 v153, 0xffff0000, v20
    v_lshlrev_b32 v154, 16, v21
    v_and_b32 v155, 0xffff0000, v21
    v_fmac_f32 v136, v96, v116
    v_fmac_f32 v137, v97, v117
    v_fmac_f32 v138, v98, v118
    v_fmac_f32 v139, v99, v119
    v_fmac_f32 v140, v100, v120
    v_fmac_f32 v141, v101, v121
    v_fmac_f32 v142, v102, v122
    v_fmac_f32 v143, v103, v123
    v_fmac_f32 v144, v104, v124
    v_fmac_f32 v145, v105, v125
    v_fmac_f32 v146, v106, v126
    v_fmac_f32 v147, v107, v127
    v_fmac_f32 v148, v108, v128
    v_fmac_f32 v149, v109, v129
    v_fmac_f32 v150, v110, v130
    v_fmac_f32 v151, v111, v131
    v_fmac_f32 v152, v112, v132
    v_fmac_f32 v153, v113, v133
    v_fmac_f32 v154, v114, v134
    v_fmac_f32 v155, v115, v135
    v_cvt_pk_bf16_f32 v12, v136, v137
    v_cvt_pk_bf16_f32 v13, v138, v139
    v_cvt_pk_bf16_f32 v14, v140, v141
    v_cvt_pk_bf16_f32 v15, v142, v143
    v_cvt_pk_bf16_f32 v16, v144, v145
    v_cvt_pk_bf16_f32 v17, v146, v147
    v_cvt_pk_bf16_f32 v18, v148, v149
    v_cvt_pk_bf16_f32 v19, v150, v151
    v_cvt_pk_bf16_f32 v20, v152, v153
    v_cvt_pk_bf16_f32 v21, v154, v155
    buffer_store_dwordx2 v[12:13], v7, s[40:43], s26 offen offset:0
    buffer_store_dwordx2 v[14:15], v7, s[40:43], s26 offen offset:32
    buffer_store_dwordx2 v[16:17], v7, s[40:43], s26 offen offset:64
    buffer_store_dwordx2 v[18:19], v7, s[40:43], s26 offen offset:96
    buffer_store_dwordx2 v[20:21], v7, s[40:43], s26 offen offset:128
    s_endpgm
L_k2_end:
    s_endpgm
L_code_end:
    s_endpgm
.section .rodata,"a"
.p2align 6
.amdhsa_kernel gemm1_kernel
  .amdhsa_next_free_vgpr 512
  .amdhsa_next_free_sgpr 102
  .amdhsa_accum_offset 256
  .amdhsa_group_segment_fixed_size 0
  .amdhsa_kernarg_size 80
  .amdhsa_user_sgpr_count 2
  .amdhsa_user_sgpr_kernarg_segment_ptr 1
  .amdhsa_system_sgpr_workgroup_id_x 1
.end_amdhsa_kernel
.p2align 6
.amdhsa_kernel mid_kernel
  .amdhsa_next_free_vgpr 256
  .amdhsa_next_free_sgpr 96
  .amdhsa_accum_offset 256
  .amdhsa_group_segment_fixed_size 0
  .amdhsa_kernarg_size 80
  .amdhsa_user_sgpr_count 2
  .amdhsa_user_sgpr_kernarg_segment_ptr 1
  .amdhsa_system_sgpr_workgroup_id_x 1
.end_amdhsa_kernel
```
